```python
import torch

def _softmax(x, axis=-1):
    return torch.softmax(x, dim=axis)
def _gelu(x):
    return torch.nn.functional.gelu(x, approximate="tanh")
def _silu(x):
    return torch.nn.functional.silu(x)
def _sigmoid(x):
    return torch.sigmoid(x)
def _layernorm(x, axis=-1, eps=1e-5):
    m = x.mean(dim=axis, keepdim=True)
    v = x.var(dim=axis, keepdim=True, unbiased=False)
    return (x - m) / torch.sqrt(v + eps)
def _scatter_add(tgt, idx, src, axis=0):
    return tgt.clone().index_add_(axis, idx, src)
def _segment_sum(src, seg, n):
    out = torch.zeros((n,) + src.shape[1:], dtype=src.dtype)
    return out.index_add_(0, seg, src)
def _pad(x, pw):
    flat = tuple(v for pair in reversed(pw) for v in pair)
    return torch.nn.functional.pad(x, flat)

kernel_name = 'parallel_sum__linear_attn_block__mixer_token_mlp__prompt'

def setup_inputs():

    _w = (lambda a: (lambda t: t.to(torch.bfloat16) if t.is_floating_point() else t)(torch.as_tensor(a)))
    def _A_setup():
        B, S, D = 1, 2048, 640
        return {
            "x": _w((lambda *s: torch.randn(*s, dtype=torch.bfloat16) * 0.05)(B, S, D)),
            "wqkv": _w((lambda *s: torch.randn(*s, dtype=torch.bfloat16) * 0.05)(D, 3 * D)),
            "wo": _w((lambda *s: torch.randn(*s, dtype=torch.bfloat16) * 0.05)(D, D)),
        }
    _A_in = _A_setup()

    def _B_setup():
        B, S, D, F = 1, 2048, 640, 1728
        return {
            "x": _w((lambda *s: torch.randn(*s, dtype=torch.bfloat16) * 0.05)(B, S, D)),
            "w1": _w((lambda *s: torch.randn(*s, dtype=torch.bfloat16) * 0.4)(S, F) * (S ** -0.5)),
            "b1": _w((lambda *s: torch.randn(*s, dtype=torch.bfloat16) * 3.2)(F) * 0.02),
            "w2": _w((lambda *s: torch.randn(*s, dtype=torch.bfloat16) * 0.2)(F, S) * (F ** -0.5)),
            "b2": _w((lambda *s: torch.randn(*s, dtype=torch.bfloat16) * 0.4)(S) * 0.02),
        }
    _B_in = _B_setup()

    return {
        "A_x": _A_in["x"],
        "A_wqkv": _A_in["wqkv"],
        "A_wo": _A_in["wo"],
        "B_x": _B_in["x"],
        "B_w1": _B_in["w1"],
        "B_b1": _B_in["b1"],
        "B_w2": _B_in["w2"],
        "B_b2": _B_in["b2"],
    }

def reference(A_x, A_wqkv, A_wo, B_x, B_w1, B_b1, B_w2, B_b2):
    def _A_ref(x, wqkv, wo):
        B, S, D = x.shape
        H = 32; Dh = D // H
        qkv = (lambda x, *d: x.permute(*d))((x @ wqkv).reshape(B, S, 3, H, Dh), 2, 0, 3, 1, 4)
        q, k, v = qkv[0], qkv[1], qkv[2]
        phi = lambda t: torch.where(t > 0, t + 1, torch.exp(t)) + 1e-6
        pq, pk = phi(q), phi(k)
        kv = torch.einsum("bhsd,bhse->bhde", pk, v)
        z = torch.einsum("bhsd->bhd", pk)
        num = torch.einsum("bhqd,bhde->bhqe", pq, kv)
        den = torch.einsum("bhqd,bhd->bhq", pq, z)[..., None] + 1e-6
        o = num / den
        return (lambda x, *d: x.permute(*d))(o, 0, 2, 1, 3).reshape(B, S, D) @ wo

    def _B_ref(x, w1, b1, w2, b2):
        B, S, D = x.shape
        h = _layernorm(x, axis=-1)
        u = torch.einsum("bsd,sf->bdf", h, w1) + b1
        u = _gelu(u)
        y = torch.einsum("bdf,fs->bds", u, w2) + b2
        return (lambda x, *d: x.permute(*d))(y, 0, 2, 1)

    x = A_x
    xn = _layernorm(x, axis=-1)
    return x + _A_ref(xn, A_wqkv, A_wo) + _B_ref(xn, B_w1, B_b1, B_w2, B_b2)
```

```asm
; @launch grid=(256,1,1) block=(512,1,1) lds=163840
.amdgcn_target "amdgcn-amd-amdhsa--gfx950"
.text
.globl parallel_sum__linear_attn_block__mixer_token_mlp__prompt_kernel
.p2align 8
.type parallel_sum__linear_attn_block__mixer_token_mlp__prompt_kernel,@function
parallel_sum__linear_attn_block__mixer_token_mlp__prompt_kernel:
    s_cmp_ge_u32 s2, 256
    s_cbranch_scc1 L_end
    s_load_dwordx16 s[64:79], s[0:1], 0
    s_load_dwordx4 s[80:83], s[0:1], 64
    s_load_dwordx2 s[84:85], s[0:1], 80
    s_memrealtime s[60:61]
    s_and_b32 s14, s2, 7
    s_lshr_b32 s15, s2, 3
    s_lshr_b32 s17, s14, 1
    s_and_b32 s19, s14, 1
    s_lshl_b32 s16, s17, 3
    s_lshr_b32 s21, s15, 2
    s_add_u32 s16, s16, s21
    s_lshl_b32 s18, s19, 2
    s_and_b32 s21, s15, 3
    s_add_u32 s18, s18, s21
    v_lshrrev_b32 v1, 6, v0
    v_and_b32 v0, 63, v0
    v_mov_b32 v252, 0
    v_mov_b32 v240, 0
    v_mov_b32 v241, 0
    v_mov_b32 v242, 0
    v_mov_b32 v243, 0
    v_mov_b32 v244, 0
    v_mov_b32 v245, 0
    v_mov_b32 v246, 0
    v_mov_b32 v247, 0
    v_mov_b32 v248, 0
    v_mov_b32 v249, 0
    v_mov_b32 v250, 0
    v_readfirstlane_b32 s20, v1
    s_getpc_b64 s[4:5]
L_pc:
    s_cmp_lg_u32 s20, 5
    s_cbranch_scc1 L_ncp
    s_cmp_ge_u32 s15, 8
    s_cbranch_scc1 L_ncp
    s_lshl_b32 s6, s15, 13
    v_lshlrev_b32 v2, 7, v0
    v_add_u32 v2, s6, v2
    v_min_u32 v2, L_end-L_pc, v2
    v_mov_b32 v3, s5
    v_add_co_u32 v2, vcc, s4, v2
    s_nop 1
    v_addc_co_u32 v3, vcc, 0, v3, vcc
    global_load_dword v253, v[2:3], off
L_ncp:
    v_lshrrev_b32 v2, 4, v0
    v_mul_u32_u24 v2, 1280, v2
    v_and_b32 v3, 15, v0
    v_lshl_add_u32 v2, v3, 4, v2
    s_lshl_b32 s21, s16, 6
    s_lshl_b32 s22, s18, 1
    s_add_u32 s22, s22, s20
    s_and_b32 s22, s22, 7
    s_lshl_b32 s52, s22, 3
    s_add_u32 s21, s21, s52
    s_mul_i32 s21, s21, 1280
    s_and_b32 s13, s20, 3
    s_lshl_b32 s23, s18, 2
    s_add_u32 s23, s23, s13
    s_waitcnt lgkmcnt(0)
    s_mov_b32 s24, s64
    s_mov_b32 s25, s65
    s_mov_b32 s26, 0x280000
    s_mov_b32 s27, 0x20000
    s_mov_b32 s4, 0
    s_and_b32 s4, s4, 1
    s_mul_i32 s22, s4, 5120
    s_add_u32 s22, s22, s21
    s_lshl_b32 s8, s4, 2
    buffer_load_dwordx4 v[64:67], v2, s[24:27], s22 offen offset:0
    buffer_load_dwordx4 v[68:71], v2, s[24:27], s22 offen offset:256
    buffer_load_dwordx4 v[72:75], v2, s[24:27], s22 offen offset:512
    buffer_load_dwordx4 v[76:79], v2, s[24:27], s22 offen offset:768
    buffer_load_dwordx4 v[80:83], v2, s[24:27], s22 offen offset:1024
    s_mov_b32 s4, 1
    s_and_b32 s4, s4, 1
    s_mul_i32 s22, s4, 5120
    s_add_u32 s22, s22, s21
    s_lshl_b32 s9, s4, 2
    buffer_load_dwordx4 v[84:87], v2, s[24:27], s22 offen offset:0
    buffer_load_dwordx4 v[88:91], v2, s[24:27], s22 offen offset:256
    buffer_load_dwordx4 v[92:95], v2, s[24:27], s22 offen offset:512
    buffer_load_dwordx4 v[96:99], v2, s[24:27], s22 offen offset:768
    buffer_load_dwordx4 v[100:103], v2, s[24:27], s22 offen offset:1024
    s_mov_b32 s28, s66
    s_mov_b32 s29, s67
    s_mov_b32 s30, 0x258000
    s_mov_b32 s31, 0x20000
    s_mov_b32 s32, s84
    s_mov_b32 s33, s85
    s_mov_b32 s34, 0x1100000
    s_mov_b32 s35, 0x20000
    s_mov_b32 s56, s82
    s_mov_b32 s57, s83
    s_mov_b32 s58, 0x100
    s_mov_b32 s59, 0x20000
    s_mul_i32 s10, s17, 28
    s_add_u32 s10, s10, s15
    s_and_b32 s11, s10, 3
    s_lshr_b32 s10, s10, 2
    s_cmp_ge_u32 s15, 27
    s_subb_u32 s15, s15, 0
    s_cmp_eq_u32 s10, 27
    s_cselect_b32 s15, 31, s15
    s_lshl_b32 s12, s19, 2
    s_add_u32 s11, s11, s12
    s_add_u32 s98, s10, s11
    s_add_u32 s99, s16, s18
    s_mul_i32 s3, s16, 52
    s_lshr_b32 s3, s3, 8
    s_mul_i32 s3, s3, 5
    s_sub_u32 s3, s16, s3
    s_cmp_ge_u32 s20, 4
    s_cbranch_scc1 L_loader
    s_or_b32 s21, s2, s20
    s_cmp_lg_u32 s21, 0
    s_cbranch_scc1 L_non
    s_or_b32 s60, s60, 1
    v_mov_b32 v251, s60
    s_mov_b64 exec, 1
    buffer_store_dword v251, v252, s[56:59], 0 offen sc1
    s_mov_b64 exec, -1
L_non:
    s_lshl_b32 s21, s20, 12
    s_add_u32 s21, s21, 81920
    v_lshrrev_b32 v16, 4, v0
    v_lshlrev_b32 v16, 3, v16
    v_bfe_u32 v17, v0, 2, 2
    v_add_u32 v16, v16, v17
    v_lshlrev_b32 v16, 7, v16
    v_and_b32 v17, 3, v0
    v_lshl_add_u32 v16, v17, 3, v16
    v_add_u32 v16, s21, v16
    v_bfe_u32 v17, v0, 3, 2
    v_xor_b32 v4, 0, v17
    v_lshl_add_u32 v4, v4, 5, v16
    v_xor_b32 v5, 1, v17
    v_lshl_add_u32 v5, v5, 5, v16
    v_xor_b32 v6, 2, v17
    v_lshl_add_u32 v6, v6, 5, v16
    v_xor_b32 v7, 3, v17
    v_lshl_add_u32 v7, v7, 5, v16
    s_cmp_eq_u32 s3, 4
    s_mov_b32 s40, 256
    s_cmp_eq_u32 s3, 4
    s_cselect_b32 s40, 0xfffffc00, s40
    s_cmp_eq_u32 s3, 3
    s_mov_b32 s41, 256
    s_cmp_eq_u32 s3, 3
    s_cselect_b32 s41, 0xfffffc00, s41
    s_cmp_eq_u32 s3, 2
    s_mov_b32 s42, 256
    s_cmp_eq_u32 s3, 2
    s_cselect_b32 s42, 0xfffffc00, s42
    s_cmp_eq_u32 s3, 1
    s_mov_b32 s43, 256
    s_cmp_eq_u32 s3, 1
    s_cselect_b32 s43, 0xfffffc00, s43
    v_add_u32 v8, 0x10000, v4
    v_add_u32 v9, 0x10000, v5
    v_add_u32 v10, 0x10000, v6
    v_add_u32 v11, 0x10000, v7
    v_and_b32 v16, 15, v0
    v_lshrrev_b32 v17, 4, v0
    v_xor_b32 v17, v17, v16
    v_mul_u32_u24 v16, 1280, v16
    s_lshl_b32 s21, s3, 8
    v_add_u32 v16, s21, v16
    v_xor_b32 v12, 0, v17
    v_lshl_add_u32 v12, v12, 4, v16
    v_xor_b32 v13, 4, v17
    v_lshl_add_u32 v13, v13, 4, v16
    v_xor_b32 v14, 8, v17
    v_lshl_add_u32 v14, v14, 4, v16
    v_xor_b32 v15, 12, v17
    v_lshl_add_u32 v15, v15, 4, v16
    s_and_b32 s7, s13, 1
    s_lshl_b32 s21, s7, 5
    v_lshrrev_b32 v16, 2, v0
    v_add_u32 v17, s21, v16
    v_mul_u32_u24 v17, 1280, v17
    v_and_b32 v18, 1, v0
    v_lshl_add_u32 v17, v18, 3, v17
    v_bfe_u32 v18, v0, 1, 1
    s_and_b32 s5, s13, 2
    s_mul_i32 s6, s18, 10
    s_lshl_b32 s21, s5, 1
    s_add_u32 s6, s6, s21
    v_lshrrev_b32 v59, 4, v0
    v_lshlrev_b32 v59, 4, v59
    s_lshl_b32 s21, s7, 7
    s_add_u32 s21, s21, 151552
    v_add_u32 v59, s21, v59
    s_add_u32 s21, s6, 0
    v_add_u32 v20, s21, v18
    v_xor_b32 v21, v20, v16
    v_and_b32 v21, 15, v21
    v_and_b32 v20, 0x70, v20
    v_or_b32 v20, v20, v21
    v_lshl_add_u32 v56, v20, 4, v17
    s_add_u32 s21, s6, 2
    v_add_u32 v20, s21, v18
    v_xor_b32 v21, v20, v16
    v_and_b32 v21, 15, v21
    v_and_b32 v20, 0x70, v20
    v_or_b32 v20, v20, v21
    v_lshl_add_u32 v57, v20, 4, v17
    s_add_u32 s21, s6, 4
    v_add_u32 v20, s21, v18
    v_xor_b32 v21, v20, v16
    v_and_b32 v21, 15, v21
    v_and_b32 v20, 0x70, v20
    v_or_b32 v20, v20, v21
    v_lshl_add_u32 v58, v20, 4, v17
    s_lshl_b32 s21, s18, 6
    s_lshl_b32 s22, s16, 1
    s_add_u32 s21, s21, s22
    s_add_u32 s21, s21, s7
    s_mul_i32 s21, s21, 5120
    s_lshl_b32 s22, s5, 10
    s_add_u32 s12, s21, s22
    v_lshlrev_b32 v60, 4, v0
    s_cmp_ge_u32 s23, 20
    s_cselect_b32 s21, 0, 0x358637bd
    v_mov_b32 v128, s21
    v_mov_b32 v129, s21
    v_mov_b32 v130, s21
    v_mov_b32 v131, s21
    v_mov_b32 v132, s21
    v_mov_b32 v133, s21
    v_mov_b32 v134, s21
    v_mov_b32 v135, s21
    v_mov_b32 v136, s21
    v_mov_b32 v137, s21
    v_mov_b32 v138, s21
    v_mov_b32 v139, s21
    v_mov_b32 v140, s21
    v_mov_b32 v141, s21
    v_mov_b32 v142, s21
    v_mov_b32 v143, s21
    v_mov_b32 v144, s21
    v_mov_b32 v145, s21
    v_mov_b32 v146, s21
    v_mov_b32 v147, s21
    v_mov_b32 v148, s21
    v_mov_b32 v149, s21
    v_mov_b32 v150, s21
    v_mov_b32 v151, s21
    v_mov_b32 v152, s21
    v_mov_b32 v153, s21
    v_mov_b32 v154, s21
    v_mov_b32 v155, s21
    v_mov_b32 v156, s21
    v_mov_b32 v157, s21
    v_mov_b32 v158, s21
    v_mov_b32 v159, s21
    v_mov_b32 v160, s21
    v_mov_b32 v161, s21
    v_mov_b32 v162, s21
    v_mov_b32 v163, s21
    v_mov_b32 v164, s21
    v_mov_b32 v165, s21
    v_mov_b32 v166, s21
    v_mov_b32 v167, s21
    v_mov_b32 v168, s21
    v_mov_b32 v169, s21
    v_mov_b32 v170, s21
    v_mov_b32 v171, s21
    v_mov_b32 v172, s21
    v_mov_b32 v173, s21
    v_mov_b32 v174, s21
    v_mov_b32 v175, s21
    v_mov_b32 v176, s21
    v_mov_b32 v177, s21
    v_mov_b32 v178, s21
    v_mov_b32 v179, s21
    v_mov_b32 v180, s21
    v_mov_b32 v181, s21
    v_mov_b32 v182, s21
    v_mov_b32 v183, s21
    v_mov_b32 v184, s21
    v_mov_b32 v185, s21
    v_mov_b32 v186, s21
    v_mov_b32 v187, s21
    v_mov_b32 v188, s21
    v_mov_b32 v189, s21
    v_mov_b32 v190, s21
    v_mov_b32 v191, s21
    s_cmp_ge_u32 s20, 2
    s_cbranch_scc1 L_npt
    s_mul_i32 s21, s11, 54
    s_lshl_b32 s22, s10, 1
    s_add_u32 s21, s21, s22
    s_add_u32 s21, s21, s20
    s_mul_i32 s21, s21, 5120
    s_add_u32 s21, s21, 10487808
    v_lshlrev_b32 v16, 7, v0
    v_add_u32 v16, s21, v16
    s_lshl_b32 s21, s18, 5
    s_add_u32 s21, s21, s16
    s_lshl_b32 s21, s21, 7
    s_lshl_b32 s22, s20, 15
    s_add_u32 s21, s21, s22
    s_add_u32 s21, s21, 17301504
    v_writelane_b32 v16, s21, 8
    s_mov_b64 exec, 0x1ff
    buffer_load_dword v253, v16, s[32:35], 0 offen sc1
    s_mov_b64 exec, -1
L_npt:
    s_waitcnt vmcnt(0)
    s_mov_b32 s49, 0x3f803f80
    v_mov_b32 v24, 0
    v_mov_b32 v25, 0
    v_mov_b32 v26, 0
    v_mov_b32 v27, 0
    v_mov_b32 v28, s49
    v_dot2_f32_bf16 v24, v64, v28, v24
    v_dot2_f32_bf16 v25, v64, v64, v25
    v_dot2_f32_bf16 v26, v84, v28, v26
    v_dot2_f32_bf16 v27, v84, v84, v27
    v_dot2_f32_bf16 v24, v65, v28, v24
    v_dot2_f32_bf16 v25, v65, v65, v25
    v_dot2_f32_bf16 v26, v85, v28, v26
    v_dot2_f32_bf16 v27, v85, v85, v27
    v_dot2_f32_bf16 v24, v66, v28, v24
    v_dot2_f32_bf16 v25, v66, v66, v25
    v_dot2_f32_bf16 v26, v86, v28, v26
    v_dot2_f32_bf16 v27, v86, v86, v27
    v_dot2_f32_bf16 v24, v67, v28, v24
    v_dot2_f32_bf16 v25, v67, v67, v25
    v_dot2_f32_bf16 v26, v87, v28, v26
    v_dot2_f32_bf16 v27, v87, v87, v27
    v_dot2_f32_bf16 v24, v68, v28, v24
    v_dot2_f32_bf16 v25, v68, v68, v25
    v_dot2_f32_bf16 v26, v88, v28, v26
    v_dot2_f32_bf16 v27, v88, v88, v27
    v_dot2_f32_bf16 v24, v69, v28, v24
    v_dot2_f32_bf16 v25, v69, v69, v25
    v_dot2_f32_bf16 v26, v89, v28, v26
    v_dot2_f32_bf16 v27, v89, v89, v27
    v_dot2_f32_bf16 v24, v70, v28, v24
    v_dot2_f32_bf16 v25, v70, v70, v25
    v_dot2_f32_bf16 v26, v90, v28, v26
    v_dot2_f32_bf16 v27, v90, v90, v27
    v_dot2_f32_bf16 v24, v71, v28, v24
    v_dot2_f32_bf16 v25, v71, v71, v25
    v_dot2_f32_bf16 v26, v91, v28, v26
    v_dot2_f32_bf16 v27, v91, v91, v27
    v_dot2_f32_bf16 v24, v72, v28, v24
    v_dot2_f32_bf16 v25, v72, v72, v25
    v_dot2_f32_bf16 v26, v92, v28, v26
    v_dot2_f32_bf16 v27, v92, v92, v27
    v_dot2_f32_bf16 v24, v73, v28, v24
    v_dot2_f32_bf16 v25, v73, v73, v25
    v_dot2_f32_bf16 v26, v93, v28, v26
    v_dot2_f32_bf16 v27, v93, v93, v27
    v_dot2_f32_bf16 v24, v74, v28, v24
    v_dot2_f32_bf16 v25, v74, v74, v25
    v_dot2_f32_bf16 v26, v94, v28, v26
    v_dot2_f32_bf16 v27, v94, v94, v27
    v_dot2_f32_bf16 v24, v75, v28, v24
    v_dot2_f32_bf16 v25, v75, v75, v25
    v_dot2_f32_bf16 v26, v95, v28, v26
    v_dot2_f32_bf16 v27, v95, v95, v27
    v_dot2_f32_bf16 v24, v76, v28, v24
    v_dot2_f32_bf16 v25, v76, v76, v25
    v_dot2_f32_bf16 v26, v96, v28, v26
    v_dot2_f32_bf16 v27, v96, v96, v27
    v_dot2_f32_bf16 v24, v77, v28, v24
    v_dot2_f32_bf16 v25, v77, v77, v25
    v_dot2_f32_bf16 v26, v97, v28, v26
    v_dot2_f32_bf16 v27, v97, v97, v27
    v_dot2_f32_bf16 v24, v78, v28, v24
    v_dot2_f32_bf16 v25, v78, v78, v25
    v_dot2_f32_bf16 v26, v98, v28, v26
    v_dot2_f32_bf16 v27, v98, v98, v27
    v_dot2_f32_bf16 v24, v79, v28, v24
    v_dot2_f32_bf16 v25, v79, v79, v25
    v_dot2_f32_bf16 v26, v99, v28, v26
    v_dot2_f32_bf16 v27, v99, v99, v27
    v_dot2_f32_bf16 v24, v80, v28, v24
    v_dot2_f32_bf16 v25, v80, v80, v25
    v_dot2_f32_bf16 v26, v100, v28, v26
    v_dot2_f32_bf16 v27, v100, v100, v27
    v_dot2_f32_bf16 v24, v81, v28, v24
    v_dot2_f32_bf16 v25, v81, v81, v25
    v_dot2_f32_bf16 v26, v101, v28, v26
    v_dot2_f32_bf16 v27, v101, v101, v27
    v_dot2_f32_bf16 v24, v82, v28, v24
    v_dot2_f32_bf16 v25, v82, v82, v25
    v_dot2_f32_bf16 v26, v102, v28, v26
    v_dot2_f32_bf16 v27, v102, v102, v27
    v_dot2_f32_bf16 v24, v83, v28, v24
    v_dot2_f32_bf16 v25, v83, v83, v25
    v_dot2_f32_bf16 v26, v103, v28, v26
    v_dot2_f32_bf16 v27, v103, v103, v27
    s_nop 2
    v_add_f32_dpp v24, v24, v24 row_ror:8 row_mask:0xf bank_mask:0xf
    v_add_f32_dpp v25, v25, v25 row_ror:8 row_mask:0xf bank_mask:0xf
    v_add_f32_dpp v26, v26, v26 row_ror:8 row_mask:0xf bank_mask:0xf
    v_add_f32_dpp v27, v27, v27 row_ror:8 row_mask:0xf bank_mask:0xf
    v_add_f32_dpp v24, v24, v24 row_ror:4 row_mask:0xf bank_mask:0xf
    v_add_f32_dpp v25, v25, v25 row_ror:4 row_mask:0xf bank_mask:0xf
    v_add_f32_dpp v26, v26, v26 row_ror:4 row_mask:0xf bank_mask:0xf
    v_add_f32_dpp v27, v27, v27 row_ror:4 row_mask:0xf bank_mask:0xf
    v_add_f32_dpp v24, v24, v24 row_ror:2 row_mask:0xf bank_mask:0xf
    v_add_f32_dpp v25, v25, v25 row_ror:2 row_mask:0xf bank_mask:0xf
    v_add_f32_dpp v26, v26, v26 row_ror:2 row_mask:0xf bank_mask:0xf
    v_add_f32_dpp v27, v27, v27 row_ror:2 row_mask:0xf bank_mask:0xf
    v_add_f32_dpp v24, v24, v24 row_ror:1 row_mask:0xf bank_mask:0xf
    v_add_f32_dpp v25, v25, v25 row_ror:1 row_mask:0xf bank_mask:0xf
    v_add_f32_dpp v26, v26, v26 row_ror:1 row_mask:0xf bank_mask:0xf
    v_add_f32_dpp v27, v27, v27 row_ror:1 row_mask:0xf bank_mask:0xf
    s_mov_b32 s50, 0x3acccccd
    s_mov_b32 s51, 0x3727c5ac
    v_mul_f32 v30, s50, v24
    v_mul_f32 v31, s50, v25
    v_fma_f32 v31, -v30, v30, v31
    v_max_f32 v31, 0, v31
    v_add_f32 v32, s51, v31
    v_rsq_f32 v32, v32
    s_nop 0
    v_mul_f32 v31, v31, v32
    v_mul_f32 v34, -v30, v32
    v_fma_f32 v40, v31, v32, s51
    v_rsq_f32 v40, v40
    v_mul_f32 v30, s50, v26
    v_mul_f32 v31, s50, v27
    v_fma_f32 v31, -v30, v30, v31
    v_max_f32 v31, 0, v31
    v_add_f32 v36, s51, v31
    v_rsq_f32 v36, v36
    s_nop 0
    v_mul_f32 v31, v31, v36
    v_mul_f32 v38, -v30, v36
    v_fma_f32 v41, v31, v36, s51
    v_rsq_f32 v41, v41
    v_lshrrev_b32 v20, 4, v0
    v_add_u32 v23, s52, v20
    v_add_u32 v20, s8, v23
    v_xor_b32 v21, v20, v0
    v_and_b32 v21, 15, v21
    v_mul_u32_u24 v22, 1280, v20
    v_lshl_add_u32 v42, v21, 4, v22
    v_lshlrev_b32 v22, 2, v20
    v_add_u32 v22, 151552, v22
    ds_write_b32 v22, v40
    v_add_u32 v20, s9, v23
    v_xor_b32 v21, v20, v0
    v_and_b32 v21, 15, v21
    v_mul_u32_u24 v22, 1280, v20
    v_lshl_add_u32 v43, v21, 4, v22
    v_lshlrev_b32 v22, 2, v20
    v_add_u32 v22, 151552, v22
    ds_write_b32 v22, v41
    s_mov_b32 s53, 0xffff0000
    v_lshlrev_b32 v44, 16, v64
    v_and_b32 v45, s53, v64
    v_lshlrev_b32 v46, 16, v65
    v_and_b32 v47, s53, v65
    v_lshlrev_b32 v48, 16, v66
    v_and_b32 v49, s53, v66
    v_lshlrev_b32 v50, 16, v67
    v_and_b32 v51, s53, v67
    v_pk_fma_f32 v[44:45], v[44:45], v[32:33], v[34:35] op_sel_hi:[1,0,0]
    v_pk_fma_f32 v[46:47], v[46:47], v[32:33], v[34:35] op_sel_hi:[1,0,0]
    v_pk_fma_f32 v[48:49], v[48:49], v[32:33], v[34:35] op_sel_hi:[1,0,0]
    v_pk_fma_f32 v[50:51], v[50:51], v[32:33], v[34:35] op_sel_hi:[1,0,0]
    v_cvt_pk_bf16_f32 v64, v44, v45
    v_cvt_pk_bf16_f32 v65, v46, v47
    v_cvt_pk_bf16_f32 v66, v48, v49
    v_cvt_pk_bf16_f32 v67, v50, v51
    ds_write_b128 v42, v[64:67] offset:0
    v_lshlrev_b32 v44, 16, v68
    v_and_b32 v45, s53, v68
    v_lshlrev_b32 v46, 16, v69
    v_and_b32 v47, s53, v69
    v_lshlrev_b32 v48, 16, v70
    v_and_b32 v49, s53, v70
    v_lshlrev_b32 v50, 16, v71
    v_and_b32 v51, s53, v71
    v_pk_fma_f32 v[44:45], v[44:45], v[32:33], v[34:35] op_sel_hi:[1,0,0]
    v_pk_fma_f32 v[46:47], v[46:47], v[32:33], v[34:35] op_sel_hi:[1,0,0]
    v_pk_fma_f32 v[48:49], v[48:49], v[32:33], v[34:35] op_sel_hi:[1,0,0]
    v_pk_fma_f32 v[50:51], v[50:51], v[32:33], v[34:35] op_sel_hi:[1,0,0]
    v_cvt_pk_bf16_f32 v68, v44, v45
    v_cvt_pk_bf16_f32 v69, v46, v47
    v_cvt_pk_bf16_f32 v70, v48, v49
    v_cvt_pk_bf16_f32 v71, v50, v51
    ds_write_b128 v42, v[68:71] offset:256
    v_lshlrev_b32 v44, 16, v72
    v_and_b32 v45, s53, v72
    v_lshlrev_b32 v46, 16, v73
    v_and_b32 v47, s53, v73
    v_lshlrev_b32 v48, 16, v74
    v_and_b32 v49, s53, v74
    v_lshlrev_b32 v50, 16, v75
    v_and_b32 v51, s53, v75
    v_pk_fma_f32 v[44:45], v[44:45], v[32:33], v[34:35] op_sel_hi:[1,0,0]
    v_pk_fma_f32 v[46:47], v[46:47], v[32:33], v[34:35] op_sel_hi:[1,0,0]
    v_pk_fma_f32 v[48:49], v[48:49], v[32:33], v[34:35] op_sel_hi:[1,0,0]
    v_pk_fma_f32 v[50:51], v[50:51], v[32:33], v[34:35] op_sel_hi:[1,0,0]
    v_cvt_pk_bf16_f32 v72, v44, v45
    v_cvt_pk_bf16_f32 v73, v46, v47
    v_cvt_pk_bf16_f32 v74, v48, v49
    v_cvt_pk_bf16_f32 v75, v50, v51
    ds_write_b128 v42, v[72:75] offset:512
    v_lshlrev_b32 v44, 16, v76
    v_and_b32 v45, s53, v76
    v_lshlrev_b32 v46, 16, v77
    v_and_b32 v47, s53, v77
    v_lshlrev_b32 v48, 16, v78
    v_and_b32 v49, s53, v78
    v_lshlrev_b32 v50, 16, v79
    v_and_b32 v51, s53, v79
    v_pk_fma_f32 v[44:45], v[44:45], v[32:33], v[34:35] op_sel_hi:[1,0,0]
    v_pk_fma_f32 v[46:47], v[46:47], v[32:33], v[34:35] op_sel_hi:[1,0,0]
    v_pk_fma_f32 v[48:49], v[48:49], v[32:33], v[34:35] op_sel_hi:[1,0,0]
    v_pk_fma_f32 v[50:51], v[50:51], v[32:33], v[34:35] op_sel_hi:[1,0,0]
    v_cvt_pk_bf16_f32 v76, v44, v45
    v_cvt_pk_bf16_f32 v77, v46, v47
    v_cvt_pk_bf16_f32 v78, v48, v49
    v_cvt_pk_bf16_f32 v79, v50, v51
    ds_write_b128 v42, v[76:79] offset:768
    v_lshlrev_b32 v44, 16, v80
    v_and_b32 v45, s53, v80
    v_lshlrev_b32 v46, 16, v81
    v_and_b32 v47, s53, v81
    v_lshlrev_b32 v48, 16, v82
    v_and_b32 v49, s53, v82
    v_lshlrev_b32 v50, 16, v83
    v_and_b32 v51, s53, v83
    v_pk_fma_f32 v[44:45], v[44:45], v[32:33], v[34:35] op_sel_hi:[1,0,0]
    v_pk_fma_f32 v[46:47], v[46:47], v[32:33], v[34:35] op_sel_hi:[1,0,0]
    v_pk_fma_f32 v[48:49], v[48:49], v[32:33], v[34:35] op_sel_hi:[1,0,0]
    v_pk_fma_f32 v[50:51], v[50:51], v[32:33], v[34:35] op_sel_hi:[1,0,0]
    v_cvt_pk_bf16_f32 v80, v44, v45
    v_cvt_pk_bf16_f32 v81, v46, v47
    v_cvt_pk_bf16_f32 v82, v48, v49
    v_cvt_pk_bf16_f32 v83, v50, v51
    ds_write_b128 v42, v[80:83] offset:1024
    v_lshlrev_b32 v44, 16, v84
    v_and_b32 v45, s53, v84
    v_lshlrev_b32 v46, 16, v85
    v_and_b32 v47, s53, v85
    v_lshlrev_b32 v48, 16, v86
    v_and_b32 v49, s53, v86
    v_lshlrev_b32 v50, 16, v87
    v_and_b32 v51, s53, v87
    v_pk_fma_f32 v[44:45], v[44:45], v[36:37], v[38:39] op_sel_hi:[1,0,0]
    v_pk_fma_f32 v[46:47], v[46:47], v[36:37], v[38:39] op_sel_hi:[1,0,0]
    v_pk_fma_f32 v[48:49], v[48:49], v[36:37], v[38:39] op_sel_hi:[1,0,0]
    v_pk_fma_f32 v[50:51], v[50:51], v[36:37], v[38:39] op_sel_hi:[1,0,0]
    v_cvt_pk_bf16_f32 v84, v44, v45
    v_cvt_pk_bf16_f32 v85, v46, v47
    v_cvt_pk_bf16_f32 v86, v48, v49
    v_cvt_pk_bf16_f32 v87, v50, v51
    ds_write_b128 v43, v[84:87] offset:0
    v_lshlrev_b32 v44, 16, v88
    v_and_b32 v45, s53, v88
    v_lshlrev_b32 v46, 16, v89
    v_and_b32 v47, s53, v89
    v_lshlrev_b32 v48, 16, v90
    v_and_b32 v49, s53, v90
    v_lshlrev_b32 v50, 16, v91
    v_and_b32 v51, s53, v91
    v_pk_fma_f32 v[44:45], v[44:45], v[36:37], v[38:39] op_sel_hi:[1,0,0]
    v_pk_fma_f32 v[46:47], v[46:47], v[36:37], v[38:39] op_sel_hi:[1,0,0]
    v_pk_fma_f32 v[48:49], v[48:49], v[36:37], v[38:39] op_sel_hi:[1,0,0]
    v_pk_fma_f32 v[50:51], v[50:51], v[36:37], v[38:39] op_sel_hi:[1,0,0]
    v_cvt_pk_bf16_f32 v88, v44, v45
    v_cvt_pk_bf16_f32 v89, v46, v47
    v_cvt_pk_bf16_f32 v90, v48, v49
    v_cvt_pk_bf16_f32 v91, v50, v51
    ds_write_b128 v43, v[88:91] offset:256
    v_lshlrev_b32 v44, 16, v92
    v_and_b32 v45, s53, v92
    v_lshlrev_b32 v46, 16, v93
    v_and_b32 v47, s53, v93
    v_lshlrev_b32 v48, 16, v94
    v_and_b32 v49, s53, v94
    v_lshlrev_b32 v50, 16, v95
    v_and_b32 v51, s53, v95
    v_pk_fma_f32 v[44:45], v[44:45], v[36:37], v[38:39] op_sel_hi:[1,0,0]
    v_pk_fma_f32 v[46:47], v[46:47], v[36:37], v[38:39] op_sel_hi:[1,0,0]
    v_pk_fma_f32 v[48:49], v[48:49], v[36:37], v[38:39] op_sel_hi:[1,0,0]
    v_pk_fma_f32 v[50:51], v[50:51], v[36:37], v[38:39] op_sel_hi:[1,0,0]
    v_cvt_pk_bf16_f32 v92, v44, v45
    v_cvt_pk_bf16_f32 v93, v46, v47
    v_cvt_pk_bf16_f32 v94, v48, v49
    v_cvt_pk_bf16_f32 v95, v50, v51
    ds_write_b128 v43, v[92:95] offset:512
    v_lshlrev_b32 v44, 16, v96
    v_and_b32 v45, s53, v96
    v_lshlrev_b32 v46, 16, v97
    v_and_b32 v47, s53, v97
    v_lshlrev_b32 v48, 16, v98
    v_and_b32 v49, s53, v98
    v_lshlrev_b32 v50, 16, v99
    v_and_b32 v51, s53, v99
    v_pk_fma_f32 v[44:45], v[44:45], v[36:37], v[38:39] op_sel_hi:[1,0,0]
    v_pk_fma_f32 v[46:47], v[46:47], v[36:37], v[38:39] op_sel_hi:[1,0,0]
    v_pk_fma_f32 v[48:49], v[48:49], v[36:37], v[38:39] op_sel_hi:[1,0,0]
    v_pk_fma_f32 v[50:51], v[50:51], v[36:37], v[38:39] op_sel_hi:[1,0,0]
    v_cvt_pk_bf16_f32 v96, v44, v45
    v_cvt_pk_bf16_f32 v97, v46, v47
    v_cvt_pk_bf16_f32 v98, v48, v49
    v_cvt_pk_bf16_f32 v99, v50, v51
    ds_write_b128 v43, v[96:99] offset:768
    v_lshlrev_b32 v44, 16, v100
    v_and_b32 v45, s53, v100
    v_lshlrev_b32 v46, 16, v101
    v_and_b32 v47, s53, v101
    v_lshlrev_b32 v48, 16, v102
    v_and_b32 v49, s53, v102
    v_lshlrev_b32 v50, 16, v103
    v_and_b32 v51, s53, v103
    v_pk_fma_f32 v[44:45], v[44:45], v[36:37], v[38:39] op_sel_hi:[1,0,0]
    v_pk_fma_f32 v[46:47], v[46:47], v[36:37], v[38:39] op_sel_hi:[1,0,0]
    v_pk_fma_f32 v[48:49], v[48:49], v[36:37], v[38:39] op_sel_hi:[1,0,0]
    v_pk_fma_f32 v[50:51], v[50:51], v[36:37], v[38:39] op_sel_hi:[1,0,0]
    v_cvt_pk_bf16_f32 v100, v44, v45
    v_cvt_pk_bf16_f32 v101, v46, v47
    v_cvt_pk_bf16_f32 v102, v48, v49
    v_cvt_pk_bf16_f32 v103, v50, v51
    ds_write_b128 v43, v[100:103] offset:1024
    s_waitcnt lgkmcnt(0)
    s_barrier
    ds_read_b128 v[48:51], v59
    ds_read_b128 v[52:55], v59 offset:64
    ds_read_b64_tr_b16 v[24:25], v56
    ds_read_b64_tr_b16 v[26:27], v56 offset:20480
    ds_read_b64_tr_b16 v[28:29], v57
    ds_read_b64_tr_b16 v[30:31], v57 offset:20480
    ds_read_b64_tr_b16 v[32:33], v58
    ds_read_b64_tr_b16 v[34:35], v58 offset:20480
    buffer_load_dword v251, v252, s[56:59], 0 offen sc1
    s_waitcnt lgkmcnt(0)
    ds_read_b64_tr_b16 v[96:97], v4 offset:0
    ds_read_b64_tr_b16 v[98:99], v4 offset:512
    ds_read_b64_tr_b16 v[100:101], v5 offset:0
    ds_read_b64_tr_b16 v[102:103], v5 offset:512
    ds_read_b64_tr_b16 v[104:105], v6 offset:0
    ds_read_b64_tr_b16 v[106:107], v6 offset:512
    ds_read_b64_tr_b16 v[108:109], v7 offset:0
    ds_read_b64_tr_b16 v[110:111], v7 offset:512
    ds_read_b128 v[64:67], v12 offset:0
    ds_read_b128 v[68:71], v12 offset:20480
    ds_read_b128 v[72:75], v12 offset:40960
    ds_read_b128 v[76:79], v12 offset:61440
    v_lshlrev_b32 v36, 16, v24
    v_and_b32 v37, s53, v24
    v_lshlrev_b32 v38, 16, v25
    v_and_b32 v39, s53, v25
    v_lshlrev_b32 v40, 16, v26
    v_and_b32 v41, s53, v26
    v_lshlrev_b32 v42, 16, v27
    v_and_b32 v43, s53, v27
    v_pk_mul_f32 v[36:37], v[36:37], v[48:49]
    v_pk_mul_f32 v[38:39], v[38:39], v[50:51]
    v_pk_mul_f32 v[40:41], v[40:41], v[52:53]
    v_pk_mul_f32 v[42:43], v[42:43], v[54:55]
    v_cvt_pk_bf16_f32 v24, v36, v37
    v_cvt_pk_bf16_f32 v25, v38, v39
    v_cvt_pk_bf16_f32 v26, v40, v41
    v_cvt_pk_bf16_f32 v27, v42, v43
    buffer_store_dwordx4 v[24:27], v60, s[32:35], s12 offen offset:0 sc1
    v_lshlrev_b32 v36, 16, v28
    v_and_b32 v37, s53, v28
    v_lshlrev_b32 v38, 16, v29
    v_and_b32 v39, s53, v29
    v_lshlrev_b32 v40, 16, v30
    v_and_b32 v41, s53, v30
    v_lshlrev_b32 v42, 16, v31
    v_and_b32 v43, s53, v31
    v_pk_mul_f32 v[36:37], v[36:37], v[48:49]
    v_pk_mul_f32 v[38:39], v[38:39], v[50:51]
    v_pk_mul_f32 v[40:41], v[40:41], v[52:53]
    v_pk_mul_f32 v[42:43], v[42:43], v[54:55]
    v_cvt_pk_bf16_f32 v28, v36, v37
    v_cvt_pk_bf16_f32 v29, v38, v39
    v_cvt_pk_bf16_f32 v30, v40, v41
    v_cvt_pk_bf16_f32 v31, v42, v43
    buffer_store_dwordx4 v[28:31], v60, s[32:35], s12 offen offset:1024 sc1
    v_lshlrev_b32 v36, 16, v32
    v_and_b32 v37, s53, v32
    v_lshlrev_b32 v38, 16, v33
    v_and_b32 v39, s53, v33
    v_lshlrev_b32 v40, 16, v34
    v_and_b32 v41, s53, v34
    v_lshlrev_b32 v42, 16, v35
    v_and_b32 v43, s53, v35
    v_pk_mul_f32 v[36:37], v[36:37], v[48:49]
    v_pk_mul_f32 v[38:39], v[38:39], v[50:51]
    v_pk_mul_f32 v[40:41], v[40:41], v[52:53]
    v_pk_mul_f32 v[42:43], v[42:43], v[54:55]
    v_cvt_pk_bf16_f32 v32, v36, v37
    v_cvt_pk_bf16_f32 v33, v38, v39
    v_cvt_pk_bf16_f32 v34, v40, v41
    v_cvt_pk_bf16_f32 v35, v42, v43
    buffer_store_dwordx4 v[32:35], v60, s[32:35], s12 offen offset:2048 sc1
    s_lshl_b32 s21, s18, 5
    s_add_u32 s21, s21, s16
    s_lshl_b32 s21, s21, 5
    s_add_u32 s21, s21, s13
    s_lshl_b32 s21, s21, 2
    s_add_u32 s12, s21, 17301504
    s_cmp_lt_u32 s23, 10
    s_cbranch_scc1 LA_q
    s_waitcnt lgkmcnt(0)
    s_barrier
    ds_read_b64_tr_b16 v[112:113], v4 offset:16384
    v_mfma_f32_16x16x32_bf16 v[128:131], v[64:67], v[96:99], v[128:131]
    ds_read_b64_tr_b16 v[114:115], v4 offset:16896
    v_mfma_f32_16x16x32_bf16 v[132:135], v[64:67], v[100:103], v[132:135]
    ds_read_b64_tr_b16 v[116:117], v5 offset:16384
    v_mfma_f32_16x16x32_bf16 v[136:139], v[64:67], v[104:107], v[136:139]
    ds_read_b64_tr_b16 v[118:119], v5 offset:16896
    v_mfma_f32_16x16x32_bf16 v[140:143], v[64:67], v[108:111], v[140:143]
    ds_read_b64_tr_b16 v[120:121], v6 offset:16384
    v_mfma_f32_16x16x32_bf16 v[144:147], v[68:71], v[96:99], v[144:147]
    ds_read_b64_tr_b16 v[122:123], v6 offset:16896
    v_mfma_f32_16x16x32_bf16 v[148:151], v[68:71], v[100:103], v[148:151]
    ds_read_b64_tr_b16 v[124:125], v7 offset:16384
    v_mfma_f32_16x16x32_bf16 v[152:155], v[68:71], v[104:107], v[152:155]
    ds_read_b64_tr_b16 v[126:127], v7 offset:16896
    v_mfma_f32_16x16x32_bf16 v[156:159], v[68:71], v[108:111], v[156:159]
    ds_read_b128 v[80:83], v13 offset:0
    v_mfma_f32_16x16x32_bf16 v[160:163], v[72:75], v[96:99], v[160:163]
    ds_read_b128 v[84:87], v13 offset:20480
    v_mfma_f32_16x16x32_bf16 v[164:167], v[72:75], v[100:103], v[164:167]
    ds_read_b128 v[88:91], v13 offset:40960
    v_mfma_f32_16x16x32_bf16 v[168:171], v[72:75], v[104:107], v[168:171]
    ds_read_b128 v[92:95], v13 offset:61440
    v_mfma_f32_16x16x32_bf16 v[172:175], v[72:75], v[108:111], v[172:175]
    v_mfma_f32_16x16x32_bf16 v[176:179], v[76:79], v[96:99], v[176:179]
    v_mfma_f32_16x16x32_bf16 v[180:183], v[76:79], v[100:103], v[180:183]
    v_mfma_f32_16x16x32_bf16 v[184:187], v[76:79], v[104:107], v[184:187]
    v_mfma_f32_16x16x32_bf16 v[188:191], v[76:79], v[108:111], v[188:191]
    s_waitcnt lgkmcnt(0)
    s_barrier
    ds_read_b64_tr_b16 v[96:97], v4 offset:32768
    v_mfma_f32_16x16x32_bf16 v[128:131], v[80:83], v[112:115], v[128:131]
    ds_read_b64_tr_b16 v[98:99], v4 offset:33280
    v_mfma_f32_16x16x32_bf16 v[132:135], v[80:83], v[116:119], v[132:135]
    ds_read_b64_tr_b16 v[100:101], v5 offset:32768
    v_mfma_f32_16x16x32_bf16 v[136:139], v[80:83], v[120:123], v[136:139]
    ds_read_b64_tr_b16 v[102:103], v5 offset:33280
    v_mfma_f32_16x16x32_bf16 v[140:143], v[80:83], v[124:127], v[140:143]
    ds_read_b64_tr_b16 v[104:105], v6 offset:32768
    v_mfma_f32_16x16x32_bf16 v[144:147], v[84:87], v[112:115], v[144:147]
    ds_read_b64_tr_b16 v[106:107], v6 offset:33280
    v_mfma_f32_16x16x32_bf16 v[148:151], v[84:87], v[116:119], v[148:151]
    ds_read_b64_tr_b16 v[108:109], v7 offset:32768
    v_mfma_f32_16x16x32_bf16 v[152:155], v[84:87], v[120:123], v[152:155]
    ds_read_b64_tr_b16 v[110:111], v7 offset:33280
    v_mfma_f32_16x16x32_bf16 v[156:159], v[84:87], v[124:127], v[156:159]
    ds_read_b128 v[64:67], v14 offset:0
    v_mfma_f32_16x16x32_bf16 v[160:163], v[88:91], v[112:115], v[160:163]
    ds_read_b128 v[68:71], v14 offset:20480
    v_mfma_f32_16x16x32_bf16 v[164:167], v[88:91], v[116:119], v[164:167]
    ds_read_b128 v[72:75], v14 offset:40960
    v_mfma_f32_16x16x32_bf16 v[168:171], v[88:91], v[120:123], v[168:171]
    ds_read_b128 v[76:79], v14 offset:61440
    v_mfma_f32_16x16x32_bf16 v[172:175], v[88:91], v[124:127], v[172:175]
    v_mfma_f32_16x16x32_bf16 v[176:179], v[92:95], v[112:115], v[176:179]
    v_mfma_f32_16x16x32_bf16 v[180:183], v[92:95], v[116:119], v[180:183]
    v_mfma_f32_16x16x32_bf16 v[184:187], v[92:95], v[120:123], v[184:187]
    v_mfma_f32_16x16x32_bf16 v[188:191], v[92:95], v[124:127], v[188:191]
    s_waitcnt lgkmcnt(0)
    s_barrier
    ds_read_b64_tr_b16 v[112:113], v4 offset:49152
    v_mfma_f32_16x16x32_bf16 v[128:131], v[64:67], v[96:99], v[128:131]
    ds_read_b64_tr_b16 v[114:115], v4 offset:49664
    v_mfma_f32_16x16x32_bf16 v[132:135], v[64:67], v[100:103], v[132:135]
    ds_read_b64_tr_b16 v[116:117], v5 offset:49152
    v_mfma_f32_16x16x32_bf16 v[136:139], v[64:67], v[104:107], v[136:139]
    ds_read_b64_tr_b16 v[118:119], v5 offset:49664
    v_mfma_f32_16x16x32_bf16 v[140:143], v[64:67], v[108:111], v[140:143]
    ds_read_b64_tr_b16 v[120:121], v6 offset:49152
    v_mfma_f32_16x16x32_bf16 v[144:147], v[68:71], v[96:99], v[144:147]
    ds_read_b64_tr_b16 v[122:123], v6 offset:49664
    v_mfma_f32_16x16x32_bf16 v[148:151], v[68:71], v[100:103], v[148:151]
    ds_read_b64_tr_b16 v[124:125], v7 offset:49152
    v_mfma_f32_16x16x32_bf16 v[152:155], v[68:71], v[104:107], v[152:155]
    ds_read_b64_tr_b16 v[126:127], v7 offset:49664
    v_mfma_f32_16x16x32_bf16 v[156:159], v[68:71], v[108:111], v[156:159]
    ds_read_b128 v[80:83], v15 offset:0
    v_mfma_f32_16x16x32_bf16 v[160:163], v[72:75], v[96:99], v[160:163]
    ds_read_b128 v[84:87], v15 offset:20480
    v_mfma_f32_16x16x32_bf16 v[164:167], v[72:75], v[100:103], v[164:167]
    ds_read_b128 v[88:91], v15 offset:40960
    v_mfma_f32_16x16x32_bf16 v[168:171], v[72:75], v[104:107], v[168:171]
    ds_read_b128 v[92:95], v15 offset:61440
    v_mfma_f32_16x16x32_bf16 v[172:175], v[72:75], v[108:111], v[172:175]
    v_mfma_f32_16x16x32_bf16 v[176:179], v[76:79], v[96:99], v[176:179]
    v_mfma_f32_16x16x32_bf16 v[180:183], v[76:79], v[100:103], v[180:183]
    v_mfma_f32_16x16x32_bf16 v[184:187], v[76:79], v[104:107], v[184:187]
    v_mfma_f32_16x16x32_bf16 v[188:191], v[76:79], v[108:111], v[188:191]
    s_waitcnt lgkmcnt(0)
    s_barrier
    v_add_u32 v12, s40, v12
    ds_read_b64_tr_b16 v[96:97], v8 offset:0
    v_mfma_f32_16x16x32_bf16 v[128:131], v[80:83], v[112:115], v[128:131]
    ds_read_b64_tr_b16 v[98:99], v8 offset:512
    v_mfma_f32_16x16x32_bf16 v[132:135], v[80:83], v[116:119], v[132:135]
    ds_read_b64_tr_b16 v[100:101], v9 offset:0
    v_mfma_f32_16x16x32_bf16 v[136:139], v[80:83], v[120:123], v[136:139]
    ds_read_b64_tr_b16 v[102:103], v9 offset:512
    v_mfma_f32_16x16x32_bf16 v[140:143], v[80:83], v[124:127], v[140:143]
    ds_read_b64_tr_b16 v[104:105], v10 offset:0
    v_mfma_f32_16x16x32_bf16 v[144:147], v[84:87], v[112:115], v[144:147]
    ds_read_b64_tr_b16 v[106:107], v10 offset:512
    v_mfma_f32_16x16x32_bf16 v[148:151], v[84:87], v[116:119], v[148:151]
    ds_read_b64_tr_b16 v[108:109], v11 offset:0
    v_mfma_f32_16x16x32_bf16 v[152:155], v[84:87], v[120:123], v[152:155]
    ds_read_b64_tr_b16 v[110:111], v11 offset:512
    v_mfma_f32_16x16x32_bf16 v[156:159], v[84:87], v[124:127], v[156:159]
    ds_read_b128 v[64:67], v12 offset:0
    v_mfma_f32_16x16x32_bf16 v[160:163], v[88:91], v[112:115], v[160:163]
    ds_read_b128 v[68:71], v12 offset:20480
    v_mfma_f32_16x16x32_bf16 v[164:167], v[88:91], v[116:119], v[164:167]
    ds_read_b128 v[72:75], v12 offset:40960
    v_mfma_f32_16x16x32_bf16 v[168:171], v[88:91], v[120:123], v[168:171]
    ds_read_b128 v[76:79], v12 offset:61440
    v_mfma_f32_16x16x32_bf16 v[172:175], v[88:91], v[124:127], v[172:175]
    v_mfma_f32_16x16x32_bf16 v[176:179], v[92:95], v[112:115], v[176:179]
    v_mfma_f32_16x16x32_bf16 v[180:183], v[92:95], v[116:119], v[180:183]
    v_mfma_f32_16x16x32_bf16 v[184:187], v[92:95], v[120:123], v[184:187]
    v_mfma_f32_16x16x32_bf16 v[188:191], v[92:95], v[124:127], v[188:191]
    s_waitcnt lgkmcnt(0)
    s_barrier
    v_add_u32 v13, s40, v13
    ds_read_b64_tr_b16 v[112:113], v4 offset:0
    v_mfma_f32_16x16x32_bf16 v[128:131], v[64:67], v[96:99], v[128:131]
    ds_read_b64_tr_b16 v[114:115], v4 offset:512
    v_mfma_f32_16x16x32_bf16 v[132:135], v[64:67], v[100:103], v[132:135]
    ds_read_b64_tr_b16 v[116:117], v5 offset:0
    v_mfma_f32_16x16x32_bf16 v[136:139], v[64:67], v[104:107], v[136:139]
    ds_read_b64_tr_b16 v[118:119], v5 offset:512
    v_mfma_f32_16x16x32_bf16 v[140:143], v[64:67], v[108:111], v[140:143]
    ds_read_b64_tr_b16 v[120:121], v6 offset:0
    v_mfma_f32_16x16x32_bf16 v[144:147], v[68:71], v[96:99], v[144:147]
    ds_read_b64_tr_b16 v[122:123], v6 offset:512
    v_mfma_f32_16x16x32_bf16 v[148:151], v[68:71], v[100:103], v[148:151]
    ds_read_b64_tr_b16 v[124:125], v7 offset:0
    v_mfma_f32_16x16x32_bf16 v[152:155], v[68:71], v[104:107], v[152:155]
    ds_read_b64_tr_b16 v[126:127], v7 offset:512
    v_mfma_f32_16x16x32_bf16 v[156:159], v[68:71], v[108:111], v[156:159]
    ds_read_b128 v[80:83], v13 offset:0
    v_mfma_f32_16x16x32_bf16 v[160:163], v[72:75], v[96:99], v[160:163]
    ds_read_b128 v[84:87], v13 offset:20480
    v_mfma_f32_16x16x32_bf16 v[164:167], v[72:75], v[100:103], v[164:167]
    ds_read_b128 v[88:91], v13 offset:40960
    v_mfma_f32_16x16x32_bf16 v[168:171], v[72:75], v[104:107], v[168:171]
    ds_read_b128 v[92:95], v13 offset:61440
    v_mfma_f32_16x16x32_bf16 v[172:175], v[72:75], v[108:111], v[172:175]
    v_mfma_f32_16x16x32_bf16 v[176:179], v[76:79], v[96:99], v[176:179]
    v_mfma_f32_16x16x32_bf16 v[180:183], v[76:79], v[100:103], v[180:183]
    v_mfma_f32_16x16x32_bf16 v[184:187], v[76:79], v[104:107], v[184:187]
    v_mfma_f32_16x16x32_bf16 v[188:191], v[76:79], v[108:111], v[188:191]
    s_waitcnt lgkmcnt(0)
    s_barrier
    v_add_u32 v14, s40, v14
    ds_read_b64_tr_b16 v[96:97], v4 offset:16384
    v_mfma_f32_16x16x32_bf16 v[128:131], v[80:83], v[112:115], v[128:131]
    ds_read_b64_tr_b16 v[98:99], v4 offset:16896
    v_mfma_f32_16x16x32_bf16 v[132:135], v[80:83], v[116:119], v[132:135]
    ds_read_b64_tr_b16 v[100:101], v5 offset:16384
    v_mfma_f32_16x16x32_bf16 v[136:139], v[80:83], v[120:123], v[136:139]
    ds_read_b64_tr_b16 v[102:103], v5 offset:16896
    v_mfma_f32_16x16x32_bf16 v[140:143], v[80:83], v[124:127], v[140:143]
    ds_read_b64_tr_b16 v[104:105], v6 offset:16384
    v_mfma_f32_16x16x32_bf16 v[144:147], v[84:87], v[112:115], v[144:147]
    ds_read_b64_tr_b16 v[106:107], v6 offset:16896
    v_mfma_f32_16x16x32_bf16 v[148:151], v[84:87], v[116:119], v[148:151]
    ds_read_b64_tr_b16 v[108:109], v7 offset:16384
    v_mfma_f32_16x16x32_bf16 v[152:155], v[84:87], v[120:123], v[152:155]
    ds_read_b64_tr_b16 v[110:111], v7 offset:16896
    v_mfma_f32_16x16x32_bf16 v[156:159], v[84:87], v[124:127], v[156:159]
    ds_read_b128 v[64:67], v14 offset:0
    v_mfma_f32_16x16x32_bf16 v[160:163], v[88:91], v[112:115], v[160:163]
    ds_read_b128 v[68:71], v14 offset:20480
    v_mfma_f32_16x16x32_bf16 v[164:167], v[88:91], v[116:119], v[164:167]
    ds_read_b128 v[72:75], v14 offset:40960
    v_mfma_f32_16x16x32_bf16 v[168:171], v[88:91], v[120:123], v[168:171]
    ds_read_b128 v[76:79], v14 offset:61440
    v_mfma_f32_16x16x32_bf16 v[172:175], v[88:91], v[124:127], v[172:175]
    v_mfma_f32_16x16x32_bf16 v[176:179], v[92:95], v[112:115], v[176:179]
    v_mfma_f32_16x16x32_bf16 v[180:183], v[92:95], v[116:119], v[180:183]
    v_mfma_f32_16x16x32_bf16 v[184:187], v[92:95], v[120:123], v[184:187]
    v_mfma_f32_16x16x32_bf16 v[188:191], v[92:95], v[124:127], v[188:191]
    s_waitcnt lgkmcnt(0)
    s_barrier
    v_add_u32 v15, s40, v15
    ds_read_b64_tr_b16 v[112:113], v4 offset:32768
    v_mfma_f32_16x16x32_bf16 v[128:131], v[64:67], v[96:99], v[128:131]
    ds_read_b64_tr_b16 v[114:115], v4 offset:33280
    v_mfma_f32_16x16x32_bf16 v[132:135], v[64:67], v[100:103], v[132:135]
    ds_read_b64_tr_b16 v[116:117], v5 offset:32768
    v_mfma_f32_16x16x32_bf16 v[136:139], v[64:67], v[104:107], v[136:139]
    ds_read_b64_tr_b16 v[118:119], v5 offset:33280
    v_mfma_f32_16x16x32_bf16 v[140:143], v[64:67], v[108:111], v[140:143]
    ds_read_b64_tr_b16 v[120:121], v6 offset:32768
    v_mfma_f32_16x16x32_bf16 v[144:147], v[68:71], v[96:99], v[144:147]
    ds_read_b64_tr_b16 v[122:123], v6 offset:33280
    v_mfma_f32_16x16x32_bf16 v[148:151], v[68:71], v[100:103], v[148:151]
    ds_read_b64_tr_b16 v[124:125], v7 offset:32768
    v_mfma_f32_16x16x32_bf16 v[152:155], v[68:71], v[104:107], v[152:155]
    ds_read_b64_tr_b16 v[126:127], v7 offset:33280
    v_mfma_f32_16x16x32_bf16 v[156:159], v[68:71], v[108:111], v[156:159]
    ds_read_b128 v[80:83], v15 offset:0
    v_mfma_f32_16x16x32_bf16 v[160:163], v[72:75], v[96:99], v[160:163]
    ds_read_b128 v[84:87], v15 offset:20480
    v_mfma_f32_16x16x32_bf16 v[164:167], v[72:75], v[100:103], v[164:167]
    ds_read_b128 v[88:91], v15 offset:40960
    v_mfma_f32_16x16x32_bf16 v[168:171], v[72:75], v[104:107], v[168:171]
    ds_read_b128 v[92:95], v15 offset:61440
    v_mfma_f32_16x16x32_bf16 v[172:175], v[72:75], v[108:111], v[172:175]
    v_mfma_f32_16x16x32_bf16 v[176:179], v[76:79], v[96:99], v[176:179]
    v_mfma_f32_16x16x32_bf16 v[180:183], v[76:79], v[100:103], v[180:183]
    v_mfma_f32_16x16x32_bf16 v[184:187], v[76:79], v[104:107], v[184:187]
    v_mfma_f32_16x16x32_bf16 v[188:191], v[76:79], v[108:111], v[188:191]
    s_waitcnt lgkmcnt(0)
    s_barrier
    v_add_u32 v12, s41, v12
    ds_read_b64_tr_b16 v[96:97], v4 offset:49152
    v_mfma_f32_16x16x32_bf16 v[128:131], v[80:83], v[112:115], v[128:131]
    ds_read_b64_tr_b16 v[98:99], v4 offset:49664
    v_mfma_f32_16x16x32_bf16 v[132:135], v[80:83], v[116:119], v[132:135]
    ds_read_b64_tr_b16 v[100:101], v5 offset:49152
    v_mfma_f32_16x16x32_bf16 v[136:139], v[80:83], v[120:123], v[136:139]
    ds_read_b64_tr_b16 v[102:103], v5 offset:49664
    v_mfma_f32_16x16x32_bf16 v[140:143], v[80:83], v[124:127], v[140:143]
    ds_read_b64_tr_b16 v[104:105], v6 offset:49152
    v_mfma_f32_16x16x32_bf16 v[144:147], v[84:87], v[112:115], v[144:147]
    ds_read_b64_tr_b16 v[106:107], v6 offset:49664
    v_mfma_f32_16x16x32_bf16 v[148:151], v[84:87], v[116:119], v[148:151]
    ds_read_b64_tr_b16 v[108:109], v7 offset:49152
    v_mfma_f32_16x16x32_bf16 v[152:155], v[84:87], v[120:123], v[152:155]
    ds_read_b64_tr_b16 v[110:111], v7 offset:49664
    v_mfma_f32_16x16x32_bf16 v[156:159], v[84:87], v[124:127], v[156:159]
    ds_read_b128 v[64:67], v12 offset:0
    v_mfma_f32_16x16x32_bf16 v[160:163], v[88:91], v[112:115], v[160:163]
    ds_read_b128 v[68:71], v12 offset:20480
    v_mfma_f32_16x16x32_bf16 v[164:167], v[88:91], v[116:119], v[164:167]
    ds_read_b128 v[72:75], v12 offset:40960
    v_mfma_f32_16x16x32_bf16 v[168:171], v[88:91], v[120:123], v[168:171]
    ds_read_b128 v[76:79], v12 offset:61440
    v_mfma_f32_16x16x32_bf16 v[172:175], v[88:91], v[124:127], v[172:175]
    v_mfma_f32_16x16x32_bf16 v[176:179], v[92:95], v[112:115], v[176:179]
    v_mfma_f32_16x16x32_bf16 v[180:183], v[92:95], v[116:119], v[180:183]
    v_mfma_f32_16x16x32_bf16 v[184:187], v[92:95], v[120:123], v[184:187]
    v_mfma_f32_16x16x32_bf16 v[188:191], v[92:95], v[124:127], v[188:191]
    s_waitcnt lgkmcnt(0)
    s_barrier
    v_add_u32 v13, s41, v13
    ds_read_b64_tr_b16 v[112:113], v8 offset:0
    v_mfma_f32_16x16x32_bf16 v[128:131], v[64:67], v[96:99], v[128:131]
    ds_read_b64_tr_b16 v[114:115], v8 offset:512
    v_mfma_f32_16x16x32_bf16 v[132:135], v[64:67], v[100:103], v[132:135]
    ds_read_b64_tr_b16 v[116:117], v9 offset:0
    v_mfma_f32_16x16x32_bf16 v[136:139], v[64:67], v[104:107], v[136:139]
    ds_read_b64_tr_b16 v[118:119], v9 offset:512
    v_mfma_f32_16x16x32_bf16 v[140:143], v[64:67], v[108:111], v[140:143]
    ds_read_b64_tr_b16 v[120:121], v10 offset:0
    v_mfma_f32_16x16x32_bf16 v[144:147], v[68:71], v[96:99], v[144:147]
    ds_read_b64_tr_b16 v[122:123], v10 offset:512
    v_mfma_f32_16x16x32_bf16 v[148:151], v[68:71], v[100:103], v[148:151]
    ds_read_b64_tr_b16 v[124:125], v11 offset:0
    v_mfma_f32_16x16x32_bf16 v[152:155], v[68:71], v[104:107], v[152:155]
    ds_read_b64_tr_b16 v[126:127], v11 offset:512
    v_mfma_f32_16x16x32_bf16 v[156:159], v[68:71], v[108:111], v[156:159]
    ds_read_b128 v[80:83], v13 offset:0
    v_mfma_f32_16x16x32_bf16 v[160:163], v[72:75], v[96:99], v[160:163]
    ds_read_b128 v[84:87], v13 offset:20480
    v_mfma_f32_16x16x32_bf16 v[164:167], v[72:75], v[100:103], v[164:167]
    ds_read_b128 v[88:91], v13 offset:40960
    v_mfma_f32_16x16x32_bf16 v[168:171], v[72:75], v[104:107], v[168:171]
    ds_read_b128 v[92:95], v13 offset:61440
    v_mfma_f32_16x16x32_bf16 v[172:175], v[72:75], v[108:111], v[172:175]
    v_mfma_f32_16x16x32_bf16 v[176:179], v[76:79], v[96:99], v[176:179]
    v_mfma_f32_16x16x32_bf16 v[180:183], v[76:79], v[100:103], v[180:183]
    v_mfma_f32_16x16x32_bf16 v[184:187], v[76:79], v[104:107], v[184:187]
    v_mfma_f32_16x16x32_bf16 v[188:191], v[76:79], v[108:111], v[188:191]
    s_waitcnt lgkmcnt(0)
    s_barrier
    v_add_u32 v14, s41, v14
    ds_read_b64_tr_b16 v[96:97], v4 offset:0
    v_mfma_f32_16x16x32_bf16 v[128:131], v[80:83], v[112:115], v[128:131]
    ds_read_b64_tr_b16 v[98:99], v4 offset:512
    v_mfma_f32_16x16x32_bf16 v[132:135], v[80:83], v[116:119], v[132:135]
    ds_read_b64_tr_b16 v[100:101], v5 offset:0
    v_mfma_f32_16x16x32_bf16 v[136:139], v[80:83], v[120:123], v[136:139]
    ds_read_b64_tr_b16 v[102:103], v5 offset:512
    v_mfma_f32_16x16x32_bf16 v[140:143], v[80:83], v[124:127], v[140:143]
    ds_read_b64_tr_b16 v[104:105], v6 offset:0
    v_mfma_f32_16x16x32_bf16 v[144:147], v[84:87], v[112:115], v[144:147]
    ds_read_b64_tr_b16 v[106:107], v6 offset:512
    v_mfma_f32_16x16x32_bf16 v[148:151], v[84:87], v[116:119], v[148:151]
    ds_read_b64_tr_b16 v[108:109], v7 offset:0
    v_mfma_f32_16x16x32_bf16 v[152:155], v[84:87], v[120:123], v[152:155]
    ds_read_b64_tr_b16 v[110:111], v7 offset:512
    v_mfma_f32_16x16x32_bf16 v[156:159], v[84:87], v[124:127], v[156:159]
    ds_read_b128 v[64:67], v14 offset:0
    v_mfma_f32_16x16x32_bf16 v[160:163], v[88:91], v[112:115], v[160:163]
    ds_read_b128 v[68:71], v14 offset:20480
    v_mfma_f32_16x16x32_bf16 v[164:167], v[88:91], v[116:119], v[164:167]
    ds_read_b128 v[72:75], v14 offset:40960
    v_mfma_f32_16x16x32_bf16 v[168:171], v[88:91], v[120:123], v[168:171]
    ds_read_b128 v[76:79], v14 offset:61440
    v_mfma_f32_16x16x32_bf16 v[172:175], v[88:91], v[124:127], v[172:175]
    v_mfma_f32_16x16x32_bf16 v[176:179], v[92:95], v[112:115], v[176:179]
    v_mfma_f32_16x16x32_bf16 v[180:183], v[92:95], v[116:119], v[180:183]
    v_mfma_f32_16x16x32_bf16 v[184:187], v[92:95], v[120:123], v[184:187]
    v_mfma_f32_16x16x32_bf16 v[188:191], v[92:95], v[124:127], v[188:191]
    s_waitcnt lgkmcnt(0)
    s_barrier
    v_add_u32 v15, s41, v15
    ds_read_b64_tr_b16 v[112:113], v4 offset:16384
    v_mfma_f32_16x16x32_bf16 v[128:131], v[64:67], v[96:99], v[128:131]
    ds_read_b64_tr_b16 v[114:115], v4 offset:16896
    v_mfma_f32_16x16x32_bf16 v[132:135], v[64:67], v[100:103], v[132:135]
    ds_read_b64_tr_b16 v[116:117], v5 offset:16384
    v_mfma_f32_16x16x32_bf16 v[136:139], v[64:67], v[104:107], v[136:139]
    ds_read_b64_tr_b16 v[118:119], v5 offset:16896
    v_mfma_f32_16x16x32_bf16 v[140:143], v[64:67], v[108:111], v[140:143]
    ds_read_b64_tr_b16 v[120:121], v6 offset:16384
    v_mfma_f32_16x16x32_bf16 v[144:147], v[68:71], v[96:99], v[144:147]
    ds_read_b64_tr_b16 v[122:123], v6 offset:16896
    v_mfma_f32_16x16x32_bf16 v[148:151], v[68:71], v[100:103], v[148:151]
    ds_read_b64_tr_b16 v[124:125], v7 offset:16384
    v_mfma_f32_16x16x32_bf16 v[152:155], v[68:71], v[104:107], v[152:155]
    ds_read_b64_tr_b16 v[126:127], v7 offset:16896
    v_mfma_f32_16x16x32_bf16 v[156:159], v[68:71], v[108:111], v[156:159]
    ds_read_b128 v[80:83], v15 offset:0
    v_mfma_f32_16x16x32_bf16 v[160:163], v[72:75], v[96:99], v[160:163]
    ds_read_b128 v[84:87], v15 offset:20480
    v_mfma_f32_16x16x32_bf16 v[164:167], v[72:75], v[100:103], v[164:167]
    ds_read_b128 v[88:91], v15 offset:40960
    v_mfma_f32_16x16x32_bf16 v[168:171], v[72:75], v[104:107], v[168:171]
    ds_read_b128 v[92:95], v15 offset:61440
    v_mfma_f32_16x16x32_bf16 v[172:175], v[72:75], v[108:111], v[172:175]
    v_mfma_f32_16x16x32_bf16 v[176:179], v[76:79], v[96:99], v[176:179]
    v_mfma_f32_16x16x32_bf16 v[180:183], v[76:79], v[100:103], v[180:183]
    v_mfma_f32_16x16x32_bf16 v[184:187], v[76:79], v[104:107], v[184:187]
    v_mfma_f32_16x16x32_bf16 v[188:191], v[76:79], v[108:111], v[188:191]
    s_waitcnt vmcnt(0)
    s_mov_b32 s63, 200000
LN1:
    v_readfirstlane_b32 s62, v251
    s_cmp_lg_u32 s62, 0
    s_cbranch_scc1 LNo1
    s_sub_u32 s63, s63, 1
    s_cmp_eq_u32 s63, 0
    s_cbranch_scc1 LNo1
    buffer_load_dword v251, v252, s[56:59], 0 offen sc1
    s_waitcnt vmcnt(0)
    s_branch LN1
LNo1:
    v_mov_b32 v251, s62
    s_mov_b64 exec, 1
    buffer_store_dword v251, v252, s[32:35], s12 offen sc1
    s_mov_b64 exec, -1
    s_waitcnt lgkmcnt(0)
    s_barrier
    v_add_u32 v12, s42, v12
    ds_read_b64_tr_b16 v[96:97], v4 offset:32768
    v_mfma_f32_16x16x32_bf16 v[128:131], v[80:83], v[112:115], v[128:131]
    ds_read_b64_tr_b16 v[98:99], v4 offset:33280
    v_mfma_f32_16x16x32_bf16 v[132:135], v[80:83], v[116:119], v[132:135]
    ds_read_b64_tr_b16 v[100:101], v5 offset:32768
    v_mfma_f32_16x16x32_bf16 v[136:139], v[80:83], v[120:123], v[136:139]
    ds_read_b64_tr_b16 v[102:103], v5 offset:33280
    v_mfma_f32_16x16x32_bf16 v[140:143], v[80:83], v[124:127], v[140:143]
    ds_read_b64_tr_b16 v[104:105], v6 offset:32768
    v_mfma_f32_16x16x32_bf16 v[144:147], v[84:87], v[112:115], v[144:147]
    ds_read_b64_tr_b16 v[106:107], v6 offset:33280
    v_mfma_f32_16x16x32_bf16 v[148:151], v[84:87], v[116:119], v[148:151]
    ds_read_b64_tr_b16 v[108:109], v7 offset:32768
    v_mfma_f32_16x16x32_bf16 v[152:155], v[84:87], v[120:123], v[152:155]
    ds_read_b64_tr_b16 v[110:111], v7 offset:33280
    v_mfma_f32_16x16x32_bf16 v[156:159], v[84:87], v[124:127], v[156:159]
    ds_read_b128 v[64:67], v12 offset:0
    v_mfma_f32_16x16x32_bf16 v[160:163], v[88:91], v[112:115], v[160:163]
    ds_read_b128 v[68:71], v12 offset:20480
    v_mfma_f32_16x16x32_bf16 v[164:167], v[88:91], v[116:119], v[164:167]
    ds_read_b128 v[72:75], v12 offset:40960
    v_mfma_f32_16x16x32_bf16 v[168:171], v[88:91], v[120:123], v[168:171]
    ds_read_b128 v[76:79], v12 offset:61440
    v_mfma_f32_16x16x32_bf16 v[172:175], v[88:91], v[124:127], v[172:175]
    v_mfma_f32_16x16x32_bf16 v[176:179], v[92:95], v[112:115], v[176:179]
    v_mfma_f32_16x16x32_bf16 v[180:183], v[92:95], v[116:119], v[180:183]
    v_mfma_f32_16x16x32_bf16 v[184:187], v[92:95], v[120:123], v[184:187]
    v_mfma_f32_16x16x32_bf16 v[188:191], v[92:95], v[124:127], v[188:191]
    s_waitcnt lgkmcnt(0)
    s_barrier
    v_add_u32 v13, s42, v13
    ds_read_b64_tr_b16 v[112:113], v4 offset:49152
    v_mfma_f32_16x16x32_bf16 v[128:131], v[64:67], v[96:99], v[128:131]
    ds_read_b64_tr_b16 v[114:115], v4 offset:49664
    v_mfma_f32_16x16x32_bf16 v[132:135], v[64:67], v[100:103], v[132:135]
    ds_read_b64_tr_b16 v[116:117], v5 offset:49152
    v_mfma_f32_16x16x32_bf16 v[136:139], v[64:67], v[104:107], v[136:139]
    ds_read_b64_tr_b16 v[118:119], v5 offset:49664
    v_mfma_f32_16x16x32_bf16 v[140:143], v[64:67], v[108:111], v[140:143]
    ds_read_b64_tr_b16 v[120:121], v6 offset:49152
    v_mfma_f32_16x16x32_bf16 v[144:147], v[68:71], v[96:99], v[144:147]
    ds_read_b64_tr_b16 v[122:123], v6 offset:49664
    v_mfma_f32_16x16x32_bf16 v[148:151], v[68:71], v[100:103], v[148:151]
    ds_read_b64_tr_b16 v[124:125], v7 offset:49152
    v_mfma_f32_16x16x32_bf16 v[152:155], v[68:71], v[104:107], v[152:155]
    ds_read_b64_tr_b16 v[126:127], v7 offset:49664
    v_mfma_f32_16x16x32_bf16 v[156:159], v[68:71], v[108:111], v[156:159]
    ds_read_b128 v[80:83], v13 offset:0
    v_mfma_f32_16x16x32_bf16 v[160:163], v[72:75], v[96:99], v[160:163]
    ds_read_b128 v[84:87], v13 offset:20480
    v_mfma_f32_16x16x32_bf16 v[164:167], v[72:75], v[100:103], v[164:167]
    ds_read_b128 v[88:91], v13 offset:40960
    v_mfma_f32_16x16x32_bf16 v[168:171], v[72:75], v[104:107], v[168:171]
    ds_read_b128 v[92:95], v13 offset:61440
    v_mfma_f32_16x16x32_bf16 v[172:175], v[72:75], v[108:111], v[172:175]
    v_mfma_f32_16x16x32_bf16 v[176:179], v[76:79], v[96:99], v[176:179]
    v_mfma_f32_16x16x32_bf16 v[180:183], v[76:79], v[100:103], v[180:183]
    v_mfma_f32_16x16x32_bf16 v[184:187], v[76:79], v[104:107], v[184:187]
    v_mfma_f32_16x16x32_bf16 v[188:191], v[76:79], v[108:111], v[188:191]
    s_waitcnt lgkmcnt(0)
    s_barrier
    v_add_u32 v14, s42, v14
    ds_read_b64_tr_b16 v[96:97], v8 offset:0
    v_mfma_f32_16x16x32_bf16 v[128:131], v[80:83], v[112:115], v[128:131]
    ds_read_b64_tr_b16 v[98:99], v8 offset:512
    v_mfma_f32_16x16x32_bf16 v[132:135], v[80:83], v[116:119], v[132:135]
    ds_read_b64_tr_b16 v[100:101], v9 offset:0
    v_mfma_f32_16x16x32_bf16 v[136:139], v[80:83], v[120:123], v[136:139]
    ds_read_b64_tr_b16 v[102:103], v9 offset:512
    v_mfma_f32_16x16x32_bf16 v[140:143], v[80:83], v[124:127], v[140:143]
    ds_read_b64_tr_b16 v[104:105], v10 offset:0
    v_mfma_f32_16x16x32_bf16 v[144:147], v[84:87], v[112:115], v[144:147]
    ds_read_b64_tr_b16 v[106:107], v10 offset:512
    v_mfma_f32_16x16x32_bf16 v[148:151], v[84:87], v[116:119], v[148:151]
    ds_read_b64_tr_b16 v[108:109], v11 offset:0
    v_mfma_f32_16x16x32_bf16 v[152:155], v[84:87], v[120:123], v[152:155]
    ds_read_b64_tr_b16 v[110:111], v11 offset:512
    v_mfma_f32_16x16x32_bf16 v[156:159], v[84:87], v[124:127], v[156:159]
    ds_read_b128 v[64:67], v14 offset:0
    v_mfma_f32_16x16x32_bf16 v[160:163], v[88:91], v[112:115], v[160:163]
    ds_read_b128 v[68:71], v14 offset:20480
    v_mfma_f32_16x16x32_bf16 v[164:167], v[88:91], v[116:119], v[164:167]
    ds_read_b128 v[72:75], v14 offset:40960
    v_mfma_f32_16x16x32_bf16 v[168:171], v[88:91], v[120:123], v[168:171]
    ds_read_b128 v[76:79], v14 offset:61440
    v_mfma_f32_16x16x32_bf16 v[172:175], v[88:91], v[124:127], v[172:175]
    v_mfma_f32_16x16x32_bf16 v[176:179], v[92:95], v[112:115], v[176:179]
    v_mfma_f32_16x16x32_bf16 v[180:183], v[92:95], v[116:119], v[180:183]
    v_mfma_f32_16x16x32_bf16 v[184:187], v[92:95], v[120:123], v[184:187]
    v_mfma_f32_16x16x32_bf16 v[188:191], v[92:95], v[124:127], v[188:191]
    s_waitcnt lgkmcnt(0)
    s_barrier
    v_add_u32 v15, s42, v15
    ds_read_b64_tr_b16 v[112:113], v4 offset:0
    v_mfma_f32_16x16x32_bf16 v[128:131], v[64:67], v[96:99], v[128:131]
    ds_read_b64_tr_b16 v[114:115], v4 offset:512
    v_mfma_f32_16x16x32_bf16 v[132:135], v[64:67], v[100:103], v[132:135]
    ds_read_b64_tr_b16 v[116:117], v5 offset:0
    v_mfma_f32_16x16x32_bf16 v[136:139], v[64:67], v[104:107], v[136:139]
    ds_read_b64_tr_b16 v[118:119], v5 offset:512
    v_mfma_f32_16x16x32_bf16 v[140:143], v[64:67], v[108:111], v[140:143]
    ds_read_b64_tr_b16 v[120:121], v6 offset:0
    v_mfma_f32_16x16x32_bf16 v[144:147], v[68:71], v[96:99], v[144:147]
    ds_read_b64_tr_b16 v[122:123], v6 offset:512
    v_mfma_f32_16x16x32_bf16 v[148:151], v[68:71], v[100:103], v[148:151]
    ds_read_b64_tr_b16 v[124:125], v7 offset:0
    v_mfma_f32_16x16x32_bf16 v[152:155], v[68:71], v[104:107], v[152:155]
    ds_read_b64_tr_b16 v[126:127], v7 offset:512
    v_mfma_f32_16x16x32_bf16 v[156:159], v[68:71], v[108:111], v[156:159]
    ds_read_b128 v[80:83], v15 offset:0
    v_mfma_f32_16x16x32_bf16 v[160:163], v[72:75], v[96:99], v[160:163]
    ds_read_b128 v[84:87], v15 offset:20480
    v_mfma_f32_16x16x32_bf16 v[164:167], v[72:75], v[100:103], v[164:167]
    ds_read_b128 v[88:91], v15 offset:40960
    v_mfma_f32_16x16x32_bf16 v[168:171], v[72:75], v[104:107], v[168:171]
    ds_read_b128 v[92:95], v15 offset:61440
    v_mfma_f32_16x16x32_bf16 v[172:175], v[72:75], v[108:111], v[172:175]
    v_mfma_f32_16x16x32_bf16 v[176:179], v[76:79], v[96:99], v[176:179]
    v_mfma_f32_16x16x32_bf16 v[180:183], v[76:79], v[100:103], v[180:183]
    v_mfma_f32_16x16x32_bf16 v[184:187], v[76:79], v[104:107], v[184:187]
    v_mfma_f32_16x16x32_bf16 v[188:191], v[76:79], v[108:111], v[188:191]
    s_waitcnt lgkmcnt(0)
    s_barrier
    v_add_u32 v12, s43, v12
    ds_read_b64_tr_b16 v[96:97], v4 offset:16384
    v_mfma_f32_16x16x32_bf16 v[128:131], v[80:83], v[112:115], v[128:131]
    ds_read_b64_tr_b16 v[98:99], v4 offset:16896
    v_mfma_f32_16x16x32_bf16 v[132:135], v[80:83], v[116:119], v[132:135]
    ds_read_b64_tr_b16 v[100:101], v5 offset:16384
    v_mfma_f32_16x16x32_bf16 v[136:139], v[80:83], v[120:123], v[136:139]
    ds_read_b64_tr_b16 v[102:103], v5 offset:16896
    v_mfma_f32_16x16x32_bf16 v[140:143], v[80:83], v[124:127], v[140:143]
    ds_read_b64_tr_b16 v[104:105], v6 offset:16384
    v_mfma_f32_16x16x32_bf16 v[144:147], v[84:87], v[112:115], v[144:147]
    ds_read_b64_tr_b16 v[106:107], v6 offset:16896
    v_mfma_f32_16x16x32_bf16 v[148:151], v[84:87], v[116:119], v[148:151]
    ds_read_b64_tr_b16 v[108:109], v7 offset:16384
    v_mfma_f32_16x16x32_bf16 v[152:155], v[84:87], v[120:123], v[152:155]
    ds_read_b64_tr_b16 v[110:111], v7 offset:16896
    v_mfma_f32_16x16x32_bf16 v[156:159], v[84:87], v[124:127], v[156:159]
    ds_read_b128 v[64:67], v12 offset:0
    v_mfma_f32_16x16x32_bf16 v[160:163], v[88:91], v[112:115], v[160:163]
    ds_read_b128 v[68:71], v12 offset:20480
    v_mfma_f32_16x16x32_bf16 v[164:167], v[88:91], v[116:119], v[164:167]
    ds_read_b128 v[72:75], v12 offset:40960
    v_mfma_f32_16x16x32_bf16 v[168:171], v[88:91], v[120:123], v[168:171]
    ds_read_b128 v[76:79], v12 offset:61440
    v_mfma_f32_16x16x32_bf16 v[172:175], v[88:91], v[124:127], v[172:175]
    v_mfma_f32_16x16x32_bf16 v[176:179], v[92:95], v[112:115], v[176:179]
    v_mfma_f32_16x16x32_bf16 v[180:183], v[92:95], v[116:119], v[180:183]
    v_mfma_f32_16x16x32_bf16 v[184:187], v[92:95], v[120:123], v[184:187]
    v_mfma_f32_16x16x32_bf16 v[188:191], v[92:95], v[124:127], v[188:191]
    s_waitcnt lgkmcnt(0)
    s_barrier
    v_add_u32 v13, s43, v13
    ds_read_b64_tr_b16 v[112:113], v4 offset:32768
    v_mfma_f32_16x16x32_bf16 v[128:131], v[64:67], v[96:99], v[128:131]
    ds_read_b64_tr_b16 v[114:115], v4 offset:33280
    v_mfma_f32_16x16x32_bf16 v[132:135], v[64:67], v[100:103], v[132:135]
    ds_read_b64_tr_b16 v[116:117], v5 offset:32768
    v_mfma_f32_16x16x32_bf16 v[136:139], v[64:67], v[104:107], v[136:139]
    ds_read_b64_tr_b16 v[118:119], v5 offset:33280
    v_mfma_f32_16x16x32_bf16 v[140:143], v[64:67], v[108:111], v[140:143]
    ds_read_b64_tr_b16 v[120:121], v6 offset:32768
    v_mfma_f32_16x16x32_bf16 v[144:147], v[68:71], v[96:99], v[144:147]
    ds_read_b64_tr_b16 v[122:123], v6 offset:33280
    v_mfma_f32_16x16x32_bf16 v[148:151], v[68:71], v[100:103], v[148:151]
    ds_read_b64_tr_b16 v[124:125], v7 offset:32768
    v_mfma_f32_16x16x32_bf16 v[152:155], v[68:71], v[104:107], v[152:155]
    ds_read_b64_tr_b16 v[126:127], v7 offset:33280
    v_mfma_f32_16x16x32_bf16 v[156:159], v[68:71], v[108:111], v[156:159]
    ds_read_b128 v[80:83], v13 offset:0
    v_mfma_f32_16x16x32_bf16 v[160:163], v[72:75], v[96:99], v[160:163]
    ds_read_b128 v[84:87], v13 offset:20480
    v_mfma_f32_16x16x32_bf16 v[164:167], v[72:75], v[100:103], v[164:167]
    ds_read_b128 v[88:91], v13 offset:40960
    v_mfma_f32_16x16x32_bf16 v[168:171], v[72:75], v[104:107], v[168:171]
    ds_read_b128 v[92:95], v13 offset:61440
    v_mfma_f32_16x16x32_bf16 v[172:175], v[72:75], v[108:111], v[172:175]
    v_mfma_f32_16x16x32_bf16 v[176:179], v[76:79], v[96:99], v[176:179]
    v_mfma_f32_16x16x32_bf16 v[180:183], v[76:79], v[100:103], v[180:183]
    v_mfma_f32_16x16x32_bf16 v[184:187], v[76:79], v[104:107], v[184:187]
    v_mfma_f32_16x16x32_bf16 v[188:191], v[76:79], v[108:111], v[188:191]
    s_waitcnt lgkmcnt(0)
    s_barrier
    v_add_u32 v14, s43, v14
    ds_read_b64_tr_b16 v[96:97], v4 offset:49152
    v_mfma_f32_16x16x32_bf16 v[128:131], v[80:83], v[112:115], v[128:131]
    ds_read_b64_tr_b16 v[98:99], v4 offset:49664
    v_mfma_f32_16x16x32_bf16 v[132:135], v[80:83], v[116:119], v[132:135]
    ds_read_b64_tr_b16 v[100:101], v5 offset:49152
    v_mfma_f32_16x16x32_bf16 v[136:139], v[80:83], v[120:123], v[136:139]
    ds_read_b64_tr_b16 v[102:103], v5 offset:49664
    v_mfma_f32_16x16x32_bf16 v[140:143], v[80:83], v[124:127], v[140:143]
    ds_read_b64_tr_b16 v[104:105], v6 offset:49152
    v_mfma_f32_16x16x32_bf16 v[144:147], v[84:87], v[112:115], v[144:147]
    ds_read_b64_tr_b16 v[106:107], v6 offset:49664
    v_mfma_f32_16x16x32_bf16 v[148:151], v[84:87], v[116:119], v[148:151]
    ds_read_b64_tr_b16 v[108:109], v7 offset:49152
    v_mfma_f32_16x16x32_bf16 v[152:155], v[84:87], v[120:123], v[152:155]
    ds_read_b64_tr_b16 v[110:111], v7 offset:49664
    v_mfma_f32_16x16x32_bf16 v[156:159], v[84:87], v[124:127], v[156:159]
    ds_read_b128 v[64:67], v14 offset:0
    v_mfma_f32_16x16x32_bf16 v[160:163], v[88:91], v[112:115], v[160:163]
    ds_read_b128 v[68:71], v14 offset:20480
    v_mfma_f32_16x16x32_bf16 v[164:167], v[88:91], v[116:119], v[164:167]
    ds_read_b128 v[72:75], v14 offset:40960
    v_mfma_f32_16x16x32_bf16 v[168:171], v[88:91], v[120:123], v[168:171]
    ds_read_b128 v[76:79], v14 offset:61440
    v_mfma_f32_16x16x32_bf16 v[172:175], v[88:91], v[124:127], v[172:175]
    v_mfma_f32_16x16x32_bf16 v[176:179], v[92:95], v[112:115], v[176:179]
    v_mfma_f32_16x16x32_bf16 v[180:183], v[92:95], v[116:119], v[180:183]
    v_mfma_f32_16x16x32_bf16 v[184:187], v[92:95], v[120:123], v[184:187]
    v_mfma_f32_16x16x32_bf16 v[188:191], v[92:95], v[124:127], v[188:191]
    s_waitcnt lgkmcnt(0)
    v_add_u32 v15, s43, v15
    ds_read_b64_tr_b16 v[112:113], v8 offset:0
    v_mfma_f32_16x16x32_bf16 v[128:131], v[64:67], v[96:99], v[128:131]
    ds_read_b64_tr_b16 v[114:115], v8 offset:512
    v_mfma_f32_16x16x32_bf16 v[132:135], v[64:67], v[100:103], v[132:135]
    ds_read_b64_tr_b16 v[116:117], v9 offset:0
    v_mfma_f32_16x16x32_bf16 v[136:139], v[64:67], v[104:107], v[136:139]
    ds_read_b64_tr_b16 v[118:119], v9 offset:512
    v_mfma_f32_16x16x32_bf16 v[140:143], v[64:67], v[108:111], v[140:143]
    ds_read_b64_tr_b16 v[120:121], v10 offset:0
    v_mfma_f32_16x16x32_bf16 v[144:147], v[68:71], v[96:99], v[144:147]
    ds_read_b64_tr_b16 v[122:123], v10 offset:512
    v_mfma_f32_16x16x32_bf16 v[148:151], v[68:71], v[100:103], v[148:151]
    ds_read_b64_tr_b16 v[124:125], v11 offset:0
    v_mfma_f32_16x16x32_bf16 v[152:155], v[68:71], v[104:107], v[152:155]
    ds_read_b64_tr_b16 v[126:127], v11 offset:512
    v_mfma_f32_16x16x32_bf16 v[156:159], v[68:71], v[108:111], v[156:159]
    ds_read_b128 v[80:83], v15 offset:0
    v_mfma_f32_16x16x32_bf16 v[160:163], v[72:75], v[96:99], v[160:163]
    ds_read_b128 v[84:87], v15 offset:20480
    v_mfma_f32_16x16x32_bf16 v[164:167], v[72:75], v[100:103], v[164:167]
    ds_read_b128 v[88:91], v15 offset:40960
    v_mfma_f32_16x16x32_bf16 v[168:171], v[72:75], v[104:107], v[168:171]
    ds_read_b128 v[92:95], v15 offset:61440
    v_mfma_f32_16x16x32_bf16 v[172:175], v[72:75], v[108:111], v[172:175]
    v_mfma_f32_16x16x32_bf16 v[176:179], v[76:79], v[96:99], v[176:179]
    v_mfma_f32_16x16x32_bf16 v[180:183], v[76:79], v[100:103], v[180:183]
    v_mfma_f32_16x16x32_bf16 v[184:187], v[76:79], v[104:107], v[184:187]
    v_mfma_f32_16x16x32_bf16 v[188:191], v[76:79], v[108:111], v[188:191]
    s_waitcnt lgkmcnt(0)
    v_mfma_f32_16x16x32_bf16 v[128:131], v[80:83], v[112:115], v[128:131]
    v_mfma_f32_16x16x32_bf16 v[132:135], v[80:83], v[116:119], v[132:135]
    v_mfma_f32_16x16x32_bf16 v[136:139], v[80:83], v[120:123], v[136:139]
    v_mfma_f32_16x16x32_bf16 v[140:143], v[80:83], v[124:127], v[140:143]
    v_mfma_f32_16x16x32_bf16 v[144:147], v[84:87], v[112:115], v[144:147]
    v_mfma_f32_16x16x32_bf16 v[148:151], v[84:87], v[116:119], v[148:151]
    v_mfma_f32_16x16x32_bf16 v[152:155], v[84:87], v[120:123], v[152:155]
    v_mfma_f32_16x16x32_bf16 v[156:159], v[84:87], v[124:127], v[156:159]
    v_mfma_f32_16x16x32_bf16 v[160:163], v[88:91], v[112:115], v[160:163]
    v_mfma_f32_16x16x32_bf16 v[164:167], v[88:91], v[116:119], v[164:167]
    v_mfma_f32_16x16x32_bf16 v[168:171], v[88:91], v[120:123], v[168:171]
    v_mfma_f32_16x16x32_bf16 v[172:175], v[88:91], v[124:127], v[172:175]
    v_mfma_f32_16x16x32_bf16 v[176:179], v[92:95], v[112:115], v[176:179]
    v_mfma_f32_16x16x32_bf16 v[180:183], v[92:95], v[116:119], v[180:183]
    v_mfma_f32_16x16x32_bf16 v[184:187], v[92:95], v[120:123], v[184:187]
    v_mfma_f32_16x16x32_bf16 v[188:191], v[92:95], v[124:127], v[188:191]
    s_barrier
    s_sub_u32 s47, s23, 10
    s_lshl_b32 s47, s47, 18
    s_lshl_b32 s4, s16, 13
    s_add_u32 s4, s4, s47
    s_add_u32 s4, s4, 5242880
    s_cmp_ge_u32 s23, 30
    s_cselect_b32 s4, 0x7f000000, s4
    s_add_u32 s5, s4, 512
    s_add_u32 s6, s4, 4096
    s_add_u32 s7, s4, 4608
    v_and_b32 v16, 15, v0
    v_lshrrev_b32 v17, 4, v0
    v_lshlrev_b32 v17, 10, v17
    v_lshl_add_u32 v23, v16, 4, v17
    v_mov_b32 v20, v23
    v_mov_b32 v21, v23
    v_mov_b32 v22, v23
    s_lshl_b32 s4, s16, 9
    s_add_u32 s4, s4, s47
    s_add_u32 s4, s4, 5242624
    s_cmp_ge_u32 s23, 30
    s_cselect_b32 s4, 0x7f000000, s4
    s_mov_b32 s5, s4
    s_add_u32 s6, s4, 256
    s_mov_b32 s7, s6
    v_bfe_u32 v16, v0, 2, 2
    v_lshrrev_b32 v17, 4, v0
    v_lshlrev_b32 v17, 6, v17
    v_lshl_add_u32 v16, v16, 14, v17
    v_and_b32 v17, 3, v0
    v_lshl_add_u32 v16, v17, 4, v16
    v_add_u32 v20, 256, v16
    v_add_u32 v21, 65536, v16
    v_add_u32 v22, 131328, v16
    v_add_u32 v23, 196608, v16
    s_cmp_ge_u32 s23, 20
    s_cbranch_scc1 LA_vst0
    s_mov_b32 s54, 0x3fb8aa3b
    s_mov_b32 s55, 0xb5c1a2a0
    s_mov_b32 s52, 0x358637bd
    v_pk_fma_f32 v[64:65], v[128:129], s[54:55], s[54:55] op_sel:[0,0,1] op_sel_hi:[1,0,1]
    v_pk_fma_f32 v[66:67], v[130:131], s[54:55], s[54:55] op_sel:[0,0,1] op_sel_hi:[1,0,1]
    v_pk_fma_f32 v[68:69], v[132:133], s[54:55], s[54:55] op_sel:[0,0,1] op_sel_hi:[1,0,1]
    v_pk_fma_f32 v[70:71], v[134:135], s[54:55], s[54:55] op_sel:[0,0,1] op_sel_hi:[1,0,1]
    v_exp_f32_e64 v64, v64 clamp
    v_exp_f32_e64 v65, v65 clamp
    v_exp_f32_e64 v66, v66 clamp
    v_exp_f32_e64 v67, v67 clamp
    v_exp_f32_e64 v68, v68 clamp
    v_exp_f32_e64 v69, v69 clamp
    v_exp_f32_e64 v70, v70 clamp
    v_exp_f32_e64 v71, v71 clamp
    v_max_f32 v128, s52, v128
    v_max_f32 v129, s52, v129
    v_max_f32 v130, s52, v130
    v_max_f32 v131, s52, v131
    v_max_f32 v132, s52, v132
    v_max_f32 v133, s52, v133
    v_max_f32 v134, s52, v134
    v_max_f32 v135, s52, v135
    v_pk_add_f32 v[128:129], v[128:129], v[64:65]
    v_pk_add_f32 v[130:131], v[130:131], v[66:67]
    v_pk_add_f32 v[132:133], v[132:133], v[68:69]
    v_pk_add_f32 v[134:135], v[134:135], v[70:71]
    v_pk_fma_f32 v[64:65], v[136:137], s[54:55], s[54:55] op_sel:[0,0,1] op_sel_hi:[1,0,1]
    v_pk_fma_f32 v[66:67], v[138:139], s[54:55], s[54:55] op_sel:[0,0,1] op_sel_hi:[1,0,1]
    v_pk_fma_f32 v[68:69], v[140:141], s[54:55], s[54:55] op_sel:[0,0,1] op_sel_hi:[1,0,1]
    v_pk_fma_f32 v[70:71], v[142:143], s[54:55], s[54:55] op_sel:[0,0,1] op_sel_hi:[1,0,1]
    v_exp_f32_e64 v64, v64 clamp
    v_exp_f32_e64 v65, v65 clamp
    v_exp_f32_e64 v66, v66 clamp
    v_exp_f32_e64 v67, v67 clamp
    v_exp_f32_e64 v68, v68 clamp
    v_exp_f32_e64 v69, v69 clamp
    v_exp_f32_e64 v70, v70 clamp
    v_exp_f32_e64 v71, v71 clamp
    v_max_f32 v136, s52, v136
    v_max_f32 v137, s52, v137
    v_max_f32 v138, s52, v138
    v_max_f32 v139, s52, v139
    v_max_f32 v140, s52, v140
    v_max_f32 v141, s52, v141
    v_max_f32 v142, s52, v142
    v_max_f32 v143, s52, v143
    v_pk_add_f32 v[136:137], v[136:137], v[64:65]
    v_pk_add_f32 v[138:139], v[138:139], v[66:67]
    v_pk_add_f32 v[140:141], v[140:141], v[68:69]
    v_pk_add_f32 v[142:143], v[142:143], v[70:71]
    v_pk_fma_f32 v[64:65], v[144:145], s[54:55], s[54:55] op_sel:[0,0,1] op_sel_hi:[1,0,1]
    v_pk_fma_f32 v[66:67], v[146:147], s[54:55], s[54:55] op_sel:[0,0,1] op_sel_hi:[1,0,1]
    v_pk_fma_f32 v[68:69], v[148:149], s[54:55], s[54:55] op_sel:[0,0,1] op_sel_hi:[1,0,1]
    v_pk_fma_f32 v[70:71], v[150:151], s[54:55], s[54:55] op_sel:[0,0,1] op_sel_hi:[1,0,1]
    v_exp_f32_e64 v64, v64 clamp
    v_exp_f32_e64 v65, v65 clamp
    v_exp_f32_e64 v66, v66 clamp
    v_exp_f32_e64 v67, v67 clamp
    v_exp_f32_e64 v68, v68 clamp
    v_exp_f32_e64 v69, v69 clamp
    v_exp_f32_e64 v70, v70 clamp
    v_exp_f32_e64 v71, v71 clamp
    v_max_f32 v144, s52, v144
    v_max_f32 v145, s52, v145
    v_max_f32 v146, s52, v146
    v_max_f32 v147, s52, v147
    v_max_f32 v148, s52, v148
    v_max_f32 v149, s52, v149
    v_max_f32 v150, s52, v150
    v_max_f32 v151, s52, v151
    v_pk_add_f32 v[144:145], v[144:145], v[64:65]
    v_pk_add_f32 v[146:147], v[146:147], v[66:67]
    v_pk_add_f32 v[148:149], v[148:149], v[68:69]
    v_pk_add_f32 v[150:151], v[150:151], v[70:71]
    v_pk_fma_f32 v[64:65], v[152:153], s[54:55], s[54:55] op_sel:[0,0,1] op_sel_hi:[1,0,1]
    v_pk_fma_f32 v[66:67], v[154:155], s[54:55], s[54:55] op_sel:[0,0,1] op_sel_hi:[1,0,1]
    v_pk_fma_f32 v[68:69], v[156:157], s[54:55], s[54:55] op_sel:[0,0,1] op_sel_hi:[1,0,1]
    v_pk_fma_f32 v[70:71], v[158:159], s[54:55], s[54:55] op_sel:[0,0,1] op_sel_hi:[1,0,1]
    v_exp_f32_e64 v64, v64 clamp
    v_exp_f32_e64 v65, v65 clamp
    v_exp_f32_e64 v66, v66 clamp
    v_exp_f32_e64 v67, v67 clamp
    v_exp_f32_e64 v68, v68 clamp
    v_exp_f32_e64 v69, v69 clamp
    v_exp_f32_e64 v70, v70 clamp
    v_exp_f32_e64 v71, v71 clamp
    v_max_f32 v152, s52, v152
    v_max_f32 v153, s52, v153
    v_max_f32 v154, s52, v154
    v_max_f32 v155, s52, v155
    v_max_f32 v156, s52, v156
    v_max_f32 v157, s52, v157
    v_max_f32 v158, s52, v158
    v_max_f32 v159, s52, v159
    v_pk_add_f32 v[152:153], v[152:153], v[64:65]
    v_pk_add_f32 v[154:155], v[154:155], v[66:67]
    v_pk_add_f32 v[156:157], v[156:157], v[68:69]
    v_pk_add_f32 v[158:159], v[158:159], v[70:71]
LA_vst0:
    v_cvt_pk_bf16_f32 v208, v128, v129
    v_cvt_pk_bf16_f32 v209, v130, v131
    v_cvt_pk_bf16_f32 v210, v144, v145
    v_cvt_pk_bf16_f32 v211, v146, v147
    v_cvt_pk_bf16_f32 v212, v132, v133
    v_cvt_pk_bf16_f32 v213, v134, v135
    v_cvt_pk_bf16_f32 v214, v148, v149
    v_cvt_pk_bf16_f32 v215, v150, v151
    v_cvt_pk_bf16_f32 v216, v136, v137
    v_cvt_pk_bf16_f32 v217, v138, v139
    v_cvt_pk_bf16_f32 v218, v152, v153
    v_cvt_pk_bf16_f32 v219, v154, v155
    v_cvt_pk_bf16_f32 v220, v140, v141
    v_cvt_pk_bf16_f32 v221, v142, v143
    v_cvt_pk_bf16_f32 v222, v156, v157
    v_cvt_pk_bf16_f32 v223, v158, v159
    s_cmp_ge_u32 s23, 20
    s_cbranch_scc1 LA_vst1
    s_mov_b32 s54, 0x3fb8aa3b
    s_mov_b32 s55, 0xb5c1a2a0
    s_mov_b32 s52, 0x358637bd
    v_pk_fma_f32 v[64:65], v[160:161], s[54:55], s[54:55] op_sel:[0,0,1] op_sel_hi:[1,0,1]
    v_pk_fma_f32 v[66:67], v[162:163], s[54:55], s[54:55] op_sel:[0,0,1] op_sel_hi:[1,0,1]
    v_pk_fma_f32 v[68:69], v[164:165], s[54:55], s[54:55] op_sel:[0,0,1] op_sel_hi:[1,0,1]
    v_pk_fma_f32 v[70:71], v[166:167], s[54:55], s[54:55] op_sel:[0,0,1] op_sel_hi:[1,0,1]
    v_exp_f32_e64 v64, v64 clamp
    v_exp_f32_e64 v65, v65 clamp
    v_exp_f32_e64 v66, v66 clamp
    v_exp_f32_e64 v67, v67 clamp
    v_exp_f32_e64 v68, v68 clamp
    v_exp_f32_e64 v69, v69 clamp
    v_exp_f32_e64 v70, v70 clamp
    v_exp_f32_e64 v71, v71 clamp
    v_max_f32 v160, s52, v160
    v_max_f32 v161, s52, v161
    v_max_f32 v162, s52, v162
    v_max_f32 v163, s52, v163
    v_max_f32 v164, s52, v164
    v_max_f32 v165, s52, v165
    v_max_f32 v166, s52, v166
    v_max_f32 v167, s52, v167
    v_pk_add_f32 v[160:161], v[160:161], v[64:65]
    v_pk_add_f32 v[162:163], v[162:163], v[66:67]
    v_pk_add_f32 v[164:165], v[164:165], v[68:69]
    v_pk_add_f32 v[166:167], v[166:167], v[70:71]
    v_pk_fma_f32 v[64:65], v[168:169], s[54:55], s[54:55] op_sel:[0,0,1] op_sel_hi:[1,0,1]
    v_pk_fma_f32 v[66:67], v[170:171], s[54:55], s[54:55] op_sel:[0,0,1] op_sel_hi:[1,0,1]
    v_pk_fma_f32 v[68:69], v[172:173], s[54:55], s[54:55] op_sel:[0,0,1] op_sel_hi:[1,0,1]
    v_pk_fma_f32 v[70:71], v[174:175], s[54:55], s[54:55] op_sel:[0,0,1] op_sel_hi:[1,0,1]
    v_exp_f32_e64 v64, v64 clamp
    v_exp_f32_e64 v65, v65 clamp
    v_exp_f32_e64 v66, v66 clamp
    v_exp_f32_e64 v67, v67 clamp
    v_exp_f32_e64 v68, v68 clamp
    v_exp_f32_e64 v69, v69 clamp
    v_exp_f32_e64 v70, v70 clamp
    v_exp_f32_e64 v71, v71 clamp
    v_max_f32 v168, s52, v168
    v_max_f32 v169, s52, v169
    v_max_f32 v170, s52, v170
    v_max_f32 v171, s52, v171
    v_max_f32 v172, s52, v172
    v_max_f32 v173, s52, v173
    v_max_f32 v174, s52, v174
    v_max_f32 v175, s52, v175
    v_pk_add_f32 v[168:169], v[168:169], v[64:65]
    v_pk_add_f32 v[170:171], v[170:171], v[66:67]
    v_pk_add_f32 v[172:173], v[172:173], v[68:69]
    v_pk_add_f32 v[174:175], v[174:175], v[70:71]
    v_pk_fma_f32 v[64:65], v[176:177], s[54:55], s[54:55] op_sel:[0,0,1] op_sel_hi:[1,0,1]
    v_pk_fma_f32 v[66:67], v[178:179], s[54:55], s[54:55] op_sel:[0,0,1] op_sel_hi:[1,0,1]
    v_pk_fma_f32 v[68:69], v[180:181], s[54:55], s[54:55] op_sel:[0,0,1] op_sel_hi:[1,0,1]
    v_pk_fma_f32 v[70:71], v[182:183], s[54:55], s[54:55] op_sel:[0,0,1] op_sel_hi:[1,0,1]
    v_exp_f32_e64 v64, v64 clamp
    v_exp_f32_e64 v65, v65 clamp
    v_exp_f32_e64 v66, v66 clamp
    v_exp_f32_e64 v67, v67 clamp
    v_exp_f32_e64 v68, v68 clamp
    v_exp_f32_e64 v69, v69 clamp
    v_exp_f32_e64 v70, v70 clamp
    v_exp_f32_e64 v71, v71 clamp
    v_max_f32 v176, s52, v176
    v_max_f32 v177, s52, v177
    v_max_f32 v178, s52, v178
    v_max_f32 v179, s52, v179
    v_max_f32 v180, s52, v180
    v_max_f32 v181, s52, v181
    v_max_f32 v182, s52, v182
    v_max_f32 v183, s52, v183
    v_pk_add_f32 v[176:177], v[176:177], v[64:65]
    v_pk_add_f32 v[178:179], v[178:179], v[66:67]
    v_pk_add_f32 v[180:181], v[180:181], v[68:69]
    v_pk_add_f32 v[182:183], v[182:183], v[70:71]
    v_pk_fma_f32 v[64:65], v[184:185], s[54:55], s[54:55] op_sel:[0,0,1] op_sel_hi:[1,0,1]
    v_pk_fma_f32 v[66:67], v[186:187], s[54:55], s[54:55] op_sel:[0,0,1] op_sel_hi:[1,0,1]
    v_pk_fma_f32 v[68:69], v[188:189], s[54:55], s[54:55] op_sel:[0,0,1] op_sel_hi:[1,0,1]
    v_pk_fma_f32 v[70:71], v[190:191], s[54:55], s[54:55] op_sel:[0,0,1] op_sel_hi:[1,0,1]
    v_exp_f32_e64 v64, v64 clamp
    v_exp_f32_e64 v65, v65 clamp
    v_exp_f32_e64 v66, v66 clamp
    v_exp_f32_e64 v67, v67 clamp
    v_exp_f32_e64 v68, v68 clamp
    v_exp_f32_e64 v69, v69 clamp
    v_exp_f32_e64 v70, v70 clamp
    v_exp_f32_e64 v71, v71 clamp
    v_max_f32 v184, s52, v184
    v_max_f32 v185, s52, v185
    v_max_f32 v186, s52, v186
    v_max_f32 v187, s52, v187
    v_max_f32 v188, s52, v188
    v_max_f32 v189, s52, v189
    v_max_f32 v190, s52, v190
    v_max_f32 v191, s52, v191
    v_pk_add_f32 v[184:185], v[184:185], v[64:65]
    v_pk_add_f32 v[186:187], v[186:187], v[66:67]
    v_pk_add_f32 v[188:189], v[188:189], v[68:69]
    v_pk_add_f32 v[190:191], v[190:191], v[70:71]
LA_vst1:
    v_cvt_pk_bf16_f32 v224, v160, v161
    v_cvt_pk_bf16_f32 v225, v162, v163
    v_cvt_pk_bf16_f32 v226, v176, v177
    v_cvt_pk_bf16_f32 v227, v178, v179
    v_cvt_pk_bf16_f32 v228, v164, v165
    v_cvt_pk_bf16_f32 v229, v166, v167
    v_cvt_pk_bf16_f32 v230, v180, v181
    v_cvt_pk_bf16_f32 v231, v182, v183
    v_cvt_pk_bf16_f32 v232, v168, v169
    v_cvt_pk_bf16_f32 v233, v170, v171
    v_cvt_pk_bf16_f32 v234, v184, v185
    v_cvt_pk_bf16_f32 v235, v186, v187
    v_cvt_pk_bf16_f32 v236, v172, v173
    v_cvt_pk_bf16_f32 v237, v174, v175
    v_cvt_pk_bf16_f32 v238, v188, v189
    v_cvt_pk_bf16_f32 v239, v190, v191
    s_branch LA_done
LA_q:
    s_waitcnt lgkmcnt(0)
    s_barrier
    ds_read_b64_tr_b16 v[112:113], v4 offset:16384
    v_mfma_f32_16x16x32_bf16 v[128:131], v[96:99], v[64:67], v[128:131]
    ds_read_b64_tr_b16 v[114:115], v4 offset:16896
    v_mfma_f32_16x16x32_bf16 v[132:135], v[96:99], v[68:71], v[132:135]
    ds_read_b64_tr_b16 v[116:117], v5 offset:16384
    v_mfma_f32_16x16x32_bf16 v[136:139], v[96:99], v[72:75], v[136:139]
    ds_read_b64_tr_b16 v[118:119], v5 offset:16896
    v_mfma_f32_16x16x32_bf16 v[140:143], v[96:99], v[76:79], v[140:143]
    ds_read_b64_tr_b16 v[120:121], v6 offset:16384
    v_mfma_f32_16x16x32_bf16 v[144:147], v[100:103], v[64:67], v[144:147]
    ds_read_b64_tr_b16 v[122:123], v6 offset:16896
    v_mfma_f32_16x16x32_bf16 v[148:151], v[100:103], v[68:71], v[148:151]
    ds_read_b64_tr_b16 v[124:125], v7 offset:16384
    v_mfma_f32_16x16x32_bf16 v[152:155], v[100:103], v[72:75], v[152:155]
    ds_read_b64_tr_b16 v[126:127], v7 offset:16896
    v_mfma_f32_16x16x32_bf16 v[156:159], v[100:103], v[76:79], v[156:159]
    ds_read_b128 v[80:83], v13 offset:0
    v_mfma_f32_16x16x32_bf16 v[160:163], v[104:107], v[64:67], v[160:163]
    ds_read_b128 v[84:87], v13 offset:20480
    v_mfma_f32_16x16x32_bf16 v[164:167], v[104:107], v[68:71], v[164:167]
    ds_read_b128 v[88:91], v13 offset:40960
    v_mfma_f32_16x16x32_bf16 v[168:171], v[104:107], v[72:75], v[168:171]
    ds_read_b128 v[92:95], v13 offset:61440
    v_mfma_f32_16x16x32_bf16 v[172:175], v[104:107], v[76:79], v[172:175]
    v_mfma_f32_16x16x32_bf16 v[176:179], v[108:111], v[64:67], v[176:179]
    v_mfma_f32_16x16x32_bf16 v[180:183], v[108:111], v[68:71], v[180:183]
    v_mfma_f32_16x16x32_bf16 v[184:187], v[108:111], v[72:75], v[184:187]
    v_mfma_f32_16x16x32_bf16 v[188:191], v[108:111], v[76:79], v[188:191]
    s_waitcnt lgkmcnt(0)
    s_barrier
    ds_read_b64_tr_b16 v[96:97], v4 offset:32768
    v_mfma_f32_16x16x32_bf16 v[128:131], v[112:115], v[80:83], v[128:131]
    ds_read_b64_tr_b16 v[98:99], v4 offset:33280
    v_mfma_f32_16x16x32_bf16 v[132:135], v[112:115], v[84:87], v[132:135]
    ds_read_b64_tr_b16 v[100:101], v5 offset:32768
    v_mfma_f32_16x16x32_bf16 v[136:139], v[112:115], v[88:91], v[136:139]
    ds_read_b64_tr_b16 v[102:103], v5 offset:33280
    v_mfma_f32_16x16x32_bf16 v[140:143], v[112:115], v[92:95], v[140:143]
    ds_read_b64_tr_b16 v[104:105], v6 offset:32768
    v_mfma_f32_16x16x32_bf16 v[144:147], v[116:119], v[80:83], v[144:147]
    ds_read_b64_tr_b16 v[106:107], v6 offset:33280
    v_mfma_f32_16x16x32_bf16 v[148:151], v[116:119], v[84:87], v[148:151]
    ds_read_b64_tr_b16 v[108:109], v7 offset:32768
    v_mfma_f32_16x16x32_bf16 v[152:155], v[116:119], v[88:91], v[152:155]
    ds_read_b64_tr_b16 v[110:111], v7 offset:33280
    v_mfma_f32_16x16x32_bf16 v[156:159], v[116:119], v[92:95], v[156:159]
    ds_read_b128 v[64:67], v14 offset:0
    v_mfma_f32_16x16x32_bf16 v[160:163], v[120:123], v[80:83], v[160:163]
    ds_read_b128 v[68:71], v14 offset:20480
    v_mfma_f32_16x16x32_bf16 v[164:167], v[120:123], v[84:87], v[164:167]
    ds_read_b128 v[72:75], v14 offset:40960
    v_mfma_f32_16x16x32_bf16 v[168:171], v[120:123], v[88:91], v[168:171]
    ds_read_b128 v[76:79], v14 offset:61440
    v_mfma_f32_16x16x32_bf16 v[172:175], v[120:123], v[92:95], v[172:175]
    v_mfma_f32_16x16x32_bf16 v[176:179], v[124:127], v[80:83], v[176:179]
    v_mfma_f32_16x16x32_bf16 v[180:183], v[124:127], v[84:87], v[180:183]
    v_mfma_f32_16x16x32_bf16 v[184:187], v[124:127], v[88:91], v[184:187]
    v_mfma_f32_16x16x32_bf16 v[188:191], v[124:127], v[92:95], v[188:191]
    s_waitcnt lgkmcnt(0)
    s_barrier
    ds_read_b64_tr_b16 v[112:113], v4 offset:49152
    v_mfma_f32_16x16x32_bf16 v[128:131], v[96:99], v[64:67], v[128:131]
    ds_read_b64_tr_b16 v[114:115], v4 offset:49664
    v_mfma_f32_16x16x32_bf16 v[132:135], v[96:99], v[68:71], v[132:135]
    ds_read_b64_tr_b16 v[116:117], v5 offset:49152
    v_mfma_f32_16x16x32_bf16 v[136:139], v[96:99], v[72:75], v[136:139]
    ds_read_b64_tr_b16 v[118:119], v5 offset:49664
    v_mfma_f32_16x16x32_bf16 v[140:143], v[96:99], v[76:79], v[140:143]
    ds_read_b64_tr_b16 v[120:121], v6 offset:49152
    v_mfma_f32_16x16x32_bf16 v[144:147], v[100:103], v[64:67], v[144:147]
    ds_read_b64_tr_b16 v[122:123], v6 offset:49664
    v_mfma_f32_16x16x32_bf16 v[148:151], v[100:103], v[68:71], v[148:151]
    ds_read_b64_tr_b16 v[124:125], v7 offset:49152
    v_mfma_f32_16x16x32_bf16 v[152:155], v[100:103], v[72:75], v[152:155]
    ds_read_b64_tr_b16 v[126:127], v7 offset:49664
    v_mfma_f32_16x16x32_bf16 v[156:159], v[100:103], v[76:79], v[156:159]
    ds_read_b128 v[80:83], v15 offset:0
    v_mfma_f32_16x16x32_bf16 v[160:163], v[104:107], v[64:67], v[160:163]
    ds_read_b128 v[84:87], v15 offset:20480
    v_mfma_f32_16x16x32_bf16 v[164:167], v[104:107], v[68:71], v[164:167]
    ds_read_b128 v[88:91], v15 offset:40960
    v_mfma_f32_16x16x32_bf16 v[168:171], v[104:107], v[72:75], v[168:171]
    ds_read_b128 v[92:95], v15 offset:61440
    v_mfma_f32_16x16x32_bf16 v[172:175], v[104:107], v[76:79], v[172:175]
    v_mfma_f32_16x16x32_bf16 v[176:179], v[108:111], v[64:67], v[176:179]
    v_mfma_f32_16x16x32_bf16 v[180:183], v[108:111], v[68:71], v[180:183]
    v_mfma_f32_16x16x32_bf16 v[184:187], v[108:111], v[72:75], v[184:187]
    v_mfma_f32_16x16x32_bf16 v[188:191], v[108:111], v[76:79], v[188:191]
    s_waitcnt lgkmcnt(0)
    s_barrier
    v_add_u32 v12, s40, v12
    ds_read_b64_tr_b16 v[96:97], v8 offset:0
    v_mfma_f32_16x16x32_bf16 v[128:131], v[112:115], v[80:83], v[128:131]
    ds_read_b64_tr_b16 v[98:99], v8 offset:512
    v_mfma_f32_16x16x32_bf16 v[132:135], v[112:115], v[84:87], v[132:135]
    ds_read_b64_tr_b16 v[100:101], v9 offset:0
    v_mfma_f32_16x16x32_bf16 v[136:139], v[112:115], v[88:91], v[136:139]
    ds_read_b64_tr_b16 v[102:103], v9 offset:512
    v_mfma_f32_16x16x32_bf16 v[140:143], v[112:115], v[92:95], v[140:143]
    ds_read_b64_tr_b16 v[104:105], v10 offset:0
    v_mfma_f32_16x16x32_bf16 v[144:147], v[116:119], v[80:83], v[144:147]
    ds_read_b64_tr_b16 v[106:107], v10 offset:512
    v_mfma_f32_16x16x32_bf16 v[148:151], v[116:119], v[84:87], v[148:151]
    ds_read_b64_tr_b16 v[108:109], v11 offset:0
    v_mfma_f32_16x16x32_bf16 v[152:155], v[116:119], v[88:91], v[152:155]
    ds_read_b64_tr_b16 v[110:111], v11 offset:512
    v_mfma_f32_16x16x32_bf16 v[156:159], v[116:119], v[92:95], v[156:159]
    ds_read_b128 v[64:67], v12 offset:0
    v_mfma_f32_16x16x32_bf16 v[160:163], v[120:123], v[80:83], v[160:163]
    ds_read_b128 v[68:71], v12 offset:20480
    v_mfma_f32_16x16x32_bf16 v[164:167], v[120:123], v[84:87], v[164:167]
    ds_read_b128 v[72:75], v12 offset:40960
    v_mfma_f32_16x16x32_bf16 v[168:171], v[120:123], v[88:91], v[168:171]
    ds_read_b128 v[76:79], v12 offset:61440
    v_mfma_f32_16x16x32_bf16 v[172:175], v[120:123], v[92:95], v[172:175]
    v_mfma_f32_16x16x32_bf16 v[176:179], v[124:127], v[80:83], v[176:179]
    v_mfma_f32_16x16x32_bf16 v[180:183], v[124:127], v[84:87], v[180:183]
    v_mfma_f32_16x16x32_bf16 v[184:187], v[124:127], v[88:91], v[184:187]
    v_mfma_f32_16x16x32_bf16 v[188:191], v[124:127], v[92:95], v[188:191]
    s_waitcnt lgkmcnt(0)
    s_barrier
    v_add_u32 v13, s40, v13
    ds_read_b64_tr_b16 v[112:113], v4 offset:0
    v_mfma_f32_16x16x32_bf16 v[128:131], v[96:99], v[64:67], v[128:131]
    ds_read_b64_tr_b16 v[114:115], v4 offset:512
    v_mfma_f32_16x16x32_bf16 v[132:135], v[96:99], v[68:71], v[132:135]
    ds_read_b64_tr_b16 v[116:117], v5 offset:0
    v_mfma_f32_16x16x32_bf16 v[136:139], v[96:99], v[72:75], v[136:139]
    ds_read_b64_tr_b16 v[118:119], v5 offset:512
    v_mfma_f32_16x16x32_bf16 v[140:143], v[96:99], v[76:79], v[140:143]
    ds_read_b64_tr_b16 v[120:121], v6 offset:0
    v_mfma_f32_16x16x32_bf16 v[144:147], v[100:103], v[64:67], v[144:147]
    ds_read_b64_tr_b16 v[122:123], v6 offset:512
    v_mfma_f32_16x16x32_bf16 v[148:151], v[100:103], v[68:71], v[148:151]
    ds_read_b64_tr_b16 v[124:125], v7 offset:0
    v_mfma_f32_16x16x32_bf16 v[152:155], v[100:103], v[72:75], v[152:155]
    ds_read_b64_tr_b16 v[126:127], v7 offset:512
    v_mfma_f32_16x16x32_bf16 v[156:159], v[100:103], v[76:79], v[156:159]
    ds_read_b128 v[80:83], v13 offset:0
    v_mfma_f32_16x16x32_bf16 v[160:163], v[104:107], v[64:67], v[160:163]
    ds_read_b128 v[84:87], v13 offset:20480
    v_mfma_f32_16x16x32_bf16 v[164:167], v[104:107], v[68:71], v[164:167]
    ds_read_b128 v[88:91], v13 offset:40960
    v_mfma_f32_16x16x32_bf16 v[168:171], v[104:107], v[72:75], v[168:171]
    ds_read_b128 v[92:95], v13 offset:61440
    v_mfma_f32_16x16x32_bf16 v[172:175], v[104:107], v[76:79], v[172:175]
    v_mfma_f32_16x16x32_bf16 v[176:179], v[108:111], v[64:67], v[176:179]
    v_mfma_f32_16x16x32_bf16 v[180:183], v[108:111], v[68:71], v[180:183]
    v_mfma_f32_16x16x32_bf16 v[184:187], v[108:111], v[72:75], v[184:187]
    v_mfma_f32_16x16x32_bf16 v[188:191], v[108:111], v[76:79], v[188:191]
    s_waitcnt lgkmcnt(0)
    s_barrier
    v_add_u32 v14, s40, v14
    ds_read_b64_tr_b16 v[96:97], v4 offset:16384
    v_mfma_f32_16x16x32_bf16 v[128:131], v[112:115], v[80:83], v[128:131]
    ds_read_b64_tr_b16 v[98:99], v4 offset:16896
    v_mfma_f32_16x16x32_bf16 v[132:135], v[112:115], v[84:87], v[132:135]
    ds_read_b64_tr_b16 v[100:101], v5 offset:16384
    v_mfma_f32_16x16x32_bf16 v[136:139], v[112:115], v[88:91], v[136:139]
    ds_read_b64_tr_b16 v[102:103], v5 offset:16896
    v_mfma_f32_16x16x32_bf16 v[140:143], v[112:115], v[92:95], v[140:143]
    ds_read_b64_tr_b16 v[104:105], v6 offset:16384
    v_mfma_f32_16x16x32_bf16 v[144:147], v[116:119], v[80:83], v[144:147]
    ds_read_b64_tr_b16 v[106:107], v6 offset:16896
    v_mfma_f32_16x16x32_bf16 v[148:151], v[116:119], v[84:87], v[148:151]
    ds_read_b64_tr_b16 v[108:109], v7 offset:16384
    v_mfma_f32_16x16x32_bf16 v[152:155], v[116:119], v[88:91], v[152:155]
    ds_read_b64_tr_b16 v[110:111], v7 offset:16896
    v_mfma_f32_16x16x32_bf16 v[156:159], v[116:119], v[92:95], v[156:159]
    ds_read_b128 v[64:67], v14 offset:0
    v_mfma_f32_16x16x32_bf16 v[160:163], v[120:123], v[80:83], v[160:163]
    ds_read_b128 v[68:71], v14 offset:20480
    v_mfma_f32_16x16x32_bf16 v[164:167], v[120:123], v[84:87], v[164:167]
    ds_read_b128 v[72:75], v14 offset:40960
    v_mfma_f32_16x16x32_bf16 v[168:171], v[120:123], v[88:91], v[168:171]
    ds_read_b128 v[76:79], v14 offset:61440
    v_mfma_f32_16x16x32_bf16 v[172:175], v[120:123], v[92:95], v[172:175]
    v_mfma_f32_16x16x32_bf16 v[176:179], v[124:127], v[80:83], v[176:179]
    v_mfma_f32_16x16x32_bf16 v[180:183], v[124:127], v[84:87], v[180:183]
    v_mfma_f32_16x16x32_bf16 v[184:187], v[124:127], v[88:91], v[184:187]
    v_mfma_f32_16x16x32_bf16 v[188:191], v[124:127], v[92:95], v[188:191]
    s_waitcnt lgkmcnt(0)
    s_barrier
    v_add_u32 v15, s40, v15
    ds_read_b64_tr_b16 v[112:113], v4 offset:32768
    v_mfma_f32_16x16x32_bf16 v[128:131], v[96:99], v[64:67], v[128:131]
    ds_read_b64_tr_b16 v[114:115], v4 offset:33280
    v_mfma_f32_16x16x32_bf16 v[132:135], v[96:99], v[68:71], v[132:135]
    ds_read_b64_tr_b16 v[116:117], v5 offset:32768
    v_mfma_f32_16x16x32_bf16 v[136:139], v[96:99], v[72:75], v[136:139]
    ds_read_b64_tr_b16 v[118:119], v5 offset:33280
    v_mfma_f32_16x16x32_bf16 v[140:143], v[96:99], v[76:79], v[140:143]
    ds_read_b64_tr_b16 v[120:121], v6 offset:32768
    v_mfma_f32_16x16x32_bf16 v[144:147], v[100:103], v[64:67], v[144:147]
    ds_read_b64_tr_b16 v[122:123], v6 offset:33280
    v_mfma_f32_16x16x32_bf16 v[148:151], v[100:103], v[68:71], v[148:151]
    ds_read_b64_tr_b16 v[124:125], v7 offset:32768
    v_mfma_f32_16x16x32_bf16 v[152:155], v[100:103], v[72:75], v[152:155]
    ds_read_b64_tr_b16 v[126:127], v7 offset:33280
    v_mfma_f32_16x16x32_bf16 v[156:159], v[100:103], v[76:79], v[156:159]
    ds_read_b128 v[80:83], v15 offset:0
    v_mfma_f32_16x16x32_bf16 v[160:163], v[104:107], v[64:67], v[160:163]
    ds_read_b128 v[84:87], v15 offset:20480
    v_mfma_f32_16x16x32_bf16 v[164:167], v[104:107], v[68:71], v[164:167]
    ds_read_b128 v[88:91], v15 offset:40960
    v_mfma_f32_16x16x32_bf16 v[168:171], v[104:107], v[72:75], v[168:171]
    ds_read_b128 v[92:95], v15 offset:61440
    v_mfma_f32_16x16x32_bf16 v[172:175], v[104:107], v[76:79], v[172:175]
    v_mfma_f32_16x16x32_bf16 v[176:179], v[108:111], v[64:67], v[176:179]
    v_mfma_f32_16x16x32_bf16 v[180:183], v[108:111], v[68:71], v[180:183]
    v_mfma_f32_16x16x32_bf16 v[184:187], v[108:111], v[72:75], v[184:187]
    v_mfma_f32_16x16x32_bf16 v[188:191], v[108:111], v[76:79], v[188:191]
    s_waitcnt lgkmcnt(0)
    s_barrier
    v_add_u32 v12, s41, v12
    ds_read_b64_tr_b16 v[96:97], v4 offset:49152
    v_mfma_f32_16x16x32_bf16 v[128:131], v[112:115], v[80:83], v[128:131]
    ds_read_b64_tr_b16 v[98:99], v4 offset:49664
    v_mfma_f32_16x16x32_bf16 v[132:135], v[112:115], v[84:87], v[132:135]
    ds_read_b64_tr_b16 v[100:101], v5 offset:49152
    v_mfma_f32_16x16x32_bf16 v[136:139], v[112:115], v[88:91], v[136:139]
    ds_read_b64_tr_b16 v[102:103], v5 offset:49664
    v_mfma_f32_16x16x32_bf16 v[140:143], v[112:115], v[92:95], v[140:143]
    ds_read_b64_tr_b16 v[104:105], v6 offset:49152
    v_mfma_f32_16x16x32_bf16 v[144:147], v[116:119], v[80:83], v[144:147]
    ds_read_b64_tr_b16 v[106:107], v6 offset:49664
    v_mfma_f32_16x16x32_bf16 v[148:151], v[116:119], v[84:87], v[148:151]
    ds_read_b64_tr_b16 v[108:109], v7 offset:49152
    v_mfma_f32_16x16x32_bf16 v[152:155], v[116:119], v[88:91], v[152:155]
    ds_read_b64_tr_b16 v[110:111], v7 offset:49664
    v_mfma_f32_16x16x32_bf16 v[156:159], v[116:119], v[92:95], v[156:159]
    ds_read_b128 v[64:67], v12 offset:0
    v_mfma_f32_16x16x32_bf16 v[160:163], v[120:123], v[80:83], v[160:163]
    ds_read_b128 v[68:71], v12 offset:20480
    v_mfma_f32_16x16x32_bf16 v[164:167], v[120:123], v[84:87], v[164:167]
    ds_read_b128 v[72:75], v12 offset:40960
    v_mfma_f32_16x16x32_bf16 v[168:171], v[120:123], v[88:91], v[168:171]
    ds_read_b128 v[76:79], v12 offset:61440
    v_mfma_f32_16x16x32_bf16 v[172:175], v[120:123], v[92:95], v[172:175]
    v_mfma_f32_16x16x32_bf16 v[176:179], v[124:127], v[80:83], v[176:179]
    v_mfma_f32_16x16x32_bf16 v[180:183], v[124:127], v[84:87], v[180:183]
    v_mfma_f32_16x16x32_bf16 v[184:187], v[124:127], v[88:91], v[184:187]
    v_mfma_f32_16x16x32_bf16 v[188:191], v[124:127], v[92:95], v[188:191]
    s_waitcnt lgkmcnt(0)
    s_barrier
    v_add_u32 v13, s41, v13
    ds_read_b64_tr_b16 v[112:113], v8 offset:0
    v_mfma_f32_16x16x32_bf16 v[128:131], v[96:99], v[64:67], v[128:131]
    ds_read_b64_tr_b16 v[114:115], v8 offset:512
    v_mfma_f32_16x16x32_bf16 v[132:135], v[96:99], v[68:71], v[132:135]
    ds_read_b64_tr_b16 v[116:117], v9 offset:0
    v_mfma_f32_16x16x32_bf16 v[136:139], v[96:99], v[72:75], v[136:139]
    ds_read_b64_tr_b16 v[118:119], v9 offset:512
    v_mfma_f32_16x16x32_bf16 v[140:143], v[96:99], v[76:79], v[140:143]
    ds_read_b64_tr_b16 v[120:121], v10 offset:0
    v_mfma_f32_16x16x32_bf16 v[144:147], v[100:103], v[64:67], v[144:147]
    ds_read_b64_tr_b16 v[122:123], v10 offset:512
    v_mfma_f32_16x16x32_bf16 v[148:151], v[100:103], v[68:71], v[148:151]
    ds_read_b64_tr_b16 v[124:125], v11 offset:0
    v_mfma_f32_16x16x32_bf16 v[152:155], v[100:103], v[72:75], v[152:155]
    ds_read_b64_tr_b16 v[126:127], v11 offset:512
    v_mfma_f32_16x16x32_bf16 v[156:159], v[100:103], v[76:79], v[156:159]
    ds_read_b128 v[80:83], v13 offset:0
    v_mfma_f32_16x16x32_bf16 v[160:163], v[104:107], v[64:67], v[160:163]
    ds_read_b128 v[84:87], v13 offset:20480
    v_mfma_f32_16x16x32_bf16 v[164:167], v[104:107], v[68:71], v[164:167]
    ds_read_b128 v[88:91], v13 offset:40960
    v_mfma_f32_16x16x32_bf16 v[168:171], v[104:107], v[72:75], v[168:171]
    ds_read_b128 v[92:95], v13 offset:61440
    v_mfma_f32_16x16x32_bf16 v[172:175], v[104:107], v[76:79], v[172:175]
    v_mfma_f32_16x16x32_bf16 v[176:179], v[108:111], v[64:67], v[176:179]
    v_mfma_f32_16x16x32_bf16 v[180:183], v[108:111], v[68:71], v[180:183]
    v_mfma_f32_16x16x32_bf16 v[184:187], v[108:111], v[72:75], v[184:187]
    v_mfma_f32_16x16x32_bf16 v[188:191], v[108:111], v[76:79], v[188:191]
    s_waitcnt lgkmcnt(0)
    s_barrier
    v_add_u32 v14, s41, v14
    ds_read_b64_tr_b16 v[96:97], v4 offset:0
    v_mfma_f32_16x16x32_bf16 v[128:131], v[112:115], v[80:83], v[128:131]
    ds_read_b64_tr_b16 v[98:99], v4 offset:512
    v_mfma_f32_16x16x32_bf16 v[132:135], v[112:115], v[84:87], v[132:135]
    ds_read_b64_tr_b16 v[100:101], v5 offset:0
    v_mfma_f32_16x16x32_bf16 v[136:139], v[112:115], v[88:91], v[136:139]
    ds_read_b64_tr_b16 v[102:103], v5 offset:512
    v_mfma_f32_16x16x32_bf16 v[140:143], v[112:115], v[92:95], v[140:143]
    ds_read_b64_tr_b16 v[104:105], v6 offset:0
    v_mfma_f32_16x16x32_bf16 v[144:147], v[116:119], v[80:83], v[144:147]
    ds_read_b64_tr_b16 v[106:107], v6 offset:512
    v_mfma_f32_16x16x32_bf16 v[148:151], v[116:119], v[84:87], v[148:151]
    ds_read_b64_tr_b16 v[108:109], v7 offset:0
    v_mfma_f32_16x16x32_bf16 v[152:155], v[116:119], v[88:91], v[152:155]
    ds_read_b64_tr_b16 v[110:111], v7 offset:512
    v_mfma_f32_16x16x32_bf16 v[156:159], v[116:119], v[92:95], v[156:159]
    ds_read_b128 v[64:67], v14 offset:0
    v_mfma_f32_16x16x32_bf16 v[160:163], v[120:123], v[80:83], v[160:163]
    ds_read_b128 v[68:71], v14 offset:20480
    v_mfma_f32_16x16x32_bf16 v[164:167], v[120:123], v[84:87], v[164:167]
    ds_read_b128 v[72:75], v14 offset:40960
    v_mfma_f32_16x16x32_bf16 v[168:171], v[120:123], v[88:91], v[168:171]
    ds_read_b128 v[76:79], v14 offset:61440
    v_mfma_f32_16x16x32_bf16 v[172:175], v[120:123], v[92:95], v[172:175]
    v_mfma_f32_16x16x32_bf16 v[176:179], v[124:127], v[80:83], v[176:179]
    v_mfma_f32_16x16x32_bf16 v[180:183], v[124:127], v[84:87], v[180:183]
    v_mfma_f32_16x16x32_bf16 v[184:187], v[124:127], v[88:91], v[184:187]
    v_mfma_f32_16x16x32_bf16 v[188:191], v[124:127], v[92:95], v[188:191]
    s_waitcnt lgkmcnt(0)
    s_barrier
    v_add_u32 v15, s41, v15
    ds_read_b64_tr_b16 v[112:113], v4 offset:16384
    v_mfma_f32_16x16x32_bf16 v[128:131], v[96:99], v[64:67], v[128:131]
    ds_read_b64_tr_b16 v[114:115], v4 offset:16896
    v_mfma_f32_16x16x32_bf16 v[132:135], v[96:99], v[68:71], v[132:135]
    ds_read_b64_tr_b16 v[116:117], v5 offset:16384
    v_mfma_f32_16x16x32_bf16 v[136:139], v[96:99], v[72:75], v[136:139]
    ds_read_b64_tr_b16 v[118:119], v5 offset:16896
    v_mfma_f32_16x16x32_bf16 v[140:143], v[96:99], v[76:79], v[140:143]
    ds_read_b64_tr_b16 v[120:121], v6 offset:16384
    v_mfma_f32_16x16x32_bf16 v[144:147], v[100:103], v[64:67], v[144:147]
    ds_read_b64_tr_b16 v[122:123], v6 offset:16896
    v_mfma_f32_16x16x32_bf16 v[148:151], v[100:103], v[68:71], v[148:151]
    ds_read_b64_tr_b16 v[124:125], v7 offset:16384
    v_mfma_f32_16x16x32_bf16 v[152:155], v[100:103], v[72:75], v[152:155]
    ds_read_b64_tr_b16 v[126:127], v7 offset:16896
    v_mfma_f32_16x16x32_bf16 v[156:159], v[100:103], v[76:79], v[156:159]
    ds_read_b128 v[80:83], v15 offset:0
    v_mfma_f32_16x16x32_bf16 v[160:163], v[104:107], v[64:67], v[160:163]
    ds_read_b128 v[84:87], v15 offset:20480
    v_mfma_f32_16x16x32_bf16 v[164:167], v[104:107], v[68:71], v[164:167]
    ds_read_b128 v[88:91], v15 offset:40960
    v_mfma_f32_16x16x32_bf16 v[168:171], v[104:107], v[72:75], v[168:171]
    ds_read_b128 v[92:95], v15 offset:61440
    v_mfma_f32_16x16x32_bf16 v[172:175], v[104:107], v[76:79], v[172:175]
    v_mfma_f32_16x16x32_bf16 v[176:179], v[108:111], v[64:67], v[176:179]
    v_mfma_f32_16x16x32_bf16 v[180:183], v[108:111], v[68:71], v[180:183]
    v_mfma_f32_16x16x32_bf16 v[184:187], v[108:111], v[72:75], v[184:187]
    v_mfma_f32_16x16x32_bf16 v[188:191], v[108:111], v[76:79], v[188:191]
    s_waitcnt vmcnt(0)
    s_mov_b32 s63, 200000
LN2:
    v_readfirstlane_b32 s62, v251
    s_cmp_lg_u32 s62, 0
    s_cbranch_scc1 LNo2
    s_sub_u32 s63, s63, 1
    s_cmp_eq_u32 s63, 0
    s_cbranch_scc1 LNo2
    buffer_load_dword v251, v252, s[56:59], 0 offen sc1
    s_waitcnt vmcnt(0)
    s_branch LN2
LNo2:
    v_mov_b32 v251, s62
    s_mov_b64 exec, 1
    buffer_store_dword v251, v252, s[32:35], s12 offen sc1
    s_mov_b64 exec, -1
    s_waitcnt lgkmcnt(0)
    s_barrier
    v_add_u32 v12, s42, v12
    ds_read_b64_tr_b16 v[96:97], v4 offset:32768
    v_mfma_f32_16x16x32_bf16 v[128:131], v[112:115], v[80:83], v[128:131]
    ds_read_b64_tr_b16 v[98:99], v4 offset:33280
    v_mfma_f32_16x16x32_bf16 v[132:135], v[112:115], v[84:87], v[132:135]
    ds_read_b64_tr_b16 v[100:101], v5 offset:32768
    v_mfma_f32_16x16x32_bf16 v[136:139], v[112:115], v[88:91], v[136:139]
    ds_read_b64_tr_b16 v[102:103], v5 offset:33280
    v_mfma_f32_16x16x32_bf16 v[140:143], v[112:115], v[92:95], v[140:143]
    ds_read_b64_tr_b16 v[104:105], v6 offset:32768
    v_mfma_f32_16x16x32_bf16 v[144:147], v[116:119], v[80:83], v[144:147]
    ds_read_b64_tr_b16 v[106:107], v6 offset:33280
    v_mfma_f32_16x16x32_bf16 v[148:151], v[116:119], v[84:87], v[148:151]
    ds_read_b64_tr_b16 v[108:109], v7 offset:32768
    v_mfma_f32_16x16x32_bf16 v[152:155], v[116:119], v[88:91], v[152:155]
    ds_read_b64_tr_b16 v[110:111], v7 offset:33280
    v_mfma_f32_16x16x32_bf16 v[156:159], v[116:119], v[92:95], v[156:159]
    ds_read_b128 v[64:67], v12 offset:0
    v_mfma_f32_16x16x32_bf16 v[160:163], v[120:123], v[80:83], v[160:163]
    ds_read_b128 v[68:71], v12 offset:20480
    v_mfma_f32_16x16x32_bf16 v[164:167], v[120:123], v[84:87], v[164:167]
    ds_read_b128 v[72:75], v12 offset:40960
    v_mfma_f32_16x16x32_bf16 v[168:171], v[120:123], v[88:91], v[168:171]
    ds_read_b128 v[76:79], v12 offset:61440
    v_mfma_f32_16x16x32_bf16 v[172:175], v[120:123], v[92:95], v[172:175]
    v_mfma_f32_16x16x32_bf16 v[176:179], v[124:127], v[80:83], v[176:179]
    v_mfma_f32_16x16x32_bf16 v[180:183], v[124:127], v[84:87], v[180:183]
    v_mfma_f32_16x16x32_bf16 v[184:187], v[124:127], v[88:91], v[184:187]
    v_mfma_f32_16x16x32_bf16 v[188:191], v[124:127], v[92:95], v[188:191]
    s_waitcnt lgkmcnt(0)
    s_barrier
    v_add_u32 v13, s42, v13
    ds_read_b64_tr_b16 v[112:113], v4 offset:49152
    v_mfma_f32_16x16x32_bf16 v[128:131], v[96:99], v[64:67], v[128:131]
    ds_read_b64_tr_b16 v[114:115], v4 offset:49664
    v_mfma_f32_16x16x32_bf16 v[132:135], v[96:99], v[68:71], v[132:135]
    ds_read_b64_tr_b16 v[116:117], v5 offset:49152
    v_mfma_f32_16x16x32_bf16 v[136:139], v[96:99], v[72:75], v[136:139]
    ds_read_b64_tr_b16 v[118:119], v5 offset:49664
    v_mfma_f32_16x16x32_bf16 v[140:143], v[96:99], v[76:79], v[140:143]
    ds_read_b64_tr_b16 v[120:121], v6 offset:49152
    v_mfma_f32_16x16x32_bf16 v[144:147], v[100:103], v[64:67], v[144:147]
    ds_read_b64_tr_b16 v[122:123], v6 offset:49664
    v_mfma_f32_16x16x32_bf16 v[148:151], v[100:103], v[68:71], v[148:151]
    ds_read_b64_tr_b16 v[124:125], v7 offset:49152
    v_mfma_f32_16x16x32_bf16 v[152:155], v[100:103], v[72:75], v[152:155]
    ds_read_b64_tr_b16 v[126:127], v7 offset:49664
    v_mfma_f32_16x16x32_bf16 v[156:159], v[100:103], v[76:79], v[156:159]
    ds_read_b128 v[80:83], v13 offset:0
    v_mfma_f32_16x16x32_bf16 v[160:163], v[104:107], v[64:67], v[160:163]
    ds_read_b128 v[84:87], v13 offset:20480
    v_mfma_f32_16x16x32_bf16 v[164:167], v[104:107], v[68:71], v[164:167]
    ds_read_b128 v[88:91], v13 offset:40960
    v_mfma_f32_16x16x32_bf16 v[168:171], v[104:107], v[72:75], v[168:171]
    ds_read_b128 v[92:95], v13 offset:61440
    v_mfma_f32_16x16x32_bf16 v[172:175], v[104:107], v[76:79], v[172:175]
    v_mfma_f32_16x16x32_bf16 v[176:179], v[108:111], v[64:67], v[176:179]
    v_mfma_f32_16x16x32_bf16 v[180:183], v[108:111], v[68:71], v[180:183]
    v_mfma_f32_16x16x32_bf16 v[184:187], v[108:111], v[72:75], v[184:187]
    v_mfma_f32_16x16x32_bf16 v[188:191], v[108:111], v[76:79], v[188:191]
    s_waitcnt lgkmcnt(0)
    s_barrier
    v_add_u32 v14, s42, v14
    ds_read_b64_tr_b16 v[96:97], v8 offset:0
    v_mfma_f32_16x16x32_bf16 v[128:131], v[112:115], v[80:83], v[128:131]
    ds_read_b64_tr_b16 v[98:99], v8 offset:512
    v_mfma_f32_16x16x32_bf16 v[132:135], v[112:115], v[84:87], v[132:135]
    ds_read_b64_tr_b16 v[100:101], v9 offset:0
    v_mfma_f32_16x16x32_bf16 v[136:139], v[112:115], v[88:91], v[136:139]
    ds_read_b64_tr_b16 v[102:103], v9 offset:512
    v_mfma_f32_16x16x32_bf16 v[140:143], v[112:115], v[92:95], v[140:143]
    ds_read_b64_tr_b16 v[104:105], v10 offset:0
    v_mfma_f32_16x16x32_bf16 v[144:147], v[116:119], v[80:83], v[144:147]
    ds_read_b64_tr_b16 v[106:107], v10 offset:512
    v_mfma_f32_16x16x32_bf16 v[148:151], v[116:119], v[84:87], v[148:151]
    ds_read_b64_tr_b16 v[108:109], v11 offset:0
    v_mfma_f32_16x16x32_bf16 v[152:155], v[116:119], v[88:91], v[152:155]
    ds_read_b64_tr_b16 v[110:111], v11 offset:512
    v_mfma_f32_16x16x32_bf16 v[156:159], v[116:119], v[92:95], v[156:159]
    ds_read_b128 v[64:67], v14 offset:0
    v_mfma_f32_16x16x32_bf16 v[160:163], v[120:123], v[80:83], v[160:163]
    ds_read_b128 v[68:71], v14 offset:20480
    v_mfma_f32_16x16x32_bf16 v[164:167], v[120:123], v[84:87], v[164:167]
    ds_read_b128 v[72:75], v14 offset:40960
    v_mfma_f32_16x16x32_bf16 v[168:171], v[120:123], v[88:91], v[168:171]
    ds_read_b128 v[76:79], v14 offset:61440
    v_mfma_f32_16x16x32_bf16 v[172:175], v[120:123], v[92:95], v[172:175]
    v_mfma_f32_16x16x32_bf16 v[176:179], v[124:127], v[80:83], v[176:179]
    v_mfma_f32_16x16x32_bf16 v[180:183], v[124:127], v[84:87], v[180:183]
    v_mfma_f32_16x16x32_bf16 v[184:187], v[124:127], v[88:91], v[184:187]
    v_mfma_f32_16x16x32_bf16 v[188:191], v[124:127], v[92:95], v[188:191]
    s_waitcnt lgkmcnt(0)
    s_barrier
    v_add_u32 v15, s42, v15
    ds_read_b64_tr_b16 v[112:113], v4 offset:0
    v_mfma_f32_16x16x32_bf16 v[128:131], v[96:99], v[64:67], v[128:131]
    ds_read_b64_tr_b16 v[114:115], v4 offset:512
    v_mfma_f32_16x16x32_bf16 v[132:135], v[96:99], v[68:71], v[132:135]
    ds_read_b64_tr_b16 v[116:117], v5 offset:0
    v_mfma_f32_16x16x32_bf16 v[136:139], v[96:99], v[72:75], v[136:139]
    ds_read_b64_tr_b16 v[118:119], v5 offset:512
    v_mfma_f32_16x16x32_bf16 v[140:143], v[96:99], v[76:79], v[140:143]
    ds_read_b64_tr_b16 v[120:121], v6 offset:0
    v_mfma_f32_16x16x32_bf16 v[144:147], v[100:103], v[64:67], v[144:147]
    ds_read_b64_tr_b16 v[122:123], v6 offset:512
    v_mfma_f32_16x16x32_bf16 v[148:151], v[100:103], v[68:71], v[148:151]
    ds_read_b64_tr_b16 v[124:125], v7 offset:0
    v_mfma_f32_16x16x32_bf16 v[152:155], v[100:103], v[72:75], v[152:155]
    ds_read_b64_tr_b16 v[126:127], v7 offset:512
    v_mfma_f32_16x16x32_bf16 v[156:159], v[100:103], v[76:79], v[156:159]
    ds_read_b128 v[80:83], v15 offset:0
    v_mfma_f32_16x16x32_bf16 v[160:163], v[104:107], v[64:67], v[160:163]
    ds_read_b128 v[84:87], v15 offset:20480
    v_mfma_f32_16x16x32_bf16 v[164:167], v[104:107], v[68:71], v[164:167]
    ds_read_b128 v[88:91], v15 offset:40960
    v_mfma_f32_16x16x32_bf16 v[168:171], v[104:107], v[72:75], v[168:171]
    ds_read_b128 v[92:95], v15 offset:61440
    v_mfma_f32_16x16x32_bf16 v[172:175], v[104:107], v[76:79], v[172:175]
    v_mfma_f32_16x16x32_bf16 v[176:179], v[108:111], v[64:67], v[176:179]
    v_mfma_f32_16x16x32_bf16 v[180:183], v[108:111], v[68:71], v[180:183]
    v_mfma_f32_16x16x32_bf16 v[184:187], v[108:111], v[72:75], v[184:187]
    v_mfma_f32_16x16x32_bf16 v[188:191], v[108:111], v[76:79], v[188:191]
    s_waitcnt lgkmcnt(0)
    s_barrier
    v_add_u32 v12, s43, v12
    ds_read_b64_tr_b16 v[96:97], v4 offset:16384
    v_mfma_f32_16x16x32_bf16 v[128:131], v[112:115], v[80:83], v[128:131]
    ds_read_b64_tr_b16 v[98:99], v4 offset:16896
    v_mfma_f32_16x16x32_bf16 v[132:135], v[112:115], v[84:87], v[132:135]
    ds_read_b64_tr_b16 v[100:101], v5 offset:16384
    v_mfma_f32_16x16x32_bf16 v[136:139], v[112:115], v[88:91], v[136:139]
    ds_read_b64_tr_b16 v[102:103], v5 offset:16896
    v_mfma_f32_16x16x32_bf16 v[140:143], v[112:115], v[92:95], v[140:143]
    ds_read_b64_tr_b16 v[104:105], v6 offset:16384
    v_mfma_f32_16x16x32_bf16 v[144:147], v[116:119], v[80:83], v[144:147]
    ds_read_b64_tr_b16 v[106:107], v6 offset:16896
    v_mfma_f32_16x16x32_bf16 v[148:151], v[116:119], v[84:87], v[148:151]
    ds_read_b64_tr_b16 v[108:109], v7 offset:16384
    v_mfma_f32_16x16x32_bf16 v[152:155], v[116:119], v[88:91], v[152:155]
    ds_read_b64_tr_b16 v[110:111], v7 offset:16896
    v_mfma_f32_16x16x32_bf16 v[156:159], v[116:119], v[92:95], v[156:159]
    ds_read_b128 v[64:67], v12 offset:0
    v_mfma_f32_16x16x32_bf16 v[160:163], v[120:123], v[80:83], v[160:163]
    ds_read_b128 v[68:71], v12 offset:20480
    v_mfma_f32_16x16x32_bf16 v[164:167], v[120:123], v[84:87], v[164:167]
    ds_read_b128 v[72:75], v12 offset:40960
    v_mfma_f32_16x16x32_bf16 v[168:171], v[120:123], v[88:91], v[168:171]
    ds_read_b128 v[76:79], v12 offset:61440
    v_mfma_f32_16x16x32_bf16 v[172:175], v[120:123], v[92:95], v[172:175]
    v_mfma_f32_16x16x32_bf16 v[176:179], v[124:127], v[80:83], v[176:179]
    v_mfma_f32_16x16x32_bf16 v[180:183], v[124:127], v[84:87], v[180:183]
    v_mfma_f32_16x16x32_bf16 v[184:187], v[124:127], v[88:91], v[184:187]
    v_mfma_f32_16x16x32_bf16 v[188:191], v[124:127], v[92:95], v[188:191]
    s_waitcnt lgkmcnt(0)
    s_barrier
    v_add_u32 v13, s43, v13
    ds_read_b64_tr_b16 v[112:113], v4 offset:32768
    v_mfma_f32_16x16x32_bf16 v[128:131], v[96:99], v[64:67], v[128:131]
    ds_read_b64_tr_b16 v[114:115], v4 offset:33280
    v_mfma_f32_16x16x32_bf16 v[132:135], v[96:99], v[68:71], v[132:135]
    ds_read_b64_tr_b16 v[116:117], v5 offset:32768
    v_mfma_f32_16x16x32_bf16 v[136:139], v[96:99], v[72:75], v[136:139]
    ds_read_b64_tr_b16 v[118:119], v5 offset:33280
    v_mfma_f32_16x16x32_bf16 v[140:143], v[96:99], v[76:79], v[140:143]
    ds_read_b64_tr_b16 v[120:121], v6 offset:32768
    v_mfma_f32_16x16x32_bf16 v[144:147], v[100:103], v[64:67], v[144:147]
    ds_read_b64_tr_b16 v[122:123], v6 offset:33280
    v_mfma_f32_16x16x32_bf16 v[148:151], v[100:103], v[68:71], v[148:151]
    ds_read_b64_tr_b16 v[124:125], v7 offset:32768
    v_mfma_f32_16x16x32_bf16 v[152:155], v[100:103], v[72:75], v[152:155]
    ds_read_b64_tr_b16 v[126:127], v7 offset:33280
    v_mfma_f32_16x16x32_bf16 v[156:159], v[100:103], v[76:79], v[156:159]
    ds_read_b128 v[80:83], v13 offset:0
    v_mfma_f32_16x16x32_bf16 v[160:163], v[104:107], v[64:67], v[160:163]
    ds_read_b128 v[84:87], v13 offset:20480
    v_mfma_f32_16x16x32_bf16 v[164:167], v[104:107], v[68:71], v[164:167]
    ds_read_b128 v[88:91], v13 offset:40960
    v_mfma_f32_16x16x32_bf16 v[168:171], v[104:107], v[72:75], v[168:171]
    ds_read_b128 v[92:95], v13 offset:61440
    v_mfma_f32_16x16x32_bf16 v[172:175], v[104:107], v[76:79], v[172:175]
    v_mfma_f32_16x16x32_bf16 v[176:179], v[108:111], v[64:67], v[176:179]
    v_mfma_f32_16x16x32_bf16 v[180:183], v[108:111], v[68:71], v[180:183]
    v_mfma_f32_16x16x32_bf16 v[184:187], v[108:111], v[72:75], v[184:187]
    v_mfma_f32_16x16x32_bf16 v[188:191], v[108:111], v[76:79], v[188:191]
    s_waitcnt lgkmcnt(0)
    s_barrier
    v_add_u32 v14, s43, v14
    ds_read_b64_tr_b16 v[96:97], v4 offset:49152
    v_mfma_f32_16x16x32_bf16 v[128:131], v[112:115], v[80:83], v[128:131]
    ds_read_b64_tr_b16 v[98:99], v4 offset:49664
    v_mfma_f32_16x16x32_bf16 v[132:135], v[112:115], v[84:87], v[132:135]
    ds_read_b64_tr_b16 v[100:101], v5 offset:49152
    v_mfma_f32_16x16x32_bf16 v[136:139], v[112:115], v[88:91], v[136:139]
    ds_read_b64_tr_b16 v[102:103], v5 offset:49664
    v_mfma_f32_16x16x32_bf16 v[140:143], v[112:115], v[92:95], v[140:143]
    ds_read_b64_tr_b16 v[104:105], v6 offset:49152
    v_mfma_f32_16x16x32_bf16 v[144:147], v[116:119], v[80:83], v[144:147]
    ds_read_b64_tr_b16 v[106:107], v6 offset:49664
    v_mfma_f32_16x16x32_bf16 v[148:151], v[116:119], v[84:87], v[148:151]
    ds_read_b64_tr_b16 v[108:109], v7 offset:49152
    v_mfma_f32_16x16x32_bf16 v[152:155], v[116:119], v[88:91], v[152:155]
    ds_read_b64_tr_b16 v[110:111], v7 offset:49664
    v_mfma_f32_16x16x32_bf16 v[156:159], v[116:119], v[92:95], v[156:159]
    ds_read_b128 v[64:67], v14 offset:0
    v_mfma_f32_16x16x32_bf16 v[160:163], v[120:123], v[80:83], v[160:163]
    ds_read_b128 v[68:71], v14 offset:20480
    v_mfma_f32_16x16x32_bf16 v[164:167], v[120:123], v[84:87], v[164:167]
    ds_read_b128 v[72:75], v14 offset:40960
    v_mfma_f32_16x16x32_bf16 v[168:171], v[120:123], v[88:91], v[168:171]
    ds_read_b128 v[76:79], v14 offset:61440
    v_mfma_f32_16x16x32_bf16 v[172:175], v[120:123], v[92:95], v[172:175]
    v_mfma_f32_16x16x32_bf16 v[176:179], v[124:127], v[80:83], v[176:179]
    v_mfma_f32_16x16x32_bf16 v[180:183], v[124:127], v[84:87], v[180:183]
    v_mfma_f32_16x16x32_bf16 v[184:187], v[124:127], v[88:91], v[184:187]
    v_mfma_f32_16x16x32_bf16 v[188:191], v[124:127], v[92:95], v[188:191]
    s_waitcnt lgkmcnt(0)
    v_add_u32 v15, s43, v15
    ds_read_b64_tr_b16 v[112:113], v8 offset:0
    v_mfma_f32_16x16x32_bf16 v[128:131], v[96:99], v[64:67], v[128:131]
    ds_read_b64_tr_b16 v[114:115], v8 offset:512
    v_mfma_f32_16x16x32_bf16 v[132:135], v[96:99], v[68:71], v[132:135]
    ds_read_b64_tr_b16 v[116:117], v9 offset:0
    v_mfma_f32_16x16x32_bf16 v[136:139], v[96:99], v[72:75], v[136:139]
    ds_read_b64_tr_b16 v[118:119], v9 offset:512
    v_mfma_f32_16x16x32_bf16 v[140:143], v[96:99], v[76:79], v[140:143]
    ds_read_b64_tr_b16 v[120:121], v10 offset:0
    v_mfma_f32_16x16x32_bf16 v[144:147], v[100:103], v[64:67], v[144:147]
    ds_read_b64_tr_b16 v[122:123], v10 offset:512
    v_mfma_f32_16x16x32_bf16 v[148:151], v[100:103], v[68:71], v[148:151]
    ds_read_b64_tr_b16 v[124:125], v11 offset:0
    v_mfma_f32_16x16x32_bf16 v[152:155], v[100:103], v[72:75], v[152:155]
    ds_read_b64_tr_b16 v[126:127], v11 offset:512
    v_mfma_f32_16x16x32_bf16 v[156:159], v[100:103], v[76:79], v[156:159]
    ds_read_b128 v[80:83], v15 offset:0
    v_mfma_f32_16x16x32_bf16 v[160:163], v[104:107], v[64:67], v[160:163]
    ds_read_b128 v[84:87], v15 offset:20480
    v_mfma_f32_16x16x32_bf16 v[164:167], v[104:107], v[68:71], v[164:167]
    ds_read_b128 v[88:91], v15 offset:40960
    v_mfma_f32_16x16x32_bf16 v[168:171], v[104:107], v[72:75], v[168:171]
    ds_read_b128 v[92:95], v15 offset:61440
    v_mfma_f32_16x16x32_bf16 v[172:175], v[104:107], v[76:79], v[172:175]
    v_mfma_f32_16x16x32_bf16 v[176:179], v[108:111], v[64:67], v[176:179]
    v_mfma_f32_16x16x32_bf16 v[180:183], v[108:111], v[68:71], v[180:183]
    v_mfma_f32_16x16x32_bf16 v[184:187], v[108:111], v[72:75], v[184:187]
    v_mfma_f32_16x16x32_bf16 v[188:191], v[108:111], v[76:79], v[188:191]
    s_waitcnt lgkmcnt(0)
    v_mfma_f32_16x16x32_bf16 v[128:131], v[112:115], v[80:83], v[128:131]
    v_mfma_f32_16x16x32_bf16 v[132:135], v[112:115], v[84:87], v[132:135]
    v_mfma_f32_16x16x32_bf16 v[136:139], v[112:115], v[88:91], v[136:139]
    v_mfma_f32_16x16x32_bf16 v[140:143], v[112:115], v[92:95], v[140:143]
    v_mfma_f32_16x16x32_bf16 v[144:147], v[116:119], v[80:83], v[144:147]
    v_mfma_f32_16x16x32_bf16 v[148:151], v[116:119], v[84:87], v[148:151]
    v_mfma_f32_16x16x32_bf16 v[152:155], v[116:119], v[88:91], v[152:155]
    v_mfma_f32_16x16x32_bf16 v[156:159], v[116:119], v[92:95], v[156:159]
    v_mfma_f32_16x16x32_bf16 v[160:163], v[120:123], v[80:83], v[160:163]
    v_mfma_f32_16x16x32_bf16 v[164:167], v[120:123], v[84:87], v[164:167]
    v_mfma_f32_16x16x32_bf16 v[168:171], v[120:123], v[88:91], v[168:171]
    v_mfma_f32_16x16x32_bf16 v[172:175], v[120:123], v[92:95], v[172:175]
    v_mfma_f32_16x16x32_bf16 v[176:179], v[124:127], v[80:83], v[176:179]
    v_mfma_f32_16x16x32_bf16 v[180:183], v[124:127], v[84:87], v[180:183]
    v_mfma_f32_16x16x32_bf16 v[184:187], v[124:127], v[88:91], v[184:187]
    v_mfma_f32_16x16x32_bf16 v[188:191], v[124:127], v[92:95], v[188:191]
    s_barrier
    s_lshl_b32 s47, s23, 18
    s_lshl_b32 s4, s16, 9
    s_add_u32 s4, s4, s47
    s_add_u32 s4, s4, 2621440
    s_add_u32 s5, s4, 65536
    s_add_u32 s6, s4, 131072
    s_add_u32 s7, s4, 196608
    v_and_b32 v16, 15, v0
    v_lshrrev_b32 v17, 4, v0
    v_lshlrev_b32 v17, 14, v17
    v_lshl_add_u32 v23, v16, 4, v17
    v_mov_b32 v20, v23
    v_mov_b32 v21, v23
    v_mov_b32 v22, v23
    s_nop 3
    s_mov_b32 s54, 0x3fb8aa3b
    s_mov_b32 s55, 0xb5c1a2a0
    s_mov_b32 s52, 0x358637bd
    v_pk_fma_f32 v[64:65], v[128:129], s[54:55], s[54:55] op_sel:[0,0,1] op_sel_hi:[1,0,1]
    v_pk_fma_f32 v[66:67], v[130:131], s[54:55], s[54:55] op_sel:[0,0,1] op_sel_hi:[1,0,1]
    v_pk_fma_f32 v[68:69], v[132:133], s[54:55], s[54:55] op_sel:[0,0,1] op_sel_hi:[1,0,1]
    v_pk_fma_f32 v[70:71], v[134:135], s[54:55], s[54:55] op_sel:[0,0,1] op_sel_hi:[1,0,1]
    v_exp_f32_e64 v64, v64 clamp
    v_exp_f32_e64 v65, v65 clamp
    v_exp_f32_e64 v66, v66 clamp
    v_exp_f32_e64 v67, v67 clamp
    v_exp_f32_e64 v68, v68 clamp
    v_exp_f32_e64 v69, v69 clamp
    v_exp_f32_e64 v70, v70 clamp
    v_exp_f32_e64 v71, v71 clamp
    v_max_f32 v128, s52, v128
    v_max_f32 v129, s52, v129
    v_max_f32 v130, s52, v130
    v_max_f32 v131, s52, v131
    v_max_f32 v132, s52, v132
    v_max_f32 v133, s52, v133
    v_max_f32 v134, s52, v134
    v_max_f32 v135, s52, v135
    v_pk_add_f32 v[128:129], v[128:129], v[64:65]
    v_pk_add_f32 v[130:131], v[130:131], v[66:67]
    v_pk_add_f32 v[132:133], v[132:133], v[68:69]
    v_pk_add_f32 v[134:135], v[134:135], v[70:71]
    v_pk_fma_f32 v[64:65], v[136:137], s[54:55], s[54:55] op_sel:[0,0,1] op_sel_hi:[1,0,1]
    v_pk_fma_f32 v[66:67], v[138:139], s[54:55], s[54:55] op_sel:[0,0,1] op_sel_hi:[1,0,1]
    v_pk_fma_f32 v[68:69], v[140:141], s[54:55], s[54:55] op_sel:[0,0,1] op_sel_hi:[1,0,1]
    v_pk_fma_f32 v[70:71], v[142:143], s[54:55], s[54:55] op_sel:[0,0,1] op_sel_hi:[1,0,1]
    v_exp_f32_e64 v64, v64 clamp
    v_exp_f32_e64 v65, v65 clamp
    v_exp_f32_e64 v66, v66 clamp
    v_exp_f32_e64 v67, v67 clamp
    v_exp_f32_e64 v68, v68 clamp
    v_exp_f32_e64 v69, v69 clamp
    v_exp_f32_e64 v70, v70 clamp
    v_exp_f32_e64 v71, v71 clamp
    v_max_f32 v136, s52, v136
    v_max_f32 v137, s52, v137
    v_max_f32 v138, s52, v138
    v_max_f32 v139, s52, v139
    v_max_f32 v140, s52, v140
    v_max_f32 v141, s52, v141
    v_max_f32 v142, s52, v142
    v_max_f32 v143, s52, v143
    v_pk_add_f32 v[136:137], v[136:137], v[64:65]
    v_pk_add_f32 v[138:139], v[138:139], v[66:67]
    v_pk_add_f32 v[140:141], v[140:141], v[68:69]
    v_pk_add_f32 v[142:143], v[142:143], v[70:71]
    v_cvt_pk_bf16_f32 v208, v128, v129
    v_cvt_pk_bf16_f32 v209, v130, v131
    v_cvt_pk_bf16_f32 v210, v132, v133
    v_cvt_pk_bf16_f32 v211, v134, v135
    v_cvt_pk_bf16_f32 v212, v136, v137
    v_cvt_pk_bf16_f32 v213, v138, v139
    v_cvt_pk_bf16_f32 v214, v140, v141
    v_cvt_pk_bf16_f32 v215, v142, v143
    s_mov_b32 s54, 0x3fb8aa3b
    s_mov_b32 s55, 0xb5c1a2a0
    s_mov_b32 s52, 0x358637bd
    v_pk_fma_f32 v[64:65], v[144:145], s[54:55], s[54:55] op_sel:[0,0,1] op_sel_hi:[1,0,1]
    v_pk_fma_f32 v[66:67], v[146:147], s[54:55], s[54:55] op_sel:[0,0,1] op_sel_hi:[1,0,1]
    v_pk_fma_f32 v[68:69], v[148:149], s[54:55], s[54:55] op_sel:[0,0,1] op_sel_hi:[1,0,1]
    v_pk_fma_f32 v[70:71], v[150:151], s[54:55], s[54:55] op_sel:[0,0,1] op_sel_hi:[1,0,1]
    v_exp_f32_e64 v64, v64 clamp
    v_exp_f32_e64 v65, v65 clamp
    v_exp_f32_e64 v66, v66 clamp
    v_exp_f32_e64 v67, v67 clamp
    v_exp_f32_e64 v68, v68 clamp
    v_exp_f32_e64 v69, v69 clamp
    v_exp_f32_e64 v70, v70 clamp
    v_exp_f32_e64 v71, v71 clamp
    v_max_f32 v144, s52, v144
    v_max_f32 v145, s52, v145
    v_max_f32 v146, s52, v146
    v_max_f32 v147, s52, v147
    v_max_f32 v148, s52, v148
    v_max_f32 v149, s52, v149
    v_max_f32 v150, s52, v150
    v_max_f32 v151, s52, v151
    v_pk_add_f32 v[144:145], v[144:145], v[64:65]
    v_pk_add_f32 v[146:147], v[146:147], v[66:67]
    v_pk_add_f32 v[148:149], v[148:149], v[68:69]
    v_pk_add_f32 v[150:151], v[150:151], v[70:71]
    v_pk_fma_f32 v[64:65], v[152:153], s[54:55], s[54:55] op_sel:[0,0,1] op_sel_hi:[1,0,1]
    v_pk_fma_f32 v[66:67], v[154:155], s[54:55], s[54:55] op_sel:[0,0,1] op_sel_hi:[1,0,1]
    v_pk_fma_f32 v[68:69], v[156:157], s[54:55], s[54:55] op_sel:[0,0,1] op_sel_hi:[1,0,1]
    v_pk_fma_f32 v[70:71], v[158:159], s[54:55], s[54:55] op_sel:[0,0,1] op_sel_hi:[1,0,1]
    v_exp_f32_e64 v64, v64 clamp
    v_exp_f32_e64 v65, v65 clamp
    v_exp_f32_e64 v66, v66 clamp
    v_exp_f32_e64 v67, v67 clamp
    v_exp_f32_e64 v68, v68 clamp
    v_exp_f32_e64 v69, v69 clamp
    v_exp_f32_e64 v70, v70 clamp
    v_exp_f32_e64 v71, v71 clamp
    v_max_f32 v152, s52, v152
    v_max_f32 v153, s52, v153
    v_max_f32 v154, s52, v154
    v_max_f32 v155, s52, v155
    v_max_f32 v156, s52, v156
    v_max_f32 v157, s52, v157
    v_max_f32 v158, s52, v158
    v_max_f32 v159, s52, v159
    v_pk_add_f32 v[152:153], v[152:153], v[64:65]
    v_pk_add_f32 v[154:155], v[154:155], v[66:67]
    v_pk_add_f32 v[156:157], v[156:157], v[68:69]
    v_pk_add_f32 v[158:159], v[158:159], v[70:71]
    v_cvt_pk_bf16_f32 v216, v144, v145
    v_cvt_pk_bf16_f32 v217, v146, v147
    v_cvt_pk_bf16_f32 v218, v148, v149
    v_cvt_pk_bf16_f32 v219, v150, v151
    v_cvt_pk_bf16_f32 v220, v152, v153
    v_cvt_pk_bf16_f32 v221, v154, v155
    v_cvt_pk_bf16_f32 v222, v156, v157
    v_cvt_pk_bf16_f32 v223, v158, v159
    s_mov_b32 s54, 0x3fb8aa3b
    s_mov_b32 s55, 0xb5c1a2a0
    s_mov_b32 s52, 0x358637bd
    v_pk_fma_f32 v[64:65], v[160:161], s[54:55], s[54:55] op_sel:[0,0,1] op_sel_hi:[1,0,1]
    v_pk_fma_f32 v[66:67], v[162:163], s[54:55], s[54:55] op_sel:[0,0,1] op_sel_hi:[1,0,1]
    v_pk_fma_f32 v[68:69], v[164:165], s[54:55], s[54:55] op_sel:[0,0,1] op_sel_hi:[1,0,1]
    v_pk_fma_f32 v[70:71], v[166:167], s[54:55], s[54:55] op_sel:[0,0,1] op_sel_hi:[1,0,1]
    v_exp_f32_e64 v64, v64 clamp
    v_exp_f32_e64 v65, v65 clamp
    v_exp_f32_e64 v66, v66 clamp
    v_exp_f32_e64 v67, v67 clamp
    v_exp_f32_e64 v68, v68 clamp
    v_exp_f32_e64 v69, v69 clamp
    v_exp_f32_e64 v70, v70 clamp
    v_exp_f32_e64 v71, v71 clamp
    v_max_f32 v160, s52, v160
    v_max_f32 v161, s52, v161
    v_max_f32 v162, s52, v162
    v_max_f32 v163, s52, v163
    v_max_f32 v164, s52, v164
    v_max_f32 v165, s52, v165
    v_max_f32 v166, s52, v166
    v_max_f32 v167, s52, v167
    v_pk_add_f32 v[160:161], v[160:161], v[64:65]
    v_pk_add_f32 v[162:163], v[162:163], v[66:67]
    v_pk_add_f32 v[164:165], v[164:165], v[68:69]
    v_pk_add_f32 v[166:167], v[166:167], v[70:71]
    v_pk_fma_f32 v[64:65], v[168:169], s[54:55], s[54:55] op_sel:[0,0,1] op_sel_hi:[1,0,1]
    v_pk_fma_f32 v[66:67], v[170:171], s[54:55], s[54:55] op_sel:[0,0,1] op_sel_hi:[1,0,1]
    v_pk_fma_f32 v[68:69], v[172:173], s[54:55], s[54:55] op_sel:[0,0,1] op_sel_hi:[1,0,1]
    v_pk_fma_f32 v[70:71], v[174:175], s[54:55], s[54:55] op_sel:[0,0,1] op_sel_hi:[1,0,1]
    v_exp_f32_e64 v64, v64 clamp
    v_exp_f32_e64 v65, v65 clamp
    v_exp_f32_e64 v66, v66 clamp
    v_exp_f32_e64 v67, v67 clamp
    v_exp_f32_e64 v68, v68 clamp
    v_exp_f32_e64 v69, v69 clamp
    v_exp_f32_e64 v70, v70 clamp
    v_exp_f32_e64 v71, v71 clamp
    v_max_f32 v168, s52, v168
    v_max_f32 v169, s52, v169
    v_max_f32 v170, s52, v170
    v_max_f32 v171, s52, v171
    v_max_f32 v172, s52, v172
    v_max_f32 v173, s52, v173
    v_max_f32 v174, s52, v174
    v_max_f32 v175, s52, v175
    v_pk_add_f32 v[168:169], v[168:169], v[64:65]
    v_pk_add_f32 v[170:171], v[170:171], v[66:67]
    v_pk_add_f32 v[172:173], v[172:173], v[68:69]
    v_pk_add_f32 v[174:175], v[174:175], v[70:71]
    v_cvt_pk_bf16_f32 v224, v160, v161
    v_cvt_pk_bf16_f32 v225, v162, v163
    v_cvt_pk_bf16_f32 v226, v164, v165
    v_cvt_pk_bf16_f32 v227, v166, v167
    v_cvt_pk_bf16_f32 v228, v168, v169
    v_cvt_pk_bf16_f32 v229, v170, v171
    v_cvt_pk_bf16_f32 v230, v172, v173
    v_cvt_pk_bf16_f32 v231, v174, v175
    s_mov_b32 s54, 0x3fb8aa3b
    s_mov_b32 s55, 0xb5c1a2a0
    s_mov_b32 s52, 0x358637bd
    v_pk_fma_f32 v[64:65], v[176:177], s[54:55], s[54:55] op_sel:[0,0,1] op_sel_hi:[1,0,1]
    v_pk_fma_f32 v[66:67], v[178:179], s[54:55], s[54:55] op_sel:[0,0,1] op_sel_hi:[1,0,1]
    v_pk_fma_f32 v[68:69], v[180:181], s[54:55], s[54:55] op_sel:[0,0,1] op_sel_hi:[1,0,1]
    v_pk_fma_f32 v[70:71], v[182:183], s[54:55], s[54:55] op_sel:[0,0,1] op_sel_hi:[1,0,1]
    v_exp_f32_e64 v64, v64 clamp
    v_exp_f32_e64 v65, v65 clamp
    v_exp_f32_e64 v66, v66 clamp
    v_exp_f32_e64 v67, v67 clamp
    v_exp_f32_e64 v68, v68 clamp
    v_exp_f32_e64 v69, v69 clamp
    v_exp_f32_e64 v70, v70 clamp
    v_exp_f32_e64 v71, v71 clamp
    v_max_f32 v176, s52, v176
    v_max_f32 v177, s52, v177
    v_max_f32 v178, s52, v178
    v_max_f32 v179, s52, v179
    v_max_f32 v180, s52, v180
    v_max_f32 v181, s52, v181
    v_max_f32 v182, s52, v182
    v_max_f32 v183, s52, v183
    v_pk_add_f32 v[176:177], v[176:177], v[64:65]
    v_pk_add_f32 v[178:179], v[178:179], v[66:67]
    v_pk_add_f32 v[180:181], v[180:181], v[68:69]
    v_pk_add_f32 v[182:183], v[182:183], v[70:71]
    v_pk_fma_f32 v[64:65], v[184:185], s[54:55], s[54:55] op_sel:[0,0,1] op_sel_hi:[1,0,1]
    v_pk_fma_f32 v[66:67], v[186:187], s[54:55], s[54:55] op_sel:[0,0,1] op_sel_hi:[1,0,1]
    v_pk_fma_f32 v[68:69], v[188:189], s[54:55], s[54:55] op_sel:[0,0,1] op_sel_hi:[1,0,1]
    v_pk_fma_f32 v[70:71], v[190:191], s[54:55], s[54:55] op_sel:[0,0,1] op_sel_hi:[1,0,1]
    v_exp_f32_e64 v64, v64 clamp
    v_exp_f32_e64 v65, v65 clamp
    v_exp_f32_e64 v66, v66 clamp
    v_exp_f32_e64 v67, v67 clamp
    v_exp_f32_e64 v68, v68 clamp
    v_exp_f32_e64 v69, v69 clamp
    v_exp_f32_e64 v70, v70 clamp
    v_exp_f32_e64 v71, v71 clamp
    v_max_f32 v184, s52, v184
    v_max_f32 v185, s52, v185
    v_max_f32 v186, s52, v186
    v_max_f32 v187, s52, v187
    v_max_f32 v188, s52, v188
    v_max_f32 v189, s52, v189
    v_max_f32 v190, s52, v190
    v_max_f32 v191, s52, v191
    v_pk_add_f32 v[184:185], v[184:185], v[64:65]
    v_pk_add_f32 v[186:187], v[186:187], v[66:67]
    v_pk_add_f32 v[188:189], v[188:189], v[68:69]
    v_pk_add_f32 v[190:191], v[190:191], v[70:71]
    v_cvt_pk_bf16_f32 v232, v176, v177
    v_cvt_pk_bf16_f32 v233, v178, v179
    v_cvt_pk_bf16_f32 v234, v180, v181
    v_cvt_pk_bf16_f32 v235, v182, v183
    v_cvt_pk_bf16_f32 v236, v184, v185
    v_cvt_pk_bf16_f32 v237, v186, v187
    v_cvt_pk_bf16_f32 v238, v188, v189
    v_cvt_pk_bf16_f32 v239, v190, v191
LA_done:
    s_add_u32 s12, s12, 32768
    s_cmp_lt_u32 s15, 27
    s_cbranch_scc1 L_cb
    buffer_store_dwordx4 v[208:211], v20, s[32:35], s4 offen offset:0 sc1
    buffer_store_dwordx4 v[212:215], v21, s[32:35], s4 offen offset:256 sc1
    buffer_store_dwordx4 v[216:219], v22, s[32:35], s5 offen offset:0 sc1
    buffer_store_dwordx4 v[220:223], v23, s[32:35], s5 offen offset:256 sc1
    buffer_store_dwordx4 v[224:227], v20, s[32:35], s6 offen offset:0 sc1
    buffer_store_dwordx4 v[228:231], v21, s[32:35], s6 offen offset:256 sc1
    buffer_store_dwordx4 v[232:235], v22, s[32:35], s7 offen offset:0 sc1
    buffer_store_dwordx4 v[236:239], v23, s[32:35], s7 offen offset:256 sc1
    s_sub_u32 s21, s15, 27
    s_cmp_ge_u32 s21, 4
    s_cbranch_scc1 L_npt2
    s_lshl_b32 s22, s14, 2
    s_add_u32 s21, s21, s22
    s_lshr_b32 s22, s21, 1
    s_mul_i32 s22, s22, 5
    s_add_u32 s22, s22, 2
    v_lshrrev_b32 v16, 2, v0
    v_mul_u32_u24 v16, 81920, v16
    v_bfe_u32 v17, v0, 1, 1
    v_lshl_add_u32 v16, v17, 11, v16
    v_and_b32 v17, 1, v0
    v_lshl_add_u32 v16, v17, 7, v16
    s_lshr_b32 s37, s22, 2
    s_lshl_b32 s37, s37, 12
    s_and_b32 s22, s22, 3
    s_lshl_b32 s22, s22, 8
    s_add_u32 s22, s22, s37
    s_and_b32 s37, s21, 1
    s_lshl_b32 s37, s37, 10
    s_add_u32 s22, s22, s37
    s_mul_i32 s37, s20, 655360
    s_add_u32 s22, s22, s37
    s_add_u32 s22, s22, 14155776
    v_add_u32 v16, s22, v16
    s_lshl_b32 s21, s21, 7
    s_add_u32 s21, s21, 17367040
    v_writelane_b32 v16, s21, 32
    s_mov_b32 exec_hi, 1
    buffer_load_dword v253, v16, s[32:35], 0 offen sc1
    s_mov_b64 exec, -1
L_npt2:
    s_cmp_eq_u32 s15, 31
    s_cbranch_scc1 L_cspare
    s_mov_b32 s37, s12
    s_branch L_head
L_cb:
    s_mov_b32 s48, s74
    s_mov_b32 s49, s75
    s_mov_b32 s50, 0xd80
    s_mov_b32 s51, 0x20000
    s_lshr_b32 s44, s20, 1
    s_and_b32 s45, s20, 1
    s_lshl_b32 s46, s45, 1
    s_add_u32 s46, s46, s44
    s_xor_b32 s47, s46, 1
    v_lshlrev_b32 v18, 4, v0
    s_mul_i32 s21, s44, 3072
    v_add_u32 v4, s21, v18
    v_add_u32 v5, 2048, v18
    v_lshrrev_b32 v16, 2, v0
    v_lshlrev_b32 v16, 7, v16
    v_and_b32 v17, 3, v0
    v_lshl_add_u32 v16, v17, 3, v16
    v_add_u32 v16, 5120, v16
    v_bfe_u32 v17, v0, 3, 2
    v_xor_b32 v6, s46, v17
    v_lshl_add_u32 v6, v6, 5, v16
    v_xor_b32 v7, s47, v17
    v_lshl_add_u32 v7, v7, 5, v16
    s_lshl_b32 s21, s46, 10
    s_add_u32 s21, s21, 5120
    v_add_u32 v8, s21, v18
    s_lshl_b32 s21, s47, 10
    s_add_u32 s21, s21, 5120
    v_add_u32 v9, s21, v18
    v_lshrrev_b32 v16, 4, v0
    v_lshlrev_b32 v16, 3, v16
    s_lshl_b32 s21, s10, 2
    s_add_u32 s21, s21, s46
    s_lshl_b32 s21, s21, 5
    buffer_load_dwordx2 v[44:45], v16, s[48:51], s21 offen
    s_lshl_b32 s21, s10, 2
    s_add_u32 s21, s21, s47
    s_lshl_b32 s21, s21, 5
    buffer_load_dwordx2 v[46:47], v16, s[48:51], s21 offen
    s_bfe_u32 s8, s16, 0x10002
    buffer_store_dwordx4 v[208:211], v20, s[32:35], s4 offen offset:0 sc1
    buffer_store_dwordx4 v[212:215], v21, s[32:35], s4 offen offset:256 sc1
    buffer_store_dwordx4 v[216:219], v22, s[32:35], s5 offen offset:0 sc1
    buffer_store_dwordx4 v[220:223], v23, s[32:35], s5 offen offset:256 sc1
    buffer_store_dwordx4 v[224:227], v20, s[32:35], s6 offen offset:0 sc1
    buffer_store_dwordx4 v[228:231], v21, s[32:35], s6 offen offset:256 sc1
    buffer_store_dwordx4 v[232:235], v22, s[32:35], s7 offen offset:0 sc1
    buffer_store_dwordx4 v[236:239], v23, s[32:35], s7 offen offset:256 sc1
    s_barrier
    v_add_u32 v10, 81920, v4
    v_add_u32 v11, 81920, v5
    v_add_u32 v12, 81920, v6
    v_add_u32 v13, 81920, v7
    ds_read_b64_tr_b16 v[60:61], v12 offset:0
    ds_read_b64_tr_b16 v[62:63], v12 offset:2048
    ds_read_b64_tr_b16 v[64:65], v13 offset:0
    ds_read_b64_tr_b16 v[66:67], v13 offset:2048
    ds_read_b128 v[48:51], v10 offset:0
    ds_read_b128 v[52:55], v10 offset:1024
    ds_read_b128 v[56:59], v11 offset:0
    ds_read_b64_tr_b16 v[80:81], v12 offset:9216
    ds_read_b64_tr_b16 v[82:83], v12 offset:11264
    ds_read_b64_tr_b16 v[84:85], v13 offset:9216
    ds_read_b64_tr_b16 v[86:87], v13 offset:11264
    ds_read_b128 v[68:71], v10 offset:9216
    ds_read_b128 v[72:75], v10 offset:10240
    ds_read_b128 v[76:79], v11 offset:9216
    ds_read_b64_tr_b16 v[100:101], v12 offset:18432
    ds_read_b64_tr_b16 v[102:103], v12 offset:20480
    ds_read_b64_tr_b16 v[104:105], v13 offset:18432
    ds_read_b64_tr_b16 v[106:107], v13 offset:20480
    ds_read_b128 v[88:91], v10 offset:18432
    ds_read_b128 v[92:95], v10 offset:19456
    ds_read_b128 v[96:99], v11 offset:18432
    ds_read_b64_tr_b16 v[120:121], v12 offset:27648
    ds_read_b64_tr_b16 v[122:123], v12 offset:29696
    ds_read_b64_tr_b16 v[124:125], v13 offset:27648
    ds_read_b64_tr_b16 v[126:127], v13 offset:29696
    ds_read_b128 v[108:111], v10 offset:27648
    ds_read_b128 v[112:115], v10 offset:28672
    ds_read_b128 v[116:119], v11 offset:27648
    s_waitcnt lgkmcnt(0)
    s_barrier
    v_add_u32 v10, 118784, v4
    v_add_u32 v11, 118784, v5
    v_add_u32 v12, 118784, v6
    v_add_u32 v13, 118784, v7
    ds_read_b64_tr_b16 v[140:141], v12 offset:0
    ds_read_b64_tr_b16 v[142:143], v12 offset:2048
    v_mfma_f32_16x16x32_bf16 v[24:27], v[60:63], v[48:51], 0
    ds_read_b64_tr_b16 v[144:145], v13 offset:0
    ds_read_b64_tr_b16 v[146:147], v13 offset:2048
    v_mfma_f32_16x16x32_bf16 v[28:31], v[64:67], v[48:51], 0
    ds_read_b128 v[128:131], v10 offset:0
    ds_read_b128 v[132:135], v10 offset:1024
    v_mfma_f32_16x16x32_bf16 v[32:35], v[60:63], v[52:55], 0
    ds_read_b128 v[136:139], v11 offset:0
    ds_read_b64_tr_b16 v[160:161], v12 offset:9216
    v_mfma_f32_16x16x32_bf16 v[36:39], v[64:67], v[52:55], 0
    ds_read_b64_tr_b16 v[162:163], v12 offset:11264
    ds_read_b64_tr_b16 v[164:165], v13 offset:9216
    v_mfma_f32_16x16x32_bf16 v[40:43], v[60:63], v[56:59], 0
    ds_read_b64_tr_b16 v[166:167], v13 offset:11264
    ds_read_b128 v[148:151], v10 offset:9216
    v_mfma_f32_16x16x32_bf16 v[24:27], v[80:83], v[68:71], v[24:27]
    ds_read_b128 v[152:155], v10 offset:10240
    ds_read_b128 v[156:159], v11 offset:9216
    v_mfma_f32_16x16x32_bf16 v[28:31], v[84:87], v[68:71], v[28:31]
    ds_read_b64_tr_b16 v[180:181], v12 offset:18432
    ds_read_b64_tr_b16 v[182:183], v12 offset:20480
    v_mfma_f32_16x16x32_bf16 v[32:35], v[80:83], v[72:75], v[32:35]
    ds_read_b64_tr_b16 v[184:185], v13 offset:18432
    ds_read_b64_tr_b16 v[186:187], v13 offset:20480
    v_mfma_f32_16x16x32_bf16 v[36:39], v[84:87], v[72:75], v[36:39]
    ds_read_b128 v[168:171], v10 offset:18432
    ds_read_b128 v[172:175], v10 offset:19456
    v_mfma_f32_16x16x32_bf16 v[40:43], v[80:83], v[76:79], v[40:43]
    ds_read_b128 v[176:179], v11 offset:18432
    ds_read_b64_tr_b16 v[200:201], v12 offset:27648
    v_mfma_f32_16x16x32_bf16 v[24:27], v[100:103], v[88:91], v[24:27]
    ds_read_b64_tr_b16 v[202:203], v12 offset:29696
    ds_read_b64_tr_b16 v[204:205], v13 offset:27648
    v_mfma_f32_16x16x32_bf16 v[28:31], v[104:107], v[88:91], v[28:31]
    ds_read_b64_tr_b16 v[206:207], v13 offset:29696
    ds_read_b128 v[188:191], v10 offset:27648
    v_mfma_f32_16x16x32_bf16 v[32:35], v[100:103], v[92:95], v[32:35]
    ds_read_b128 v[192:195], v10 offset:28672
    ds_read_b128 v[196:199], v11 offset:27648
    v_mfma_f32_16x16x32_bf16 v[36:39], v[104:107], v[92:95], v[36:39]
    v_mfma_f32_16x16x32_bf16 v[40:43], v[100:103], v[96:99], v[40:43]
    v_mfma_f32_16x16x32_bf16 v[24:27], v[120:123], v[108:111], v[24:27]
    v_mfma_f32_16x16x32_bf16 v[28:31], v[124:127], v[108:111], v[28:31]
    v_mfma_f32_16x16x32_bf16 v[32:35], v[120:123], v[112:115], v[32:35]
    v_mfma_f32_16x16x32_bf16 v[36:39], v[124:127], v[112:115], v[36:39]
    v_mfma_f32_16x16x32_bf16 v[40:43], v[120:123], v[116:119], v[40:43]
    s_waitcnt vmcnt(0)
    v_mov_b32 v251, s62
    s_mov_b64 exec, 1
    buffer_store_dword v251, v252, s[32:35], s12 offen sc1
    s_mov_b64 exec, -1
    s_waitcnt lgkmcnt(0)
    s_barrier
    v_add_u32 v10, 0, v4
    v_add_u32 v11, 0, v5
    v_add_u32 v12, 0, v6
    v_add_u32 v13, 0, v7
    ds_read_b64_tr_b16 v[60:61], v12 offset:0
    ds_read_b64_tr_b16 v[62:63], v12 offset:2048
    v_mfma_f32_16x16x32_bf16 v[24:27], v[140:143], v[128:131], v[24:27]
    ds_read_b64_tr_b16 v[64:65], v13 offset:0
    ds_read_b64_tr_b16 v[66:67], v13 offset:2048
    v_mfma_f32_16x16x32_bf16 v[28:31], v[144:147], v[128:131], v[28:31]
    ds_read_b128 v[48:51], v10 offset:0
    ds_read_b128 v[52:55], v10 offset:1024
    v_mfma_f32_16x16x32_bf16 v[32:35], v[140:143], v[132:135], v[32:35]
    ds_read_b128 v[56:59], v11 offset:0
    ds_read_b64_tr_b16 v[80:81], v12 offset:9216
    v_mfma_f32_16x16x32_bf16 v[36:39], v[144:147], v[132:135], v[36:39]
    ds_read_b64_tr_b16 v[82:83], v12 offset:11264
    ds_read_b64_tr_b16 v[84:85], v13 offset:9216
    v_mfma_f32_16x16x32_bf16 v[40:43], v[140:143], v[136:139], v[40:43]
    ds_read_b64_tr_b16 v[86:87], v13 offset:11264
    ds_read_b128 v[68:71], v10 offset:9216
    v_mfma_f32_16x16x32_bf16 v[24:27], v[160:163], v[148:151], v[24:27]
    ds_read_b128 v[72:75], v10 offset:10240
    ds_read_b128 v[76:79], v11 offset:9216
    v_mfma_f32_16x16x32_bf16 v[28:31], v[164:167], v[148:151], v[28:31]
    ds_read_b64_tr_b16 v[100:101], v12 offset:18432
    ds_read_b64_tr_b16 v[102:103], v12 offset:20480
    v_mfma_f32_16x16x32_bf16 v[32:35], v[160:163], v[152:155], v[32:35]
    ds_read_b64_tr_b16 v[104:105], v13 offset:18432
    ds_read_b64_tr_b16 v[106:107], v13 offset:20480
    v_mfma_f32_16x16x32_bf16 v[36:39], v[164:167], v[152:155], v[36:39]
    ds_read_b128 v[88:91], v10 offset:18432
    ds_read_b128 v[92:95], v10 offset:19456
    v_mfma_f32_16x16x32_bf16 v[40:43], v[160:163], v[156:159], v[40:43]
    ds_read_b128 v[96:99], v11 offset:18432
    ds_read_b64_tr_b16 v[120:121], v12 offset:27648
    v_mfma_f32_16x16x32_bf16 v[24:27], v[180:183], v[168:171], v[24:27]
    ds_read_b64_tr_b16 v[122:123], v12 offset:29696
    ds_read_b64_tr_b16 v[124:125], v13 offset:27648
    v_mfma_f32_16x16x32_bf16 v[28:31], v[184:187], v[168:171], v[28:31]
    ds_read_b64_tr_b16 v[126:127], v13 offset:29696
    ds_read_b128 v[108:111], v10 offset:27648
    v_mfma_f32_16x16x32_bf16 v[32:35], v[180:183], v[172:175], v[32:35]
    ds_read_b128 v[112:115], v10 offset:28672
    ds_read_b128 v[116:119], v11 offset:27648
    v_mfma_f32_16x16x32_bf16 v[36:39], v[184:187], v[172:175], v[36:39]
    v_mfma_f32_16x16x32_bf16 v[40:43], v[180:183], v[176:179], v[40:43]
    v_mfma_f32_16x16x32_bf16 v[24:27], v[200:203], v[188:191], v[24:27]
    v_mfma_f32_16x16x32_bf16 v[28:31], v[204:207], v[188:191], v[28:31]
    v_mfma_f32_16x16x32_bf16 v[32:35], v[200:203], v[192:195], v[32:35]
    v_mfma_f32_16x16x32_bf16 v[36:39], v[204:207], v[192:195], v[36:39]
    v_mfma_f32_16x16x32_bf16 v[40:43], v[200:203], v[196:199], v[40:43]
    s_waitcnt lgkmcnt(0)
    s_barrier
    v_add_u32 v10, 36864, v4
    v_add_u32 v11, 36864, v5
    v_add_u32 v12, 36864, v6
    v_add_u32 v13, 36864, v7
    ds_read_b64_tr_b16 v[140:141], v12 offset:0
    ds_read_b64_tr_b16 v[142:143], v12 offset:2048
    v_mfma_f32_16x16x32_bf16 v[24:27], v[60:63], v[48:51], v[24:27]
    ds_read_b64_tr_b16 v[144:145], v13 offset:0
    ds_read_b64_tr_b16 v[146:147], v13 offset:2048
    v_mfma_f32_16x16x32_bf16 v[28:31], v[64:67], v[48:51], v[28:31]
    ds_read_b128 v[128:131], v10 offset:0
    ds_read_b128 v[132:135], v10 offset:1024
    v_mfma_f32_16x16x32_bf16 v[32:35], v[60:63], v[52:55], v[32:35]
    ds_read_b128 v[136:139], v11 offset:0
    ds_read_b64_tr_b16 v[160:161], v12 offset:9216
    v_mfma_f32_16x16x32_bf16 v[36:39], v[64:67], v[52:55], v[36:39]
    ds_read_b64_tr_b16 v[162:163], v12 offset:11264
    ds_read_b64_tr_b16 v[164:165], v13 offset:9216
    v_mfma_f32_16x16x32_bf16 v[40:43], v[60:63], v[56:59], v[40:43]
    ds_read_b64_tr_b16 v[166:167], v13 offset:11264
    ds_read_b128 v[148:151], v10 offset:9216
    v_mfma_f32_16x16x32_bf16 v[24:27], v[80:83], v[68:71], v[24:27]
    ds_read_b128 v[152:155], v10 offset:10240
    ds_read_b128 v[156:159], v11 offset:9216
    v_mfma_f32_16x16x32_bf16 v[28:31], v[84:87], v[68:71], v[28:31]
    ds_read_b64_tr_b16 v[180:181], v12 offset:18432
    ds_read_b64_tr_b16 v[182:183], v12 offset:20480
    v_mfma_f32_16x16x32_bf16 v[32:35], v[80:83], v[72:75], v[32:35]
    ds_read_b64_tr_b16 v[184:185], v13 offset:18432
    ds_read_b64_tr_b16 v[186:187], v13 offset:20480
    v_mfma_f32_16x16x32_bf16 v[36:39], v[84:87], v[72:75], v[36:39]
    ds_read_b128 v[168:171], v10 offset:18432
    ds_read_b128 v[172:175], v10 offset:19456
    v_mfma_f32_16x16x32_bf16 v[40:43], v[80:83], v[76:79], v[40:43]
    ds_read_b128 v[176:179], v11 offset:18432
    ds_read_b64_tr_b16 v[200:201], v12 offset:27648
    v_mfma_f32_16x16x32_bf16 v[24:27], v[100:103], v[88:91], v[24:27]
    ds_read_b64_tr_b16 v[202:203], v12 offset:29696
    ds_read_b64_tr_b16 v[204:205], v13 offset:27648
    v_mfma_f32_16x16x32_bf16 v[28:31], v[104:107], v[88:91], v[28:31]
    ds_read_b64_tr_b16 v[206:207], v13 offset:29696
    ds_read_b128 v[188:191], v10 offset:27648
    v_mfma_f32_16x16x32_bf16 v[32:35], v[100:103], v[92:95], v[32:35]
    ds_read_b128 v[192:195], v10 offset:28672
    ds_read_b128 v[196:199], v11 offset:27648
    v_mfma_f32_16x16x32_bf16 v[36:39], v[104:107], v[92:95], v[36:39]
    v_mfma_f32_16x16x32_bf16 v[40:43], v[100:103], v[96:99], v[40:43]
    v_mfma_f32_16x16x32_bf16 v[24:27], v[120:123], v[108:111], v[24:27]
    v_mfma_f32_16x16x32_bf16 v[28:31], v[124:127], v[108:111], v[28:31]
    v_mfma_f32_16x16x32_bf16 v[32:35], v[120:123], v[112:115], v[32:35]
    v_mfma_f32_16x16x32_bf16 v[36:39], v[124:127], v[112:115], v[36:39]
    v_mfma_f32_16x16x32_bf16 v[40:43], v[120:123], v[116:119], v[40:43]
    s_waitcnt lgkmcnt(0)
    s_barrier
    v_add_u32 v10, 81920, v4
    v_add_u32 v11, 81920, v5
    v_add_u32 v12, 81920, v6
    v_add_u32 v13, 81920, v7
    ds_read_b64_tr_b16 v[60:61], v12 offset:0
    ds_read_b64_tr_b16 v[62:63], v12 offset:2048
    v_mfma_f32_16x16x32_bf16 v[24:27], v[140:143], v[128:131], v[24:27]
    ds_read_b64_tr_b16 v[64:65], v13 offset:0
    ds_read_b64_tr_b16 v[66:67], v13 offset:2048
    v_mfma_f32_16x16x32_bf16 v[28:31], v[144:147], v[128:131], v[28:31]
    ds_read_b128 v[48:51], v10 offset:0
    ds_read_b128 v[52:55], v10 offset:1024
    v_mfma_f32_16x16x32_bf16 v[32:35], v[140:143], v[132:135], v[32:35]
    ds_read_b128 v[56:59], v11 offset:0
    ds_read_b64_tr_b16 v[80:81], v12 offset:9216
    v_mfma_f32_16x16x32_bf16 v[36:39], v[144:147], v[132:135], v[36:39]
    ds_read_b64_tr_b16 v[82:83], v12 offset:11264
    ds_read_b64_tr_b16 v[84:85], v13 offset:9216
    v_mfma_f32_16x16x32_bf16 v[40:43], v[140:143], v[136:139], v[40:43]
    ds_read_b64_tr_b16 v[86:87], v13 offset:11264
    ds_read_b128 v[68:71], v10 offset:9216
    v_mfma_f32_16x16x32_bf16 v[24:27], v[160:163], v[148:151], v[24:27]
    ds_read_b128 v[72:75], v10 offset:10240
    ds_read_b128 v[76:79], v11 offset:9216
    v_mfma_f32_16x16x32_bf16 v[28:31], v[164:167], v[148:151], v[28:31]
    ds_read_b64_tr_b16 v[100:101], v12 offset:18432
    ds_read_b64_tr_b16 v[102:103], v12 offset:20480
    v_mfma_f32_16x16x32_bf16 v[32:35], v[160:163], v[152:155], v[32:35]
    ds_read_b64_tr_b16 v[104:105], v13 offset:18432
    ds_read_b64_tr_b16 v[106:107], v13 offset:20480
    v_mfma_f32_16x16x32_bf16 v[36:39], v[164:167], v[152:155], v[36:39]
    ds_read_b128 v[88:91], v10 offset:18432
    ds_read_b128 v[92:95], v10 offset:19456
    v_mfma_f32_16x16x32_bf16 v[40:43], v[160:163], v[156:159], v[40:43]
    ds_read_b128 v[96:99], v11 offset:18432
    ds_read_b64_tr_b16 v[120:121], v12 offset:27648
    v_mfma_f32_16x16x32_bf16 v[24:27], v[180:183], v[168:171], v[24:27]
    ds_read_b64_tr_b16 v[122:123], v12 offset:29696
    ds_read_b64_tr_b16 v[124:125], v13 offset:27648
    v_mfma_f32_16x16x32_bf16 v[28:31], v[184:187], v[168:171], v[28:31]
    ds_read_b64_tr_b16 v[126:127], v13 offset:29696
    ds_read_b128 v[108:111], v10 offset:27648
    v_mfma_f32_16x16x32_bf16 v[32:35], v[180:183], v[172:175], v[32:35]
    ds_read_b128 v[112:115], v10 offset:28672
    ds_read_b128 v[116:119], v11 offset:27648
    v_mfma_f32_16x16x32_bf16 v[36:39], v[184:187], v[172:175], v[36:39]
    v_mfma_f32_16x16x32_bf16 v[40:43], v[180:183], v[176:179], v[40:43]
    v_mfma_f32_16x16x32_bf16 v[24:27], v[200:203], v[188:191], v[24:27]
    v_mfma_f32_16x16x32_bf16 v[28:31], v[204:207], v[188:191], v[28:31]
    v_mfma_f32_16x16x32_bf16 v[32:35], v[200:203], v[192:195], v[32:35]
    v_mfma_f32_16x16x32_bf16 v[36:39], v[204:207], v[192:195], v[36:39]
    v_mfma_f32_16x16x32_bf16 v[40:43], v[200:203], v[196:199], v[40:43]
    s_waitcnt lgkmcnt(0)
    s_barrier
    v_add_u32 v10, 118784, v4
    v_add_u32 v11, 118784, v5
    v_add_u32 v12, 118784, v6
    v_add_u32 v13, 118784, v7
    ds_read_b64_tr_b16 v[140:141], v12 offset:0
    ds_read_b64_tr_b16 v[142:143], v12 offset:2048
    v_mfma_f32_16x16x32_bf16 v[24:27], v[60:63], v[48:51], v[24:27]
    ds_read_b64_tr_b16 v[144:145], v13 offset:0
    ds_read_b64_tr_b16 v[146:147], v13 offset:2048
    v_mfma_f32_16x16x32_bf16 v[28:31], v[64:67], v[48:51], v[28:31]
    ds_read_b128 v[128:131], v10 offset:0
    ds_read_b128 v[132:135], v10 offset:1024
    v_mfma_f32_16x16x32_bf16 v[32:35], v[60:63], v[52:55], v[32:35]
    ds_read_b128 v[136:139], v11 offset:0
    ds_read_b64_tr_b16 v[160:161], v12 offset:9216
    v_mfma_f32_16x16x32_bf16 v[36:39], v[64:67], v[52:55], v[36:39]
    ds_read_b64_tr_b16 v[162:163], v12 offset:11264
    ds_read_b64_tr_b16 v[164:165], v13 offset:9216
    v_mfma_f32_16x16x32_bf16 v[40:43], v[60:63], v[56:59], v[40:43]
    ds_read_b64_tr_b16 v[166:167], v13 offset:11264
    ds_read_b128 v[148:151], v10 offset:9216
    v_mfma_f32_16x16x32_bf16 v[24:27], v[80:83], v[68:71], v[24:27]
    ds_read_b128 v[152:155], v10 offset:10240
    ds_read_b128 v[156:159], v11 offset:9216
    v_mfma_f32_16x16x32_bf16 v[28:31], v[84:87], v[68:71], v[28:31]
    ds_read_b64_tr_b16 v[180:181], v12 offset:18432
    ds_read_b64_tr_b16 v[182:183], v12 offset:20480
    v_mfma_f32_16x16x32_bf16 v[32:35], v[80:83], v[72:75], v[32:35]
    ds_read_b64_tr_b16 v[184:185], v13 offset:18432
    ds_read_b64_tr_b16 v[186:187], v13 offset:20480
    v_mfma_f32_16x16x32_bf16 v[36:39], v[84:87], v[72:75], v[36:39]
    ds_read_b128 v[168:171], v10 offset:18432
    ds_read_b128 v[172:175], v10 offset:19456
    v_mfma_f32_16x16x32_bf16 v[40:43], v[80:83], v[76:79], v[40:43]
    ds_read_b128 v[176:179], v11 offset:18432
    ds_read_b64_tr_b16 v[200:201], v12 offset:27648
    v_mfma_f32_16x16x32_bf16 v[24:27], v[100:103], v[88:91], v[24:27]
    ds_read_b64_tr_b16 v[202:203], v12 offset:29696
    ds_read_b64_tr_b16 v[204:205], v13 offset:27648
    v_mfma_f32_16x16x32_bf16 v[28:31], v[104:107], v[88:91], v[28:31]
    ds_read_b64_tr_b16 v[206:207], v13 offset:29696
    ds_read_b128 v[188:191], v10 offset:27648
    v_mfma_f32_16x16x32_bf16 v[32:35], v[100:103], v[92:95], v[32:35]
    ds_read_b128 v[192:195], v10 offset:28672
    ds_read_b128 v[196:199], v11 offset:27648
    v_mfma_f32_16x16x32_bf16 v[36:39], v[104:107], v[92:95], v[36:39]
    v_mfma_f32_16x16x32_bf16 v[40:43], v[100:103], v[96:99], v[40:43]
    v_mfma_f32_16x16x32_bf16 v[24:27], v[120:123], v[108:111], v[24:27]
    v_mfma_f32_16x16x32_bf16 v[28:31], v[124:127], v[108:111], v[28:31]
    v_mfma_f32_16x16x32_bf16 v[32:35], v[120:123], v[112:115], v[32:35]
    v_mfma_f32_16x16x32_bf16 v[36:39], v[124:127], v[112:115], v[36:39]
    v_mfma_f32_16x16x32_bf16 v[40:43], v[120:123], v[116:119], v[40:43]
    s_waitcnt lgkmcnt(0)
    s_barrier
    v_add_u32 v10, 0, v4
    v_add_u32 v11, 0, v5
    v_add_u32 v12, 0, v6
    v_add_u32 v13, 0, v7
    ds_read_b64_tr_b16 v[60:61], v12 offset:0
    ds_read_b64_tr_b16 v[62:63], v12 offset:2048
    v_mfma_f32_16x16x32_bf16 v[24:27], v[140:143], v[128:131], v[24:27]
    ds_read_b64_tr_b16 v[64:65], v13 offset:0
    ds_read_b64_tr_b16 v[66:67], v13 offset:2048
    v_mfma_f32_16x16x32_bf16 v[28:31], v[144:147], v[128:131], v[28:31]
    ds_read_b128 v[48:51], v10 offset:0
    ds_read_b128 v[52:55], v10 offset:1024
    v_mfma_f32_16x16x32_bf16 v[32:35], v[140:143], v[132:135], v[32:35]
    ds_read_b128 v[56:59], v11 offset:0
    ds_read_b64_tr_b16 v[80:81], v12 offset:9216
    v_mfma_f32_16x16x32_bf16 v[36:39], v[144:147], v[132:135], v[36:39]
    ds_read_b64_tr_b16 v[82:83], v12 offset:11264
    ds_read_b64_tr_b16 v[84:85], v13 offset:9216
    v_mfma_f32_16x16x32_bf16 v[40:43], v[140:143], v[136:139], v[40:43]
    ds_read_b64_tr_b16 v[86:87], v13 offset:11264
    ds_read_b128 v[68:71], v10 offset:9216
    v_mfma_f32_16x16x32_bf16 v[24:27], v[160:163], v[148:151], v[24:27]
    ds_read_b128 v[72:75], v10 offset:10240
    ds_read_b128 v[76:79], v11 offset:9216
    v_mfma_f32_16x16x32_bf16 v[28:31], v[164:167], v[148:151], v[28:31]
    ds_read_b64_tr_b16 v[100:101], v12 offset:18432
    ds_read_b64_tr_b16 v[102:103], v12 offset:20480
    v_mfma_f32_16x16x32_bf16 v[32:35], v[160:163], v[152:155], v[32:35]
    ds_read_b64_tr_b16 v[104:105], v13 offset:18432
    ds_read_b64_tr_b16 v[106:107], v13 offset:20480
    v_mfma_f32_16x16x32_bf16 v[36:39], v[164:167], v[152:155], v[36:39]
    ds_read_b128 v[88:91], v10 offset:18432
    ds_read_b128 v[92:95], v10 offset:19456
    v_mfma_f32_16x16x32_bf16 v[40:43], v[160:163], v[156:159], v[40:43]
    ds_read_b128 v[96:99], v11 offset:18432
    ds_read_b64_tr_b16 v[120:121], v12 offset:27648
    v_mfma_f32_16x16x32_bf16 v[24:27], v[180:183], v[168:171], v[24:27]
    ds_read_b64_tr_b16 v[122:123], v12 offset:29696
    ds_read_b64_tr_b16 v[124:125], v13 offset:27648
    v_mfma_f32_16x16x32_bf16 v[28:31], v[184:187], v[168:171], v[28:31]
    ds_read_b64_tr_b16 v[126:127], v13 offset:29696
    ds_read_b128 v[108:111], v10 offset:27648
    v_mfma_f32_16x16x32_bf16 v[32:35], v[180:183], v[172:175], v[32:35]
    ds_read_b128 v[112:115], v10 offset:28672
    ds_read_b128 v[116:119], v11 offset:27648
    v_mfma_f32_16x16x32_bf16 v[36:39], v[184:187], v[172:175], v[36:39]
    v_mfma_f32_16x16x32_bf16 v[40:43], v[180:183], v[176:179], v[40:43]
    v_mfma_f32_16x16x32_bf16 v[24:27], v[200:203], v[188:191], v[24:27]
    v_mfma_f32_16x16x32_bf16 v[28:31], v[204:207], v[188:191], v[28:31]
    v_mfma_f32_16x16x32_bf16 v[32:35], v[200:203], v[192:195], v[32:35]
    v_mfma_f32_16x16x32_bf16 v[36:39], v[204:207], v[192:195], v[36:39]
    v_mfma_f32_16x16x32_bf16 v[40:43], v[200:203], v[196:199], v[40:43]
    s_waitcnt lgkmcnt(0)
    s_barrier
    v_add_u32 v10, 36864, v4
    v_add_u32 v11, 36864, v5
    v_add_u32 v12, 36864, v6
    v_add_u32 v13, 36864, v7
    ds_read_b64_tr_b16 v[140:141], v12 offset:0
    ds_read_b64_tr_b16 v[142:143], v12 offset:2048
    v_mfma_f32_16x16x32_bf16 v[24:27], v[60:63], v[48:51], v[24:27]
    ds_read_b64_tr_b16 v[144:145], v13 offset:0
    ds_read_b64_tr_b16 v[146:147], v13 offset:2048
    v_mfma_f32_16x16x32_bf16 v[28:31], v[64:67], v[48:51], v[28:31]
    ds_read_b128 v[128:131], v10 offset:0
    ds_read_b128 v[132:135], v10 offset:1024
    v_mfma_f32_16x16x32_bf16 v[32:35], v[60:63], v[52:55], v[32:35]
    ds_read_b128 v[136:139], v11 offset:0
    ds_read_b64_tr_b16 v[160:161], v12 offset:9216
    v_mfma_f32_16x16x32_bf16 v[36:39], v[64:67], v[52:55], v[36:39]
    ds_read_b64_tr_b16 v[162:163], v12 offset:11264
    ds_read_b64_tr_b16 v[164:165], v13 offset:9216
    v_mfma_f32_16x16x32_bf16 v[40:43], v[60:63], v[56:59], v[40:43]
    ds_read_b64_tr_b16 v[166:167], v13 offset:11264
    ds_read_b128 v[148:151], v10 offset:9216
    v_mfma_f32_16x16x32_bf16 v[24:27], v[80:83], v[68:71], v[24:27]
    ds_read_b128 v[152:155], v10 offset:10240
    ds_read_b128 v[156:159], v11 offset:9216
    v_mfma_f32_16x16x32_bf16 v[28:31], v[84:87], v[68:71], v[28:31]
    ds_read_b64_tr_b16 v[180:181], v12 offset:18432
    ds_read_b64_tr_b16 v[182:183], v12 offset:20480
    v_mfma_f32_16x16x32_bf16 v[32:35], v[80:83], v[72:75], v[32:35]
    ds_read_b64_tr_b16 v[184:185], v13 offset:18432
    ds_read_b64_tr_b16 v[186:187], v13 offset:20480
    v_mfma_f32_16x16x32_bf16 v[36:39], v[84:87], v[72:75], v[36:39]
    ds_read_b128 v[168:171], v10 offset:18432
    ds_read_b128 v[172:175], v10 offset:19456
    v_mfma_f32_16x16x32_bf16 v[40:43], v[80:83], v[76:79], v[40:43]
    ds_read_b128 v[176:179], v11 offset:18432
    ds_read_b64_tr_b16 v[200:201], v12 offset:27648
    v_mfma_f32_16x16x32_bf16 v[24:27], v[100:103], v[88:91], v[24:27]
    ds_read_b64_tr_b16 v[202:203], v12 offset:29696
    ds_read_b64_tr_b16 v[204:205], v13 offset:27648
    v_mfma_f32_16x16x32_bf16 v[28:31], v[104:107], v[88:91], v[28:31]
    ds_read_b64_tr_b16 v[206:207], v13 offset:29696
    ds_read_b128 v[188:191], v10 offset:27648
    v_mfma_f32_16x16x32_bf16 v[32:35], v[100:103], v[92:95], v[32:35]
    ds_read_b128 v[192:195], v10 offset:28672
    ds_read_b128 v[196:199], v11 offset:27648
    v_mfma_f32_16x16x32_bf16 v[36:39], v[104:107], v[92:95], v[36:39]
    v_mfma_f32_16x16x32_bf16 v[40:43], v[100:103], v[96:99], v[40:43]
    v_mfma_f32_16x16x32_bf16 v[24:27], v[120:123], v[108:111], v[24:27]
    v_mfma_f32_16x16x32_bf16 v[28:31], v[124:127], v[108:111], v[28:31]
    v_mfma_f32_16x16x32_bf16 v[32:35], v[120:123], v[112:115], v[32:35]
    v_mfma_f32_16x16x32_bf16 v[36:39], v[124:127], v[112:115], v[36:39]
    v_mfma_f32_16x16x32_bf16 v[40:43], v[120:123], v[116:119], v[40:43]
    s_waitcnt lgkmcnt(0)
    s_barrier
    v_add_u32 v10, 81920, v4
    v_add_u32 v11, 81920, v5
    v_add_u32 v12, 81920, v6
    v_add_u32 v13, 81920, v7
    ds_read_b64_tr_b16 v[60:61], v12 offset:0
    ds_read_b64_tr_b16 v[62:63], v12 offset:2048
    v_mfma_f32_16x16x32_bf16 v[24:27], v[140:143], v[128:131], v[24:27]
    ds_read_b64_tr_b16 v[64:65], v13 offset:0
    ds_read_b64_tr_b16 v[66:67], v13 offset:2048
    v_mfma_f32_16x16x32_bf16 v[28:31], v[144:147], v[128:131], v[28:31]
    ds_read_b128 v[48:51], v10 offset:0
    ds_read_b128 v[52:55], v10 offset:1024
    v_mfma_f32_16x16x32_bf16 v[32:35], v[140:143], v[132:135], v[32:35]
    ds_read_b128 v[56:59], v11 offset:0
    ds_read_b64_tr_b16 v[80:81], v12 offset:9216
    v_mfma_f32_16x16x32_bf16 v[36:39], v[144:147], v[132:135], v[36:39]
    ds_read_b64_tr_b16 v[82:83], v12 offset:11264
    ds_read_b64_tr_b16 v[84:85], v13 offset:9216
    v_mfma_f32_16x16x32_bf16 v[40:43], v[140:143], v[136:139], v[40:43]
    ds_read_b64_tr_b16 v[86:87], v13 offset:11264
    ds_read_b128 v[68:71], v10 offset:9216
    v_mfma_f32_16x16x32_bf16 v[24:27], v[160:163], v[148:151], v[24:27]
    ds_read_b128 v[72:75], v10 offset:10240
    ds_read_b128 v[76:79], v11 offset:9216
    v_mfma_f32_16x16x32_bf16 v[28:31], v[164:167], v[148:151], v[28:31]
    ds_read_b64_tr_b16 v[100:101], v12 offset:18432
    ds_read_b64_tr_b16 v[102:103], v12 offset:20480
    v_mfma_f32_16x16x32_bf16 v[32:35], v[160:163], v[152:155], v[32:35]
    ds_read_b64_tr_b16 v[104:105], v13 offset:18432
    ds_read_b64_tr_b16 v[106:107], v13 offset:20480
    v_mfma_f32_16x16x32_bf16 v[36:39], v[164:167], v[152:155], v[36:39]
    ds_read_b128 v[88:91], v10 offset:18432
    ds_read_b128 v[92:95], v10 offset:19456
    v_mfma_f32_16x16x32_bf16 v[40:43], v[160:163], v[156:159], v[40:43]
    ds_read_b128 v[96:99], v11 offset:18432
    ds_read_b64_tr_b16 v[120:121], v12 offset:27648
    v_mfma_f32_16x16x32_bf16 v[24:27], v[180:183], v[168:171], v[24:27]
    ds_read_b64_tr_b16 v[122:123], v12 offset:29696
    ds_read_b64_tr_b16 v[124:125], v13 offset:27648
    v_mfma_f32_16x16x32_bf16 v[28:31], v[184:187], v[168:171], v[28:31]
    ds_read_b64_tr_b16 v[126:127], v13 offset:29696
    ds_read_b128 v[108:111], v10 offset:27648
    v_mfma_f32_16x16x32_bf16 v[32:35], v[180:183], v[172:175], v[32:35]
    ds_read_b128 v[112:115], v10 offset:28672
    ds_read_b128 v[116:119], v11 offset:27648
    v_mfma_f32_16x16x32_bf16 v[36:39], v[184:187], v[172:175], v[36:39]
    v_mfma_f32_16x16x32_bf16 v[40:43], v[180:183], v[176:179], v[40:43]
    v_mfma_f32_16x16x32_bf16 v[24:27], v[200:203], v[188:191], v[24:27]
    v_mfma_f32_16x16x32_bf16 v[28:31], v[204:207], v[188:191], v[28:31]
    v_mfma_f32_16x16x32_bf16 v[32:35], v[200:203], v[192:195], v[32:35]
    v_mfma_f32_16x16x32_bf16 v[36:39], v[204:207], v[192:195], v[36:39]
    v_mfma_f32_16x16x32_bf16 v[40:43], v[200:203], v[196:199], v[40:43]
    s_waitcnt lgkmcnt(0)
    s_barrier
    v_add_u32 v10, 118784, v4
    v_add_u32 v11, 118784, v5
    v_add_u32 v12, 118784, v6
    v_add_u32 v13, 118784, v7
    ds_read_b64_tr_b16 v[140:141], v12 offset:0
    ds_read_b64_tr_b16 v[142:143], v12 offset:2048
    v_mfma_f32_16x16x32_bf16 v[24:27], v[60:63], v[48:51], v[24:27]
    ds_read_b64_tr_b16 v[144:145], v13 offset:0
    ds_read_b64_tr_b16 v[146:147], v13 offset:2048
    v_mfma_f32_16x16x32_bf16 v[28:31], v[64:67], v[48:51], v[28:31]
    ds_read_b128 v[128:131], v10 offset:0
    ds_read_b128 v[132:135], v10 offset:1024
    v_mfma_f32_16x16x32_bf16 v[32:35], v[60:63], v[52:55], v[32:35]
    ds_read_b128 v[136:139], v11 offset:0
    ds_read_b64_tr_b16 v[160:161], v12 offset:9216
    v_mfma_f32_16x16x32_bf16 v[36:39], v[64:67], v[52:55], v[36:39]
    ds_read_b64_tr_b16 v[162:163], v12 offset:11264
    ds_read_b64_tr_b16 v[164:165], v13 offset:9216
    v_mfma_f32_16x16x32_bf16 v[40:43], v[60:63], v[56:59], v[40:43]
    ds_read_b64_tr_b16 v[166:167], v13 offset:11264
    ds_read_b128 v[148:151], v10 offset:9216
    v_mfma_f32_16x16x32_bf16 v[24:27], v[80:83], v[68:71], v[24:27]
    ds_read_b128 v[152:155], v10 offset:10240
    ds_read_b128 v[156:159], v11 offset:9216
    v_mfma_f32_16x16x32_bf16 v[28:31], v[84:87], v[68:71], v[28:31]
    ds_read_b64_tr_b16 v[180:181], v12 offset:18432
    ds_read_b64_tr_b16 v[182:183], v12 offset:20480
    v_mfma_f32_16x16x32_bf16 v[32:35], v[80:83], v[72:75], v[32:35]
    ds_read_b64_tr_b16 v[184:185], v13 offset:18432
    ds_read_b64_tr_b16 v[186:187], v13 offset:20480
    v_mfma_f32_16x16x32_bf16 v[36:39], v[84:87], v[72:75], v[36:39]
    ds_read_b128 v[168:171], v10 offset:18432
    ds_read_b128 v[172:175], v10 offset:19456
    v_mfma_f32_16x16x32_bf16 v[40:43], v[80:83], v[76:79], v[40:43]
    ds_read_b128 v[176:179], v11 offset:18432
    ds_read_b64_tr_b16 v[200:201], v12 offset:27648
    v_mfma_f32_16x16x32_bf16 v[24:27], v[100:103], v[88:91], v[24:27]
    ds_read_b64_tr_b16 v[202:203], v12 offset:29696
    ds_read_b64_tr_b16 v[204:205], v13 offset:27648
    v_mfma_f32_16x16x32_bf16 v[28:31], v[104:107], v[88:91], v[28:31]
    ds_read_b64_tr_b16 v[206:207], v13 offset:29696
    ds_read_b128 v[188:191], v10 offset:27648
    v_mfma_f32_16x16x32_bf16 v[32:35], v[100:103], v[92:95], v[32:35]
    ds_read_b128 v[192:195], v10 offset:28672
    ds_read_b128 v[196:199], v11 offset:27648
    v_mfma_f32_16x16x32_bf16 v[36:39], v[104:107], v[92:95], v[36:39]
    v_mfma_f32_16x16x32_bf16 v[40:43], v[100:103], v[96:99], v[40:43]
    v_mfma_f32_16x16x32_bf16 v[24:27], v[120:123], v[108:111], v[24:27]
    v_mfma_f32_16x16x32_bf16 v[28:31], v[124:127], v[108:111], v[28:31]
    v_mfma_f32_16x16x32_bf16 v[32:35], v[120:123], v[112:115], v[32:35]
    v_mfma_f32_16x16x32_bf16 v[36:39], v[124:127], v[112:115], v[36:39]
    v_mfma_f32_16x16x32_bf16 v[40:43], v[120:123], v[116:119], v[40:43]
    s_waitcnt lgkmcnt(0)
    s_barrier
    v_add_u32 v10, 0, v4
    v_add_u32 v11, 0, v5
    v_add_u32 v12, 0, v6
    v_add_u32 v13, 0, v7
    ds_read_b64_tr_b16 v[60:61], v12 offset:0
    ds_read_b64_tr_b16 v[62:63], v12 offset:2048
    v_mfma_f32_16x16x32_bf16 v[24:27], v[140:143], v[128:131], v[24:27]
    ds_read_b64_tr_b16 v[64:65], v13 offset:0
    ds_read_b64_tr_b16 v[66:67], v13 offset:2048
    v_mfma_f32_16x16x32_bf16 v[28:31], v[144:147], v[128:131], v[28:31]
    ds_read_b128 v[48:51], v10 offset:0
    ds_read_b128 v[52:55], v10 offset:1024
    v_mfma_f32_16x16x32_bf16 v[32:35], v[140:143], v[132:135], v[32:35]
    ds_read_b128 v[56:59], v11 offset:0
    ds_read_b64_tr_b16 v[80:81], v12 offset:9216
    v_mfma_f32_16x16x32_bf16 v[36:39], v[144:147], v[132:135], v[36:39]
    ds_read_b64_tr_b16 v[82:83], v12 offset:11264
    ds_read_b64_tr_b16 v[84:85], v13 offset:9216
    v_mfma_f32_16x16x32_bf16 v[40:43], v[140:143], v[136:139], v[40:43]
    ds_read_b64_tr_b16 v[86:87], v13 offset:11264
    ds_read_b128 v[68:71], v10 offset:9216
    v_mfma_f32_16x16x32_bf16 v[24:27], v[160:163], v[148:151], v[24:27]
    ds_read_b128 v[72:75], v10 offset:10240
    ds_read_b128 v[76:79], v11 offset:9216
    v_mfma_f32_16x16x32_bf16 v[28:31], v[164:167], v[148:151], v[28:31]
    ds_read_b64_tr_b16 v[100:101], v12 offset:18432
    ds_read_b64_tr_b16 v[102:103], v12 offset:20480
    v_mfma_f32_16x16x32_bf16 v[32:35], v[160:163], v[152:155], v[32:35]
    ds_read_b64_tr_b16 v[104:105], v13 offset:18432
    ds_read_b64_tr_b16 v[106:107], v13 offset:20480
    v_mfma_f32_16x16x32_bf16 v[36:39], v[164:167], v[152:155], v[36:39]
    ds_read_b128 v[88:91], v10 offset:18432
    ds_read_b128 v[92:95], v10 offset:19456
    v_mfma_f32_16x16x32_bf16 v[40:43], v[160:163], v[156:159], v[40:43]
    ds_read_b128 v[96:99], v11 offset:18432
    ds_read_b64_tr_b16 v[120:121], v12 offset:27648
    v_mfma_f32_16x16x32_bf16 v[24:27], v[180:183], v[168:171], v[24:27]
    ds_read_b64_tr_b16 v[122:123], v12 offset:29696
    ds_read_b64_tr_b16 v[124:125], v13 offset:27648
    v_mfma_f32_16x16x32_bf16 v[28:31], v[184:187], v[168:171], v[28:31]
    ds_read_b64_tr_b16 v[126:127], v13 offset:29696
    ds_read_b128 v[108:111], v10 offset:27648
    v_mfma_f32_16x16x32_bf16 v[32:35], v[180:183], v[172:175], v[32:35]
    ds_read_b128 v[112:115], v10 offset:28672
    ds_read_b128 v[116:119], v11 offset:27648
    v_mfma_f32_16x16x32_bf16 v[36:39], v[184:187], v[172:175], v[36:39]
    v_mfma_f32_16x16x32_bf16 v[40:43], v[180:183], v[176:179], v[40:43]
    v_mfma_f32_16x16x32_bf16 v[24:27], v[200:203], v[188:191], v[24:27]
    v_mfma_f32_16x16x32_bf16 v[28:31], v[204:207], v[188:191], v[28:31]
    v_mfma_f32_16x16x32_bf16 v[32:35], v[200:203], v[192:195], v[32:35]
    v_mfma_f32_16x16x32_bf16 v[36:39], v[204:207], v[192:195], v[36:39]
    v_mfma_f32_16x16x32_bf16 v[40:43], v[200:203], v[196:199], v[40:43]
    s_waitcnt lgkmcnt(0)
    s_barrier
    v_add_u32 v10, 36864, v4
    v_add_u32 v11, 36864, v5
    v_add_u32 v12, 36864, v6
    v_add_u32 v13, 36864, v7
    ds_read_b64_tr_b16 v[140:141], v12 offset:0
    ds_read_b64_tr_b16 v[142:143], v12 offset:2048
    v_mfma_f32_16x16x32_bf16 v[24:27], v[60:63], v[48:51], v[24:27]
    ds_read_b64_tr_b16 v[144:145], v13 offset:0
    ds_read_b64_tr_b16 v[146:147], v13 offset:2048
    v_mfma_f32_16x16x32_bf16 v[28:31], v[64:67], v[48:51], v[28:31]
    ds_read_b128 v[128:131], v10 offset:0
    ds_read_b128 v[132:135], v10 offset:1024
    v_mfma_f32_16x16x32_bf16 v[32:35], v[60:63], v[52:55], v[32:35]
    ds_read_b128 v[136:139], v11 offset:0
    ds_read_b64_tr_b16 v[160:161], v12 offset:9216
    v_mfma_f32_16x16x32_bf16 v[36:39], v[64:67], v[52:55], v[36:39]
    ds_read_b64_tr_b16 v[162:163], v12 offset:11264
    ds_read_b64_tr_b16 v[164:165], v13 offset:9216
    v_mfma_f32_16x16x32_bf16 v[40:43], v[60:63], v[56:59], v[40:43]
    ds_read_b64_tr_b16 v[166:167], v13 offset:11264
    ds_read_b128 v[148:151], v10 offset:9216
    v_mfma_f32_16x16x32_bf16 v[24:27], v[80:83], v[68:71], v[24:27]
    ds_read_b128 v[152:155], v10 offset:10240
    ds_read_b128 v[156:159], v11 offset:9216
    v_mfma_f32_16x16x32_bf16 v[28:31], v[84:87], v[68:71], v[28:31]
    ds_read_b64_tr_b16 v[180:181], v12 offset:18432
    ds_read_b64_tr_b16 v[182:183], v12 offset:20480
    v_mfma_f32_16x16x32_bf16 v[32:35], v[80:83], v[72:75], v[32:35]
    ds_read_b64_tr_b16 v[184:185], v13 offset:18432
    ds_read_b64_tr_b16 v[186:187], v13 offset:20480
    v_mfma_f32_16x16x32_bf16 v[36:39], v[84:87], v[72:75], v[36:39]
    ds_read_b128 v[168:171], v10 offset:18432
    ds_read_b128 v[172:175], v10 offset:19456
    v_mfma_f32_16x16x32_bf16 v[40:43], v[80:83], v[76:79], v[40:43]
    ds_read_b128 v[176:179], v11 offset:18432
    ds_read_b64_tr_b16 v[200:201], v12 offset:27648
    v_mfma_f32_16x16x32_bf16 v[24:27], v[100:103], v[88:91], v[24:27]
    ds_read_b64_tr_b16 v[202:203], v12 offset:29696
    ds_read_b64_tr_b16 v[204:205], v13 offset:27648
    v_mfma_f32_16x16x32_bf16 v[28:31], v[104:107], v[88:91], v[28:31]
    ds_read_b64_tr_b16 v[206:207], v13 offset:29696
    ds_read_b128 v[188:191], v10 offset:27648
    v_mfma_f32_16x16x32_bf16 v[32:35], v[100:103], v[92:95], v[32:35]
    ds_read_b128 v[192:195], v10 offset:28672
    ds_read_b128 v[196:199], v11 offset:27648
    v_mfma_f32_16x16x32_bf16 v[36:39], v[104:107], v[92:95], v[36:39]
    v_mfma_f32_16x16x32_bf16 v[40:43], v[100:103], v[96:99], v[40:43]
    v_mfma_f32_16x16x32_bf16 v[24:27], v[120:123], v[108:111], v[24:27]
    v_mfma_f32_16x16x32_bf16 v[28:31], v[124:127], v[108:111], v[28:31]
    v_mfma_f32_16x16x32_bf16 v[32:35], v[120:123], v[112:115], v[32:35]
    v_mfma_f32_16x16x32_bf16 v[36:39], v[124:127], v[112:115], v[36:39]
    v_mfma_f32_16x16x32_bf16 v[40:43], v[120:123], v[116:119], v[40:43]
    s_waitcnt lgkmcnt(0)
    s_barrier
    v_add_u32 v10, 81920, v4
    v_add_u32 v11, 81920, v5
    v_add_u32 v12, 81920, v6
    v_add_u32 v13, 81920, v7
    ds_read_b64_tr_b16 v[60:61], v12 offset:0
    ds_read_b64_tr_b16 v[62:63], v12 offset:2048
    v_mfma_f32_16x16x32_bf16 v[24:27], v[140:143], v[128:131], v[24:27]
    ds_read_b64_tr_b16 v[64:65], v13 offset:0
    ds_read_b64_tr_b16 v[66:67], v13 offset:2048
    v_mfma_f32_16x16x32_bf16 v[28:31], v[144:147], v[128:131], v[28:31]
    ds_read_b128 v[48:51], v10 offset:0
    ds_read_b128 v[52:55], v10 offset:1024
    v_mfma_f32_16x16x32_bf16 v[32:35], v[140:143], v[132:135], v[32:35]
    ds_read_b128 v[56:59], v11 offset:0
    ds_read_b64_tr_b16 v[80:81], v12 offset:9216
    v_mfma_f32_16x16x32_bf16 v[36:39], v[144:147], v[132:135], v[36:39]
    ds_read_b64_tr_b16 v[82:83], v12 offset:11264
    ds_read_b64_tr_b16 v[84:85], v13 offset:9216
    v_mfma_f32_16x16x32_bf16 v[40:43], v[140:143], v[136:139], v[40:43]
    ds_read_b64_tr_b16 v[86:87], v13 offset:11264
    ds_read_b128 v[68:71], v10 offset:9216
    v_mfma_f32_16x16x32_bf16 v[24:27], v[160:163], v[148:151], v[24:27]
    ds_read_b128 v[72:75], v10 offset:10240
    ds_read_b128 v[76:79], v11 offset:9216
    v_mfma_f32_16x16x32_bf16 v[28:31], v[164:167], v[148:151], v[28:31]
    ds_read_b64_tr_b16 v[100:101], v12 offset:18432
    ds_read_b64_tr_b16 v[102:103], v12 offset:20480
    v_mfma_f32_16x16x32_bf16 v[32:35], v[160:163], v[152:155], v[32:35]
    ds_read_b64_tr_b16 v[104:105], v13 offset:18432
    ds_read_b64_tr_b16 v[106:107], v13 offset:20480
    v_mfma_f32_16x16x32_bf16 v[36:39], v[164:167], v[152:155], v[36:39]
    ds_read_b128 v[88:91], v10 offset:18432
    ds_read_b128 v[92:95], v10 offset:19456
    v_mfma_f32_16x16x32_bf16 v[40:43], v[160:163], v[156:159], v[40:43]
    ds_read_b128 v[96:99], v11 offset:18432
    ds_read_b64_tr_b16 v[120:121], v12 offset:27648
    v_mfma_f32_16x16x32_bf16 v[24:27], v[180:183], v[168:171], v[24:27]
    ds_read_b64_tr_b16 v[122:123], v12 offset:29696
    ds_read_b64_tr_b16 v[124:125], v13 offset:27648
    v_mfma_f32_16x16x32_bf16 v[28:31], v[184:187], v[168:171], v[28:31]
    ds_read_b64_tr_b16 v[126:127], v13 offset:29696
    ds_read_b128 v[108:111], v10 offset:27648
    v_mfma_f32_16x16x32_bf16 v[32:35], v[180:183], v[172:175], v[32:35]
    ds_read_b128 v[112:115], v10 offset:28672
    ds_read_b128 v[116:119], v11 offset:27648
    v_mfma_f32_16x16x32_bf16 v[36:39], v[184:187], v[172:175], v[36:39]
    v_mfma_f32_16x16x32_bf16 v[40:43], v[180:183], v[176:179], v[40:43]
    v_mfma_f32_16x16x32_bf16 v[24:27], v[200:203], v[188:191], v[24:27]
    v_mfma_f32_16x16x32_bf16 v[28:31], v[204:207], v[188:191], v[28:31]
    v_mfma_f32_16x16x32_bf16 v[32:35], v[200:203], v[192:195], v[32:35]
    v_mfma_f32_16x16x32_bf16 v[36:39], v[204:207], v[192:195], v[36:39]
    v_mfma_f32_16x16x32_bf16 v[40:43], v[200:203], v[196:199], v[40:43]
    s_waitcnt lgkmcnt(0)
    s_barrier
    v_add_u32 v10, 118784, v4
    v_add_u32 v11, 118784, v5
    v_add_u32 v12, 118784, v6
    v_add_u32 v13, 118784, v7
    ds_read_b64_tr_b16 v[140:141], v12 offset:0
    ds_read_b64_tr_b16 v[142:143], v12 offset:2048
    v_mfma_f32_16x16x32_bf16 v[24:27], v[60:63], v[48:51], v[24:27]
    ds_read_b64_tr_b16 v[144:145], v13 offset:0
    ds_read_b64_tr_b16 v[146:147], v13 offset:2048
    v_mfma_f32_16x16x32_bf16 v[28:31], v[64:67], v[48:51], v[28:31]
    ds_read_b128 v[128:131], v10 offset:0
    ds_read_b128 v[132:135], v10 offset:1024
    v_mfma_f32_16x16x32_bf16 v[32:35], v[60:63], v[52:55], v[32:35]
    ds_read_b128 v[136:139], v11 offset:0
    ds_read_b64_tr_b16 v[160:161], v12 offset:9216
    v_mfma_f32_16x16x32_bf16 v[36:39], v[64:67], v[52:55], v[36:39]
    ds_read_b64_tr_b16 v[162:163], v12 offset:11264
    ds_read_b64_tr_b16 v[164:165], v13 offset:9216
    v_mfma_f32_16x16x32_bf16 v[40:43], v[60:63], v[56:59], v[40:43]
    ds_read_b64_tr_b16 v[166:167], v13 offset:11264
    ds_read_b128 v[148:151], v10 offset:9216
    v_mfma_f32_16x16x32_bf16 v[24:27], v[80:83], v[68:71], v[24:27]
    ds_read_b128 v[152:155], v10 offset:10240
    ds_read_b128 v[156:159], v11 offset:9216
    v_mfma_f32_16x16x32_bf16 v[28:31], v[84:87], v[68:71], v[28:31]
    ds_read_b64_tr_b16 v[180:181], v12 offset:18432
    ds_read_b64_tr_b16 v[182:183], v12 offset:20480
    v_mfma_f32_16x16x32_bf16 v[32:35], v[80:83], v[72:75], v[32:35]
    ds_read_b64_tr_b16 v[184:185], v13 offset:18432
    ds_read_b64_tr_b16 v[186:187], v13 offset:20480
    v_mfma_f32_16x16x32_bf16 v[36:39], v[84:87], v[72:75], v[36:39]
    ds_read_b128 v[168:171], v10 offset:18432
    ds_read_b128 v[172:175], v10 offset:19456
    v_mfma_f32_16x16x32_bf16 v[40:43], v[80:83], v[76:79], v[40:43]
    ds_read_b128 v[176:179], v11 offset:18432
    ds_read_b64_tr_b16 v[200:201], v12 offset:27648
    v_mfma_f32_16x16x32_bf16 v[24:27], v[100:103], v[88:91], v[24:27]
    ds_read_b64_tr_b16 v[202:203], v12 offset:29696
    ds_read_b64_tr_b16 v[204:205], v13 offset:27648
    v_mfma_f32_16x16x32_bf16 v[28:31], v[104:107], v[88:91], v[28:31]
    ds_read_b64_tr_b16 v[206:207], v13 offset:29696
    ds_read_b128 v[188:191], v10 offset:27648
    v_mfma_f32_16x16x32_bf16 v[32:35], v[100:103], v[92:95], v[32:35]
    ds_read_b128 v[192:195], v10 offset:28672
    ds_read_b128 v[196:199], v11 offset:27648
    v_mfma_f32_16x16x32_bf16 v[36:39], v[104:107], v[92:95], v[36:39]
    v_mfma_f32_16x16x32_bf16 v[40:43], v[100:103], v[96:99], v[40:43]
    v_mfma_f32_16x16x32_bf16 v[24:27], v[120:123], v[108:111], v[24:27]
    v_mfma_f32_16x16x32_bf16 v[28:31], v[124:127], v[108:111], v[28:31]
    v_mfma_f32_16x16x32_bf16 v[32:35], v[120:123], v[112:115], v[32:35]
    v_mfma_f32_16x16x32_bf16 v[36:39], v[124:127], v[112:115], v[36:39]
    v_mfma_f32_16x16x32_bf16 v[40:43], v[120:123], v[116:119], v[40:43]
    s_waitcnt lgkmcnt(0)
    s_barrier
    v_add_u32 v10, 0, v4
    v_add_u32 v11, 0, v5
    v_add_u32 v12, 0, v6
    v_add_u32 v13, 0, v7
    ds_read_b64_tr_b16 v[60:61], v12 offset:0
    ds_read_b64_tr_b16 v[62:63], v12 offset:2048
    v_mfma_f32_16x16x32_bf16 v[24:27], v[140:143], v[128:131], v[24:27]
    ds_read_b64_tr_b16 v[64:65], v13 offset:0
    ds_read_b64_tr_b16 v[66:67], v13 offset:2048
    v_mfma_f32_16x16x32_bf16 v[28:31], v[144:147], v[128:131], v[28:31]
    ds_read_b128 v[48:51], v10 offset:0
    ds_read_b128 v[52:55], v10 offset:1024
    v_mfma_f32_16x16x32_bf16 v[32:35], v[140:143], v[132:135], v[32:35]
    ds_read_b128 v[56:59], v11 offset:0
    ds_read_b64_tr_b16 v[80:81], v12 offset:9216
    v_mfma_f32_16x16x32_bf16 v[36:39], v[144:147], v[132:135], v[36:39]
    ds_read_b64_tr_b16 v[82:83], v12 offset:11264
    ds_read_b64_tr_b16 v[84:85], v13 offset:9216
    v_mfma_f32_16x16x32_bf16 v[40:43], v[140:143], v[136:139], v[40:43]
    ds_read_b64_tr_b16 v[86:87], v13 offset:11264
    ds_read_b128 v[68:71], v10 offset:9216
    v_mfma_f32_16x16x32_bf16 v[24:27], v[160:163], v[148:151], v[24:27]
    ds_read_b128 v[72:75], v10 offset:10240
    ds_read_b128 v[76:79], v11 offset:9216
    v_mfma_f32_16x16x32_bf16 v[28:31], v[164:167], v[148:151], v[28:31]
    ds_read_b64_tr_b16 v[100:101], v12 offset:18432
    ds_read_b64_tr_b16 v[102:103], v12 offset:20480
    v_mfma_f32_16x16x32_bf16 v[32:35], v[160:163], v[152:155], v[32:35]
    ds_read_b64_tr_b16 v[104:105], v13 offset:18432
    ds_read_b64_tr_b16 v[106:107], v13 offset:20480
    v_mfma_f32_16x16x32_bf16 v[36:39], v[164:167], v[152:155], v[36:39]
    ds_read_b128 v[88:91], v10 offset:18432
    ds_read_b128 v[92:95], v10 offset:19456
    v_mfma_f32_16x16x32_bf16 v[40:43], v[160:163], v[156:159], v[40:43]
    ds_read_b128 v[96:99], v11 offset:18432
    ds_read_b64_tr_b16 v[120:121], v12 offset:27648
    v_mfma_f32_16x16x32_bf16 v[24:27], v[180:183], v[168:171], v[24:27]
    ds_read_b64_tr_b16 v[122:123], v12 offset:29696
    ds_read_b64_tr_b16 v[124:125], v13 offset:27648
    v_mfma_f32_16x16x32_bf16 v[28:31], v[184:187], v[168:171], v[28:31]
    ds_read_b64_tr_b16 v[126:127], v13 offset:29696
    ds_read_b128 v[108:111], v10 offset:27648
    v_mfma_f32_16x16x32_bf16 v[32:35], v[180:183], v[172:175], v[32:35]
    ds_read_b128 v[112:115], v10 offset:28672
    ds_read_b128 v[116:119], v11 offset:27648
    v_mfma_f32_16x16x32_bf16 v[36:39], v[184:187], v[172:175], v[36:39]
    v_mfma_f32_16x16x32_bf16 v[40:43], v[180:183], v[176:179], v[40:43]
    v_mfma_f32_16x16x32_bf16 v[24:27], v[200:203], v[188:191], v[24:27]
    v_mfma_f32_16x16x32_bf16 v[28:31], v[204:207], v[188:191], v[28:31]
    v_mfma_f32_16x16x32_bf16 v[32:35], v[200:203], v[192:195], v[32:35]
    v_mfma_f32_16x16x32_bf16 v[36:39], v[204:207], v[192:195], v[36:39]
    v_mfma_f32_16x16x32_bf16 v[40:43], v[200:203], v[196:199], v[40:43]
    s_waitcnt lgkmcnt(0)
    s_barrier
    v_add_u32 v10, 36864, v4
    v_add_u32 v11, 36864, v5
    v_add_u32 v12, 36864, v6
    v_add_u32 v13, 36864, v7
    ds_read_b64_tr_b16 v[140:141], v12 offset:0
    ds_read_b64_tr_b16 v[142:143], v12 offset:2048
    v_mfma_f32_16x16x32_bf16 v[24:27], v[60:63], v[48:51], v[24:27]
    ds_read_b64_tr_b16 v[144:145], v13 offset:0
    ds_read_b64_tr_b16 v[146:147], v13 offset:2048
    v_mfma_f32_16x16x32_bf16 v[28:31], v[64:67], v[48:51], v[28:31]
    ds_read_b128 v[128:131], v10 offset:0
    ds_read_b128 v[132:135], v10 offset:1024
    v_mfma_f32_16x16x32_bf16 v[32:35], v[60:63], v[52:55], v[32:35]
    ds_read_b128 v[136:139], v11 offset:0
    ds_read_b64_tr_b16 v[160:161], v12 offset:9216
    v_mfma_f32_16x16x32_bf16 v[36:39], v[64:67], v[52:55], v[36:39]
    ds_read_b64_tr_b16 v[162:163], v12 offset:11264
    ds_read_b64_tr_b16 v[164:165], v13 offset:9216
    v_mfma_f32_16x16x32_bf16 v[40:43], v[60:63], v[56:59], v[40:43]
    ds_read_b64_tr_b16 v[166:167], v13 offset:11264
    ds_read_b128 v[148:151], v10 offset:9216
    v_mfma_f32_16x16x32_bf16 v[24:27], v[80:83], v[68:71], v[24:27]
    ds_read_b128 v[152:155], v10 offset:10240
    ds_read_b128 v[156:159], v11 offset:9216
    v_mfma_f32_16x16x32_bf16 v[28:31], v[84:87], v[68:71], v[28:31]
    ds_read_b64_tr_b16 v[180:181], v12 offset:18432
    ds_read_b64_tr_b16 v[182:183], v12 offset:20480
    v_mfma_f32_16x16x32_bf16 v[32:35], v[80:83], v[72:75], v[32:35]
    ds_read_b64_tr_b16 v[184:185], v13 offset:18432
    ds_read_b64_tr_b16 v[186:187], v13 offset:20480
    v_mfma_f32_16x16x32_bf16 v[36:39], v[84:87], v[72:75], v[36:39]
    ds_read_b128 v[168:171], v10 offset:18432
    ds_read_b128 v[172:175], v10 offset:19456
    v_mfma_f32_16x16x32_bf16 v[40:43], v[80:83], v[76:79], v[40:43]
    ds_read_b128 v[176:179], v11 offset:18432
    ds_read_b64_tr_b16 v[200:201], v12 offset:27648
    v_mfma_f32_16x16x32_bf16 v[24:27], v[100:103], v[88:91], v[24:27]
    ds_read_b64_tr_b16 v[202:203], v12 offset:29696
    ds_read_b64_tr_b16 v[204:205], v13 offset:27648
    v_mfma_f32_16x16x32_bf16 v[28:31], v[104:107], v[88:91], v[28:31]
    ds_read_b64_tr_b16 v[206:207], v13 offset:29696
    ds_read_b128 v[188:191], v10 offset:27648
    v_mfma_f32_16x16x32_bf16 v[32:35], v[100:103], v[92:95], v[32:35]
    ds_read_b128 v[192:195], v10 offset:28672
    ds_read_b128 v[196:199], v11 offset:27648
    v_mfma_f32_16x16x32_bf16 v[36:39], v[104:107], v[92:95], v[36:39]
    v_mfma_f32_16x16x32_bf16 v[40:43], v[100:103], v[96:99], v[40:43]
    v_mfma_f32_16x16x32_bf16 v[24:27], v[120:123], v[108:111], v[24:27]
    v_mfma_f32_16x16x32_bf16 v[28:31], v[124:127], v[108:111], v[28:31]
    v_mfma_f32_16x16x32_bf16 v[32:35], v[120:123], v[112:115], v[32:35]
    v_mfma_f32_16x16x32_bf16 v[36:39], v[124:127], v[112:115], v[36:39]
    v_mfma_f32_16x16x32_bf16 v[40:43], v[120:123], v[116:119], v[40:43]
    s_waitcnt lgkmcnt(0)
    v_mfma_f32_16x16x32_bf16 v[24:27], v[140:143], v[128:131], v[24:27]
    v_mfma_f32_16x16x32_bf16 v[28:31], v[144:147], v[128:131], v[28:31]
    v_mfma_f32_16x16x32_bf16 v[32:35], v[140:143], v[132:135], v[32:35]
    v_mfma_f32_16x16x32_bf16 v[36:39], v[144:147], v[132:135], v[36:39]
    v_mfma_f32_16x16x32_bf16 v[40:43], v[140:143], v[136:139], v[40:43]
    v_mfma_f32_16x16x32_bf16 v[24:27], v[160:163], v[148:151], v[24:27]
    v_mfma_f32_16x16x32_bf16 v[28:31], v[164:167], v[148:151], v[28:31]
    v_mfma_f32_16x16x32_bf16 v[32:35], v[160:163], v[152:155], v[32:35]
    v_mfma_f32_16x16x32_bf16 v[36:39], v[164:167], v[152:155], v[36:39]
    v_mfma_f32_16x16x32_bf16 v[40:43], v[160:163], v[156:159], v[40:43]
    v_mfma_f32_16x16x32_bf16 v[24:27], v[180:183], v[168:171], v[24:27]
    v_mfma_f32_16x16x32_bf16 v[28:31], v[184:187], v[168:171], v[28:31]
    v_mfma_f32_16x16x32_bf16 v[32:35], v[180:183], v[172:175], v[32:35]
    v_mfma_f32_16x16x32_bf16 v[36:39], v[184:187], v[172:175], v[36:39]
    v_mfma_f32_16x16x32_bf16 v[40:43], v[180:183], v[176:179], v[40:43]
    v_mfma_f32_16x16x32_bf16 v[24:27], v[200:203], v[188:191], v[24:27]
    v_mfma_f32_16x16x32_bf16 v[28:31], v[204:207], v[188:191], v[28:31]
    v_mfma_f32_16x16x32_bf16 v[32:35], v[200:203], v[192:195], v[32:35]
    v_mfma_f32_16x16x32_bf16 v[36:39], v[204:207], v[192:195], v[36:39]
    v_mfma_f32_16x16x32_bf16 v[40:43], v[200:203], v[196:199], v[40:43]
    s_mov_b32 s53, 0xffff0000
    s_waitcnt vmcnt(0)
    v_lshlrev_b32 v48, 16, v44
    v_and_b32 v49, s53, v44
    v_lshlrev_b32 v50, 16, v45
    v_and_b32 v51, s53, v45
    v_lshlrev_b32 v52, 16, v46
    v_and_b32 v53, s53, v46
    v_lshlrev_b32 v54, 16, v47
    v_and_b32 v55, s53, v47
    s_mov_b32 s54, 0xbdd2d3e8
    v_mov_b32 v56, 0xc0135761
    s_mul_i32 s38, s11, 54
    s_lshl_b32 s39, s10, 1
    s_add_u32 s38, s38, s39
    s_add_u32 s38, s38, s45
    s_mul_i32 s38, s38, 5120
    s_add_u32 s38, s38, 10485760
    s_lshl_b32 s39, s44, 3
    s_add_u32 s39, s39, s38
    s_mul_i32 s21, s44, 3072
    s_add_u32 s38, s38, s21
    v_lshlrev_b32 v18, 4, v0
    v_pk_add_f32 v[24:25], v[24:25], v[48:49]
    v_pk_add_f32 v[26:27], v[26:27], v[50:51]
    v_pk_add_f32 v[28:29], v[28:29], v[52:53]
    v_pk_add_f32 v[30:31], v[30:31], v[54:55]
    v_pk_add_f32 v[32:33], v[32:33], v[48:49]
    v_pk_add_f32 v[34:35], v[34:35], v[50:51]
    v_pk_add_f32 v[36:37], v[36:37], v[52:53]
    v_pk_add_f32 v[38:39], v[38:39], v[54:55]
    v_pk_add_f32 v[40:41], v[40:41], v[48:49]
    v_pk_add_f32 v[42:43], v[42:43], v[50:51]
    v_mul_f32 v64, v24, v24
    v_mul_f32 v65, v25, v25
    v_mul_f32 v66, v26, v26
    v_mul_f32 v67, v27, v27
    v_mul_f32 v68, v28, v28
    v_mul_f32 v69, v29, v29
    v_mul_f32 v70, v30, v30
    v_mul_f32 v71, v31, v31
    v_mul_f32 v72, v32, v32
    v_mul_f32 v73, v33, v33
    v_mul_f32 v74, v34, v34
    v_mul_f32 v75, v35, v35
    v_mul_f32 v76, v36, v36
    v_mul_f32 v77, v37, v37
    v_mul_f32 v78, v38, v38
    v_mul_f32 v79, v39, v39
    v_mul_f32 v80, v40, v40
    v_mul_f32 v81, v41, v41
    v_mul_f32 v82, v42, v42
    v_mul_f32 v83, v43, v43
    v_fma_f32 v64, v64, s54, v56
    v_fma_f32 v65, v65, s54, v56
    v_fma_f32 v66, v66, s54, v56
    v_fma_f32 v67, v67, s54, v56
    v_fma_f32 v68, v68, s54, v56
    v_fma_f32 v69, v69, s54, v56
    v_fma_f32 v70, v70, s54, v56
    v_fma_f32 v71, v71, s54, v56
    v_fma_f32 v72, v72, s54, v56
    v_fma_f32 v73, v73, s54, v56
    v_fma_f32 v74, v74, s54, v56
    v_fma_f32 v75, v75, s54, v56
    v_fma_f32 v76, v76, s54, v56
    v_fma_f32 v77, v77, s54, v56
    v_fma_f32 v78, v78, s54, v56
    v_fma_f32 v79, v79, s54, v56
    v_fma_f32 v80, v80, s54, v56
    v_fma_f32 v81, v81, s54, v56
    v_fma_f32 v82, v82, s54, v56
    v_fma_f32 v83, v83, s54, v56
    v_mul_f32 v64, v64, v24
    v_mul_f32 v65, v65, v25
    v_mul_f32 v66, v66, v26
    v_mul_f32 v67, v67, v27
    v_mul_f32 v68, v68, v28
    v_mul_f32 v69, v69, v29
    v_mul_f32 v70, v70, v30
    v_mul_f32 v71, v71, v31
    v_mul_f32 v72, v72, v32
    v_mul_f32 v73, v73, v33
    v_mul_f32 v74, v74, v34
    v_mul_f32 v75, v75, v35
    v_mul_f32 v76, v76, v36
    v_mul_f32 v77, v77, v37
    v_mul_f32 v78, v78, v38
    v_mul_f32 v79, v79, v39
    v_mul_f32 v80, v80, v40
    v_mul_f32 v81, v81, v41
    v_mul_f32 v82, v82, v42
    v_mul_f32 v83, v83, v43
    v_exp_f32 v64, v64
    v_exp_f32 v65, v65
    v_exp_f32 v66, v66
    v_exp_f32 v67, v67
    v_exp_f32 v68, v68
    v_exp_f32 v69, v69
    v_exp_f32 v70, v70
    v_exp_f32 v71, v71
    v_exp_f32 v72, v72
    v_exp_f32 v73, v73
    v_exp_f32 v74, v74
    v_exp_f32 v75, v75
    v_exp_f32 v76, v76
    v_exp_f32 v77, v77
    v_exp_f32 v78, v78
    v_exp_f32 v79, v79
    v_exp_f32 v80, v80
    v_exp_f32 v81, v81
    v_exp_f32 v82, v82
    v_exp_f32 v83, v83
    v_add_f32 v64, 1.0, v64
    v_add_f32 v65, 1.0, v65
    v_add_f32 v66, 1.0, v66
    v_add_f32 v67, 1.0, v67
    v_add_f32 v68, 1.0, v68
    v_add_f32 v69, 1.0, v69
    v_add_f32 v70, 1.0, v70
    v_add_f32 v71, 1.0, v71
    v_add_f32 v72, 1.0, v72
    v_add_f32 v73, 1.0, v73
    v_add_f32 v74, 1.0, v74
    v_add_f32 v75, 1.0, v75
    v_add_f32 v76, 1.0, v76
    v_add_f32 v77, 1.0, v77
    v_add_f32 v78, 1.0, v78
    v_add_f32 v79, 1.0, v79
    v_add_f32 v80, 1.0, v80
    v_add_f32 v81, 1.0, v81
    v_add_f32 v82, 1.0, v82
    v_add_f32 v83, 1.0, v83
    v_rcp_f32 v64, v64
    v_rcp_f32 v65, v65
    v_rcp_f32 v66, v66
    v_rcp_f32 v67, v67
    v_rcp_f32 v68, v68
    v_rcp_f32 v69, v69
    v_rcp_f32 v70, v70
    v_rcp_f32 v71, v71
    v_rcp_f32 v72, v72
    v_rcp_f32 v73, v73
    v_rcp_f32 v74, v74
    v_rcp_f32 v75, v75
    v_rcp_f32 v76, v76
    v_rcp_f32 v77, v77
    v_rcp_f32 v78, v78
    v_rcp_f32 v79, v79
    v_rcp_f32 v80, v80
    v_rcp_f32 v81, v81
    v_rcp_f32 v82, v82
    v_rcp_f32 v83, v83
    v_mul_f32 v24, v24, v64
    v_mul_f32 v25, v25, v65
    v_mul_f32 v26, v26, v66
    v_mul_f32 v27, v27, v67
    v_mul_f32 v28, v28, v68
    v_mul_f32 v29, v29, v69
    v_mul_f32 v30, v30, v70
    v_mul_f32 v31, v31, v71
    v_mul_f32 v32, v32, v72
    v_mul_f32 v33, v33, v73
    v_mul_f32 v34, v34, v74
    v_mul_f32 v35, v35, v75
    v_mul_f32 v36, v36, v76
    v_mul_f32 v37, v37, v77
    v_mul_f32 v38, v38, v78
    v_mul_f32 v39, v39, v79
    v_mul_f32 v40, v40, v80
    v_mul_f32 v41, v41, v81
    v_mul_f32 v42, v42, v82
    v_mul_f32 v43, v43, v83
    s_cmp_eq_u32 s44, 1
    s_cbranch_scc1 LB_sw
    v_cvt_pk_bf16_f32 v88, v24, v25
    v_cvt_pk_bf16_f32 v89, v26, v27
    v_cvt_pk_bf16_f32 v90, v28, v29
    v_cvt_pk_bf16_f32 v91, v30, v31
    v_cvt_pk_bf16_f32 v92, v32, v33
    v_cvt_pk_bf16_f32 v93, v34, v35
    v_cvt_pk_bf16_f32 v94, v36, v37
    v_cvt_pk_bf16_f32 v95, v38, v39
    v_cvt_pk_bf16_f32 v96, v40, v41
    v_cvt_pk_bf16_f32 v97, v42, v43
    s_branch LB_st
LB_sw:
    v_cvt_pk_bf16_f32 v90, v24, v25
    v_cvt_pk_bf16_f32 v91, v26, v27
    v_cvt_pk_bf16_f32 v88, v28, v29
    v_cvt_pk_bf16_f32 v89, v30, v31
    v_cvt_pk_bf16_f32 v94, v32, v33
    v_cvt_pk_bf16_f32 v95, v34, v35
    v_cvt_pk_bf16_f32 v92, v36, v37
    v_cvt_pk_bf16_f32 v93, v38, v39
    v_cvt_pk_bf16_f32 v96, v40, v41
    v_cvt_pk_bf16_f32 v97, v42, v43
LB_st:
    buffer_store_dwordx4 v[88:91], v18, s[32:35], s38 offen sc1
    buffer_store_dwordx4 v[92:95], v18, s[32:35], s38 offen offset:1024 sc1
    buffer_store_dwordx2 v[96:97], v18, s[32:35], s39 offen offset:2048 sc1
    s_lshl_b32 s21, s11, 5
    s_add_u32 s21, s21, s10
    s_lshl_b32 s21, s21, 7
    s_add_u32 s21, s21, 17399808
    s_waitcnt vmcnt(0)
    s_barrier
    s_cmp_lg_u32 s20, 0
    s_cbranch_scc1 LB_nf
    v_mov_b32 v246, s62
    v_mov_b32 v247, s62
    v_mov_b32 v248, s62
    v_mov_b32 v249, s62
    s_mov_b64 exec, 255
    buffer_store_dwordx4 v[246:249], v18, s[32:35], s21 offen sc1
    s_mov_b64 exec, -1
LB_nf:
    s_branch L_cc
L_cspare:
    s_waitcnt vmcnt(0)
    v_mov_b32 v251, s62
    s_mov_b64 exec, 1
    buffer_store_dword v251, v252, s[32:35], s12 offen sc1
    s_mov_b64 exec, -1
L_cfromh:
    s_lshr_b32 s44, s20, 1
    s_and_b32 s45, s20, 1
    s_lshl_b32 s46, s45, 1
    s_add_u32 s46, s46, s44
    s_xor_b32 s47, s46, 1
    v_lshlrev_b32 v18, 4, v0
    s_mul_i32 s21, s44, 3072
    v_add_u32 v4, s21, v18
    v_add_u32 v5, 2048, v18
    v_lshrrev_b32 v16, 2, v0
    v_lshlrev_b32 v16, 7, v16
    v_and_b32 v17, 3, v0
    v_lshl_add_u32 v16, v17, 3, v16
    v_add_u32 v16, 5120, v16
    v_bfe_u32 v17, v0, 3, 2
    v_xor_b32 v6, s46, v17
    v_lshl_add_u32 v6, v6, 5, v16
    v_xor_b32 v7, s47, v17
    v_lshl_add_u32 v7, v7, 5, v16
    s_lshl_b32 s21, s46, 10
    s_add_u32 s21, s21, 5120
    v_add_u32 v8, s21, v18
    s_lshl_b32 s21, s47, 10
    s_add_u32 s21, s21, 5120
    v_add_u32 v9, s21, v18
L_cc:
    s_mov_b32 s48, s78
    s_mov_b32 s49, s79
    s_mov_b32 s50, 0x1000
    s_mov_b32 s51, 0x20000
    s_mov_b32 s52, s80
    s_mov_b32 s53, s81
    s_mov_b32 s54, 0x280000
    s_mov_b32 s55, 0x20000
    s_mov_b32 s24, s64
    s_mov_b32 s25, s65
    s_mov_b32 s26, 0x280000
    s_mov_b32 s27, 0x20000
    v_and_b32 v16, 15, v0
    v_lshlrev_b32 v17, 1, v16
    v_mul_u32_u24 v16, 1280, v16
    v_lshrrev_b32 v18, 4, v0
    v_lshl_add_u32 v16, v18, 3, v16
    s_lshl_b32 s21, s16, 2
    s_add_u32 s21, s21, s46
    s_lshl_b32 s21, s21, 5
    buffer_load_ushort v218, v17, s[48:51], s21 offen
    s_mul_i32 s21, s46, 20480
    v_add_u32 v220, s21, v16
    s_lshl_b32 s21, s16, 2
    s_add_u32 s21, s21, s47
    s_lshl_b32 s21, s21, 5
    buffer_load_ushort v219, v17, s[48:51], s21 offen
    s_mul_i32 s21, s47, 20480
    v_add_u32 v221, s21, v16
    s_mul_i32 s39, s16, 81920
    s_mul_i32 s21, s18, 160
    s_add_u32 s39, s39, s21
    s_mul_i32 s21, s44, 96
    s_add_u32 s38, s39, s21
    buffer_load_dwordx2 v[208:209], v220, s[24:27], s38 offen offset:0
    buffer_load_dwordx2 v[210:211], v221, s[24:27], s38 offen offset:0
    buffer_load_dwordx2 v[212:213], v220, s[24:27], s38 offen offset:32
    buffer_load_dwordx2 v[214:215], v221, s[24:27], s38 offen offset:32
    buffer_load_dwordx2 v[216:217], v220, s[24:27], s39 offen offset:64
    s_barrier
    s_barrier
    v_add_u32 v10, 81920, v4
    v_add_u32 v11, 81920, v5
    v_add_u32 v12, 81920, v6
    v_add_u32 v13, 81920, v7
    ds_read_b64_tr_b16 v[60:61], v12 offset:0
    ds_read_b64_tr_b16 v[62:63], v12 offset:2048
    ds_read_b64_tr_b16 v[64:65], v13 offset:0
    ds_read_b64_tr_b16 v[66:67], v13 offset:2048
    ds_read_b128 v[48:51], v10 offset:0
    ds_read_b128 v[52:55], v10 offset:1024
    ds_read_b128 v[56:59], v11 offset:0
    ds_read_b64_tr_b16 v[80:81], v12 offset:9216
    ds_read_b64_tr_b16 v[82:83], v12 offset:11264
    ds_read_b64_tr_b16 v[84:85], v13 offset:9216
    ds_read_b64_tr_b16 v[86:87], v13 offset:11264
    ds_read_b128 v[68:71], v10 offset:9216
    ds_read_b128 v[72:75], v10 offset:10240
    ds_read_b128 v[76:79], v11 offset:9216
    ds_read_b64_tr_b16 v[100:101], v12 offset:18432
    ds_read_b64_tr_b16 v[102:103], v12 offset:20480
    ds_read_b64_tr_b16 v[104:105], v13 offset:18432
    ds_read_b64_tr_b16 v[106:107], v13 offset:20480
    ds_read_b128 v[88:91], v10 offset:18432
    ds_read_b128 v[92:95], v10 offset:19456
    ds_read_b128 v[96:99], v11 offset:18432
    ds_read_b64_tr_b16 v[120:121], v12 offset:27648
    ds_read_b64_tr_b16 v[122:123], v12 offset:29696
    ds_read_b64_tr_b16 v[124:125], v13 offset:27648
    ds_read_b64_tr_b16 v[126:127], v13 offset:29696
    ds_read_b128 v[108:111], v10 offset:27648
    ds_read_b128 v[112:115], v10 offset:28672
    ds_read_b128 v[116:119], v11 offset:27648
    s_waitcnt lgkmcnt(0)
    s_barrier
    v_add_u32 v10, 118784, v4
    v_add_u32 v11, 118784, v5
    v_add_u32 v12, 118784, v6
    v_add_u32 v13, 118784, v7
    ds_read_b64_tr_b16 v[140:141], v12 offset:0
    ds_read_b64_tr_b16 v[142:143], v12 offset:2048
    v_mfma_f32_16x16x32_bf16 v[24:27], v[48:51], v[60:63], 0
    ds_read_b64_tr_b16 v[144:145], v13 offset:0
    ds_read_b64_tr_b16 v[146:147], v13 offset:2048
    v_mfma_f32_16x16x32_bf16 v[28:31], v[48:51], v[64:67], 0
    ds_read_b128 v[128:131], v10 offset:0
    ds_read_b128 v[132:135], v10 offset:1024
    v_mfma_f32_16x16x32_bf16 v[32:35], v[52:55], v[60:63], 0
    ds_read_b128 v[136:139], v11 offset:0
    ds_read_b64_tr_b16 v[160:161], v12 offset:9216
    v_mfma_f32_16x16x32_bf16 v[36:39], v[52:55], v[64:67], 0
    ds_read_b64_tr_b16 v[162:163], v12 offset:11264
    ds_read_b64_tr_b16 v[164:165], v13 offset:9216
    v_mfma_f32_16x16x32_bf16 v[40:43], v[56:59], v[60:63], 0
    ds_read_b64_tr_b16 v[166:167], v13 offset:11264
    ds_read_b128 v[148:151], v10 offset:9216
    v_mfma_f32_16x16x32_bf16 v[24:27], v[68:71], v[80:83], v[24:27]
    ds_read_b128 v[152:155], v10 offset:10240
    ds_read_b128 v[156:159], v11 offset:9216
    v_mfma_f32_16x16x32_bf16 v[28:31], v[68:71], v[84:87], v[28:31]
    ds_read_b64_tr_b16 v[180:181], v12 offset:18432
    ds_read_b64_tr_b16 v[182:183], v12 offset:20480
    v_mfma_f32_16x16x32_bf16 v[32:35], v[72:75], v[80:83], v[32:35]
    ds_read_b64_tr_b16 v[184:185], v13 offset:18432
    ds_read_b64_tr_b16 v[186:187], v13 offset:20480
    v_mfma_f32_16x16x32_bf16 v[36:39], v[72:75], v[84:87], v[36:39]
    ds_read_b128 v[168:171], v10 offset:18432
    ds_read_b128 v[172:175], v10 offset:19456
    v_mfma_f32_16x16x32_bf16 v[40:43], v[76:79], v[80:83], v[40:43]
    ds_read_b128 v[176:179], v11 offset:18432
    ds_read_b64_tr_b16 v[200:201], v12 offset:27648
    v_mfma_f32_16x16x32_bf16 v[24:27], v[88:91], v[100:103], v[24:27]
    ds_read_b64_tr_b16 v[202:203], v12 offset:29696
    ds_read_b64_tr_b16 v[204:205], v13 offset:27648
    v_mfma_f32_16x16x32_bf16 v[28:31], v[88:91], v[104:107], v[28:31]
    ds_read_b64_tr_b16 v[206:207], v13 offset:29696
    ds_read_b128 v[188:191], v10 offset:27648
    v_mfma_f32_16x16x32_bf16 v[32:35], v[92:95], v[100:103], v[32:35]
    ds_read_b128 v[192:195], v10 offset:28672
    ds_read_b128 v[196:199], v11 offset:27648
    v_mfma_f32_16x16x32_bf16 v[36:39], v[92:95], v[104:107], v[36:39]
    v_mfma_f32_16x16x32_bf16 v[40:43], v[96:99], v[100:103], v[40:43]
    v_mfma_f32_16x16x32_bf16 v[24:27], v[108:111], v[120:123], v[24:27]
    v_mfma_f32_16x16x32_bf16 v[28:31], v[108:111], v[124:127], v[28:31]
    v_mfma_f32_16x16x32_bf16 v[32:35], v[112:115], v[120:123], v[32:35]
    v_mfma_f32_16x16x32_bf16 v[36:39], v[112:115], v[124:127], v[36:39]
    v_mfma_f32_16x16x32_bf16 v[40:43], v[116:119], v[120:123], v[40:43]
    s_waitcnt lgkmcnt(0)
    s_barrier
    v_add_u32 v10, 0, v4
    v_add_u32 v11, 0, v5
    v_add_u32 v12, 0, v6
    v_add_u32 v13, 0, v7
    ds_read_b64_tr_b16 v[60:61], v12 offset:0
    ds_read_b64_tr_b16 v[62:63], v12 offset:2048
    v_mfma_f32_16x16x32_bf16 v[24:27], v[128:131], v[140:143], v[24:27]
    ds_read_b64_tr_b16 v[64:65], v13 offset:0
    ds_read_b64_tr_b16 v[66:67], v13 offset:2048
    v_mfma_f32_16x16x32_bf16 v[28:31], v[128:131], v[144:147], v[28:31]
    ds_read_b128 v[48:51], v10 offset:0
    ds_read_b128 v[52:55], v10 offset:1024
    v_mfma_f32_16x16x32_bf16 v[32:35], v[132:135], v[140:143], v[32:35]
    ds_read_b128 v[56:59], v11 offset:0
    ds_read_b64_tr_b16 v[80:81], v12 offset:9216
    v_mfma_f32_16x16x32_bf16 v[36:39], v[132:135], v[144:147], v[36:39]
    ds_read_b64_tr_b16 v[82:83], v12 offset:11264
    ds_read_b64_tr_b16 v[84:85], v13 offset:9216
    v_mfma_f32_16x16x32_bf16 v[40:43], v[136:139], v[140:143], v[40:43]
    ds_read_b64_tr_b16 v[86:87], v13 offset:11264
    ds_read_b128 v[68:71], v10 offset:9216
    v_mfma_f32_16x16x32_bf16 v[24:27], v[148:151], v[160:163], v[24:27]
    ds_read_b128 v[72:75], v10 offset:10240
    ds_read_b128 v[76:79], v11 offset:9216
    v_mfma_f32_16x16x32_bf16 v[28:31], v[148:151], v[164:167], v[28:31]
    ds_read_b64_tr_b16 v[100:101], v12 offset:18432
    ds_read_b64_tr_b16 v[102:103], v12 offset:20480
    v_mfma_f32_16x16x32_bf16 v[32:35], v[152:155], v[160:163], v[32:35]
    ds_read_b64_tr_b16 v[104:105], v13 offset:18432
    ds_read_b64_tr_b16 v[106:107], v13 offset:20480
    v_mfma_f32_16x16x32_bf16 v[36:39], v[152:155], v[164:167], v[36:39]
    ds_read_b128 v[88:91], v10 offset:18432
    ds_read_b128 v[92:95], v10 offset:19456
    v_mfma_f32_16x16x32_bf16 v[40:43], v[156:159], v[160:163], v[40:43]
    ds_read_b128 v[96:99], v11 offset:18432
    ds_read_b64_tr_b16 v[120:121], v12 offset:27648
    v_mfma_f32_16x16x32_bf16 v[24:27], v[168:171], v[180:183], v[24:27]
    ds_read_b64_tr_b16 v[122:123], v12 offset:29696
    ds_read_b64_tr_b16 v[124:125], v13 offset:27648
    v_mfma_f32_16x16x32_bf16 v[28:31], v[168:171], v[184:187], v[28:31]
    ds_read_b64_tr_b16 v[126:127], v13 offset:29696
    ds_read_b128 v[108:111], v10 offset:27648
    v_mfma_f32_16x16x32_bf16 v[32:35], v[172:175], v[180:183], v[32:35]
    ds_read_b128 v[112:115], v10 offset:28672
    ds_read_b128 v[116:119], v11 offset:27648
    v_mfma_f32_16x16x32_bf16 v[36:39], v[172:175], v[184:187], v[36:39]
    v_mfma_f32_16x16x32_bf16 v[40:43], v[176:179], v[180:183], v[40:43]
    v_mfma_f32_16x16x32_bf16 v[24:27], v[188:191], v[200:203], v[24:27]
    v_mfma_f32_16x16x32_bf16 v[28:31], v[188:191], v[204:207], v[28:31]
    v_mfma_f32_16x16x32_bf16 v[32:35], v[192:195], v[200:203], v[32:35]
    v_mfma_f32_16x16x32_bf16 v[36:39], v[192:195], v[204:207], v[36:39]
    v_mfma_f32_16x16x32_bf16 v[40:43], v[196:199], v[200:203], v[40:43]
    s_waitcnt lgkmcnt(0)
    s_barrier
    v_add_u32 v10, 36864, v4
    v_add_u32 v11, 36864, v5
    v_add_u32 v12, 36864, v6
    v_add_u32 v13, 36864, v7
    ds_read_b64_tr_b16 v[140:141], v12 offset:0
    ds_read_b64_tr_b16 v[142:143], v12 offset:2048
    v_mfma_f32_16x16x32_bf16 v[24:27], v[48:51], v[60:63], v[24:27]
    ds_read_b64_tr_b16 v[144:145], v13 offset:0
    ds_read_b64_tr_b16 v[146:147], v13 offset:2048
    v_mfma_f32_16x16x32_bf16 v[28:31], v[48:51], v[64:67], v[28:31]
    ds_read_b128 v[128:131], v10 offset:0
    ds_read_b128 v[132:135], v10 offset:1024
    v_mfma_f32_16x16x32_bf16 v[32:35], v[52:55], v[60:63], v[32:35]
    ds_read_b128 v[136:139], v11 offset:0
    ds_read_b64_tr_b16 v[160:161], v12 offset:9216
    v_mfma_f32_16x16x32_bf16 v[36:39], v[52:55], v[64:67], v[36:39]
    ds_read_b64_tr_b16 v[162:163], v12 offset:11264
    ds_read_b64_tr_b16 v[164:165], v13 offset:9216
    v_mfma_f32_16x16x32_bf16 v[40:43], v[56:59], v[60:63], v[40:43]
    ds_read_b64_tr_b16 v[166:167], v13 offset:11264
    ds_read_b128 v[148:151], v10 offset:9216
    v_mfma_f32_16x16x32_bf16 v[24:27], v[68:71], v[80:83], v[24:27]
    ds_read_b128 v[152:155], v10 offset:10240
    ds_read_b128 v[156:159], v11 offset:9216
    v_mfma_f32_16x16x32_bf16 v[28:31], v[68:71], v[84:87], v[28:31]
    ds_read_b64_tr_b16 v[180:181], v12 offset:18432
    ds_read_b64_tr_b16 v[182:183], v12 offset:20480
    v_mfma_f32_16x16x32_bf16 v[32:35], v[72:75], v[80:83], v[32:35]
    ds_read_b64_tr_b16 v[184:185], v13 offset:18432
    ds_read_b64_tr_b16 v[186:187], v13 offset:20480
    v_mfma_f32_16x16x32_bf16 v[36:39], v[72:75], v[84:87], v[36:39]
    ds_read_b128 v[168:171], v10 offset:18432
    ds_read_b128 v[172:175], v10 offset:19456
    v_mfma_f32_16x16x32_bf16 v[40:43], v[76:79], v[80:83], v[40:43]
    ds_read_b128 v[176:179], v11 offset:18432
    ds_read_b64_tr_b16 v[200:201], v12 offset:27648
    v_mfma_f32_16x16x32_bf16 v[24:27], v[88:91], v[100:103], v[24:27]
    ds_read_b64_tr_b16 v[202:203], v12 offset:29696
    ds_read_b64_tr_b16 v[204:205], v13 offset:27648
    v_mfma_f32_16x16x32_bf16 v[28:31], v[88:91], v[104:107], v[28:31]
    ds_read_b64_tr_b16 v[206:207], v13 offset:29696
    ds_read_b128 v[188:191], v10 offset:27648
    v_mfma_f32_16x16x32_bf16 v[32:35], v[92:95], v[100:103], v[32:35]
    ds_read_b128 v[192:195], v10 offset:28672
    ds_read_b128 v[196:199], v11 offset:27648
    v_mfma_f32_16x16x32_bf16 v[36:39], v[92:95], v[104:107], v[36:39]
    v_mfma_f32_16x16x32_bf16 v[40:43], v[96:99], v[100:103], v[40:43]
    v_mfma_f32_16x16x32_bf16 v[24:27], v[108:111], v[120:123], v[24:27]
    v_mfma_f32_16x16x32_bf16 v[28:31], v[108:111], v[124:127], v[28:31]
    v_mfma_f32_16x16x32_bf16 v[32:35], v[112:115], v[120:123], v[32:35]
    v_mfma_f32_16x16x32_bf16 v[36:39], v[112:115], v[124:127], v[36:39]
    v_mfma_f32_16x16x32_bf16 v[40:43], v[116:119], v[120:123], v[40:43]
    s_waitcnt lgkmcnt(0)
    s_barrier
    v_add_u32 v10, 81920, v4
    v_add_u32 v11, 81920, v5
    v_add_u32 v12, 81920, v6
    v_add_u32 v13, 81920, v7
    ds_read_b64_tr_b16 v[60:61], v12 offset:0
    ds_read_b64_tr_b16 v[62:63], v12 offset:2048
    v_mfma_f32_16x16x32_bf16 v[24:27], v[128:131], v[140:143], v[24:27]
    ds_read_b64_tr_b16 v[64:65], v13 offset:0
    ds_read_b64_tr_b16 v[66:67], v13 offset:2048
    v_mfma_f32_16x16x32_bf16 v[28:31], v[128:131], v[144:147], v[28:31]
    ds_read_b128 v[48:51], v10 offset:0
    ds_read_b128 v[52:55], v10 offset:1024
    v_mfma_f32_16x16x32_bf16 v[32:35], v[132:135], v[140:143], v[32:35]
    ds_read_b128 v[56:59], v11 offset:0
    ds_read_b64_tr_b16 v[80:81], v12 offset:9216
    v_mfma_f32_16x16x32_bf16 v[36:39], v[132:135], v[144:147], v[36:39]
    ds_read_b64_tr_b16 v[82:83], v12 offset:11264
    ds_read_b64_tr_b16 v[84:85], v13 offset:9216
    v_mfma_f32_16x16x32_bf16 v[40:43], v[136:139], v[140:143], v[40:43]
    ds_read_b64_tr_b16 v[86:87], v13 offset:11264
    ds_read_b128 v[68:71], v10 offset:9216
    v_mfma_f32_16x16x32_bf16 v[24:27], v[148:151], v[160:163], v[24:27]
    ds_read_b128 v[72:75], v10 offset:10240
    ds_read_b128 v[76:79], v11 offset:9216
    v_mfma_f32_16x16x32_bf16 v[28:31], v[148:151], v[164:167], v[28:31]
    ds_read_b64_tr_b16 v[100:101], v12 offset:18432
    ds_read_b64_tr_b16 v[102:103], v12 offset:20480
    v_mfma_f32_16x16x32_bf16 v[32:35], v[152:155], v[160:163], v[32:35]
    ds_read_b64_tr_b16 v[104:105], v13 offset:18432
    ds_read_b64_tr_b16 v[106:107], v13 offset:20480
    v_mfma_f32_16x16x32_bf16 v[36:39], v[152:155], v[164:167], v[36:39]
    ds_read_b128 v[88:91], v10 offset:18432
    ds_read_b128 v[92:95], v10 offset:19456
    v_mfma_f32_16x16x32_bf16 v[40:43], v[156:159], v[160:163], v[40:43]
    ds_read_b128 v[96:99], v11 offset:18432
    ds_read_b64_tr_b16 v[120:121], v12 offset:27648
    v_mfma_f32_16x16x32_bf16 v[24:27], v[168:171], v[180:183], v[24:27]
    ds_read_b64_tr_b16 v[122:123], v12 offset:29696
    ds_read_b64_tr_b16 v[124:125], v13 offset:27648
    v_mfma_f32_16x16x32_bf16 v[28:31], v[168:171], v[184:187], v[28:31]
    ds_read_b64_tr_b16 v[126:127], v13 offset:29696
    ds_read_b128 v[108:111], v10 offset:27648
    v_mfma_f32_16x16x32_bf16 v[32:35], v[172:175], v[180:183], v[32:35]
    ds_read_b128 v[112:115], v10 offset:28672
    ds_read_b128 v[116:119], v11 offset:27648
    v_mfma_f32_16x16x32_bf16 v[36:39], v[172:175], v[184:187], v[36:39]
    v_mfma_f32_16x16x32_bf16 v[40:43], v[176:179], v[180:183], v[40:43]
    v_mfma_f32_16x16x32_bf16 v[24:27], v[188:191], v[200:203], v[24:27]
    v_mfma_f32_16x16x32_bf16 v[28:31], v[188:191], v[204:207], v[28:31]
    v_mfma_f32_16x16x32_bf16 v[32:35], v[192:195], v[200:203], v[32:35]
    v_mfma_f32_16x16x32_bf16 v[36:39], v[192:195], v[204:207], v[36:39]
    v_mfma_f32_16x16x32_bf16 v[40:43], v[196:199], v[200:203], v[40:43]
    s_waitcnt lgkmcnt(0)
    s_barrier
    v_add_u32 v10, 118784, v4
    v_add_u32 v11, 118784, v5
    v_add_u32 v12, 118784, v6
    v_add_u32 v13, 118784, v7
    ds_read_b64_tr_b16 v[140:141], v12 offset:0
    ds_read_b64_tr_b16 v[142:143], v12 offset:2048
    v_mfma_f32_16x16x32_bf16 v[24:27], v[48:51], v[60:63], v[24:27]
    ds_read_b64_tr_b16 v[144:145], v13 offset:0
    ds_read_b64_tr_b16 v[146:147], v13 offset:2048
    v_mfma_f32_16x16x32_bf16 v[28:31], v[48:51], v[64:67], v[28:31]
    ds_read_b128 v[128:131], v10 offset:0
    ds_read_b128 v[132:135], v10 offset:1024
    v_mfma_f32_16x16x32_bf16 v[32:35], v[52:55], v[60:63], v[32:35]
    ds_read_b128 v[136:139], v11 offset:0
    ds_read_b64_tr_b16 v[160:161], v12 offset:9216
    v_mfma_f32_16x16x32_bf16 v[36:39], v[52:55], v[64:67], v[36:39]
    ds_read_b64_tr_b16 v[162:163], v12 offset:11264
    ds_read_b64_tr_b16 v[164:165], v13 offset:9216
    v_mfma_f32_16x16x32_bf16 v[40:43], v[56:59], v[60:63], v[40:43]
    ds_read_b64_tr_b16 v[166:167], v13 offset:11264
    ds_read_b128 v[148:151], v10 offset:9216
    v_mfma_f32_16x16x32_bf16 v[24:27], v[68:71], v[80:83], v[24:27]
    ds_read_b128 v[152:155], v10 offset:10240
    ds_read_b128 v[156:159], v11 offset:9216
    v_mfma_f32_16x16x32_bf16 v[28:31], v[68:71], v[84:87], v[28:31]
    ds_read_b64_tr_b16 v[180:181], v12 offset:18432
    ds_read_b64_tr_b16 v[182:183], v12 offset:20480
    v_mfma_f32_16x16x32_bf16 v[32:35], v[72:75], v[80:83], v[32:35]
    ds_read_b64_tr_b16 v[184:185], v13 offset:18432
    ds_read_b64_tr_b16 v[186:187], v13 offset:20480
    v_mfma_f32_16x16x32_bf16 v[36:39], v[72:75], v[84:87], v[36:39]
    ds_read_b128 v[168:171], v10 offset:18432
    ds_read_b128 v[172:175], v10 offset:19456
    v_mfma_f32_16x16x32_bf16 v[40:43], v[76:79], v[80:83], v[40:43]
    ds_read_b128 v[176:179], v11 offset:18432
    ds_read_b64_tr_b16 v[200:201], v12 offset:27648
    v_mfma_f32_16x16x32_bf16 v[24:27], v[88:91], v[100:103], v[24:27]
    ds_read_b64_tr_b16 v[202:203], v12 offset:29696
    ds_read_b64_tr_b16 v[204:205], v13 offset:27648
    v_mfma_f32_16x16x32_bf16 v[28:31], v[88:91], v[104:107], v[28:31]
    ds_read_b64_tr_b16 v[206:207], v13 offset:29696
    ds_read_b128 v[188:191], v10 offset:27648
    v_mfma_f32_16x16x32_bf16 v[32:35], v[92:95], v[100:103], v[32:35]
    ds_read_b128 v[192:195], v10 offset:28672
    ds_read_b128 v[196:199], v11 offset:27648
    v_mfma_f32_16x16x32_bf16 v[36:39], v[92:95], v[104:107], v[36:39]
    v_mfma_f32_16x16x32_bf16 v[40:43], v[96:99], v[100:103], v[40:43]
    v_mfma_f32_16x16x32_bf16 v[24:27], v[108:111], v[120:123], v[24:27]
    v_mfma_f32_16x16x32_bf16 v[28:31], v[108:111], v[124:127], v[28:31]
    v_mfma_f32_16x16x32_bf16 v[32:35], v[112:115], v[120:123], v[32:35]
    v_mfma_f32_16x16x32_bf16 v[36:39], v[112:115], v[124:127], v[36:39]
    v_mfma_f32_16x16x32_bf16 v[40:43], v[116:119], v[120:123], v[40:43]
    s_waitcnt lgkmcnt(0)
    s_barrier
    v_add_u32 v10, 0, v4
    v_add_u32 v11, 0, v5
    v_add_u32 v12, 0, v6
    v_add_u32 v13, 0, v7
    ds_read_b64_tr_b16 v[60:61], v12 offset:0
    ds_read_b64_tr_b16 v[62:63], v12 offset:2048
    v_mfma_f32_16x16x32_bf16 v[24:27], v[128:131], v[140:143], v[24:27]
    ds_read_b64_tr_b16 v[64:65], v13 offset:0
    ds_read_b64_tr_b16 v[66:67], v13 offset:2048
    v_mfma_f32_16x16x32_bf16 v[28:31], v[128:131], v[144:147], v[28:31]
    ds_read_b128 v[48:51], v10 offset:0
    ds_read_b128 v[52:55], v10 offset:1024
    v_mfma_f32_16x16x32_bf16 v[32:35], v[132:135], v[140:143], v[32:35]
    ds_read_b128 v[56:59], v11 offset:0
    ds_read_b64_tr_b16 v[80:81], v12 offset:9216
    v_mfma_f32_16x16x32_bf16 v[36:39], v[132:135], v[144:147], v[36:39]
    ds_read_b64_tr_b16 v[82:83], v12 offset:11264
    ds_read_b64_tr_b16 v[84:85], v13 offset:9216
    v_mfma_f32_16x16x32_bf16 v[40:43], v[136:139], v[140:143], v[40:43]
    ds_read_b64_tr_b16 v[86:87], v13 offset:11264
    ds_read_b128 v[68:71], v10 offset:9216
    v_mfma_f32_16x16x32_bf16 v[24:27], v[148:151], v[160:163], v[24:27]
    ds_read_b128 v[72:75], v10 offset:10240
    ds_read_b128 v[76:79], v11 offset:9216
    v_mfma_f32_16x16x32_bf16 v[28:31], v[148:151], v[164:167], v[28:31]
    ds_read_b64_tr_b16 v[100:101], v12 offset:18432
    ds_read_b64_tr_b16 v[102:103], v12 offset:20480
    v_mfma_f32_16x16x32_bf16 v[32:35], v[152:155], v[160:163], v[32:35]
    ds_read_b64_tr_b16 v[104:105], v13 offset:18432
    ds_read_b64_tr_b16 v[106:107], v13 offset:20480
    v_mfma_f32_16x16x32_bf16 v[36:39], v[152:155], v[164:167], v[36:39]
    ds_read_b128 v[88:91], v10 offset:18432
    ds_read_b128 v[92:95], v10 offset:19456
    v_mfma_f32_16x16x32_bf16 v[40:43], v[156:159], v[160:163], v[40:43]
    ds_read_b128 v[96:99], v11 offset:18432
    ds_read_b64_tr_b16 v[120:121], v12 offset:27648
    v_mfma_f32_16x16x32_bf16 v[24:27], v[168:171], v[180:183], v[24:27]
    ds_read_b64_tr_b16 v[122:123], v12 offset:29696
    ds_read_b64_tr_b16 v[124:125], v13 offset:27648
    v_mfma_f32_16x16x32_bf16 v[28:31], v[168:171], v[184:187], v[28:31]
    ds_read_b64_tr_b16 v[126:127], v13 offset:29696
    ds_read_b128 v[108:111], v10 offset:27648
    v_mfma_f32_16x16x32_bf16 v[32:35], v[172:175], v[180:183], v[32:35]
    ds_read_b128 v[112:115], v10 offset:28672
    ds_read_b128 v[116:119], v11 offset:27648
    v_mfma_f32_16x16x32_bf16 v[36:39], v[172:175], v[184:187], v[36:39]
    v_mfma_f32_16x16x32_bf16 v[40:43], v[176:179], v[180:183], v[40:43]
    v_mfma_f32_16x16x32_bf16 v[24:27], v[188:191], v[200:203], v[24:27]
    v_mfma_f32_16x16x32_bf16 v[28:31], v[188:191], v[204:207], v[28:31]
    v_mfma_f32_16x16x32_bf16 v[32:35], v[192:195], v[200:203], v[32:35]
    v_mfma_f32_16x16x32_bf16 v[36:39], v[192:195], v[204:207], v[36:39]
    v_mfma_f32_16x16x32_bf16 v[40:43], v[196:199], v[200:203], v[40:43]
    s_waitcnt lgkmcnt(0)
    s_barrier
    v_add_u32 v10, 36864, v4
    v_add_u32 v11, 36864, v5
    v_add_u32 v12, 36864, v6
    v_add_u32 v13, 36864, v7
    ds_read_b64_tr_b16 v[140:141], v12 offset:0
    ds_read_b64_tr_b16 v[142:143], v12 offset:2048
    v_mfma_f32_16x16x32_bf16 v[24:27], v[48:51], v[60:63], v[24:27]
    ds_read_b64_tr_b16 v[144:145], v13 offset:0
    ds_read_b64_tr_b16 v[146:147], v13 offset:2048
    v_mfma_f32_16x16x32_bf16 v[28:31], v[48:51], v[64:67], v[28:31]
    ds_read_b128 v[128:131], v10 offset:0
    ds_read_b128 v[132:135], v10 offset:1024
    v_mfma_f32_16x16x32_bf16 v[32:35], v[52:55], v[60:63], v[32:35]
    ds_read_b128 v[136:139], v11 offset:0
    ds_read_b64_tr_b16 v[160:161], v12 offset:9216
    v_mfma_f32_16x16x32_bf16 v[36:39], v[52:55], v[64:67], v[36:39]
    ds_read_b64_tr_b16 v[162:163], v12 offset:11264
    ds_read_b64_tr_b16 v[164:165], v13 offset:9216
    v_mfma_f32_16x16x32_bf16 v[40:43], v[56:59], v[60:63], v[40:43]
    ds_read_b64_tr_b16 v[166:167], v13 offset:11264
    ds_read_b128 v[148:151], v10 offset:9216
    v_mfma_f32_16x16x32_bf16 v[24:27], v[68:71], v[80:83], v[24:27]
    ds_read_b128 v[152:155], v10 offset:10240
    ds_read_b128 v[156:159], v11 offset:9216
    v_mfma_f32_16x16x32_bf16 v[28:31], v[68:71], v[84:87], v[28:31]
    ds_read_b64_tr_b16 v[180:181], v12 offset:18432
    ds_read_b64_tr_b16 v[182:183], v12 offset:20480
    v_mfma_f32_16x16x32_bf16 v[32:35], v[72:75], v[80:83], v[32:35]
    ds_read_b64_tr_b16 v[184:185], v13 offset:18432
    ds_read_b64_tr_b16 v[186:187], v13 offset:20480
    v_mfma_f32_16x16x32_bf16 v[36:39], v[72:75], v[84:87], v[36:39]
    ds_read_b128 v[168:171], v10 offset:18432
    ds_read_b128 v[172:175], v10 offset:19456
    v_mfma_f32_16x16x32_bf16 v[40:43], v[76:79], v[80:83], v[40:43]
    ds_read_b128 v[176:179], v11 offset:18432
    ds_read_b64_tr_b16 v[200:201], v12 offset:27648
    v_mfma_f32_16x16x32_bf16 v[24:27], v[88:91], v[100:103], v[24:27]
    ds_read_b64_tr_b16 v[202:203], v12 offset:29696
    ds_read_b64_tr_b16 v[204:205], v13 offset:27648
    v_mfma_f32_16x16x32_bf16 v[28:31], v[88:91], v[104:107], v[28:31]
    ds_read_b64_tr_b16 v[206:207], v13 offset:29696
    ds_read_b128 v[188:191], v10 offset:27648
    v_mfma_f32_16x16x32_bf16 v[32:35], v[92:95], v[100:103], v[32:35]
    ds_read_b128 v[192:195], v10 offset:28672
    ds_read_b128 v[196:199], v11 offset:27648
    v_mfma_f32_16x16x32_bf16 v[36:39], v[92:95], v[104:107], v[36:39]
    v_mfma_f32_16x16x32_bf16 v[40:43], v[96:99], v[100:103], v[40:43]
    v_mfma_f32_16x16x32_bf16 v[24:27], v[108:111], v[120:123], v[24:27]
    v_mfma_f32_16x16x32_bf16 v[28:31], v[108:111], v[124:127], v[28:31]
    v_mfma_f32_16x16x32_bf16 v[32:35], v[112:115], v[120:123], v[32:35]
    v_mfma_f32_16x16x32_bf16 v[36:39], v[112:115], v[124:127], v[36:39]
    v_mfma_f32_16x16x32_bf16 v[40:43], v[116:119], v[120:123], v[40:43]
    s_waitcnt lgkmcnt(0)
    s_barrier
    v_add_u32 v10, 81920, v4
    v_add_u32 v11, 81920, v5
    v_add_u32 v12, 81920, v6
    v_add_u32 v13, 81920, v7
    ds_read_b64_tr_b16 v[60:61], v12 offset:0
    ds_read_b64_tr_b16 v[62:63], v12 offset:2048
    v_mfma_f32_16x16x32_bf16 v[24:27], v[128:131], v[140:143], v[24:27]
    ds_read_b64_tr_b16 v[64:65], v13 offset:0
    ds_read_b64_tr_b16 v[66:67], v13 offset:2048
    v_mfma_f32_16x16x32_bf16 v[28:31], v[128:131], v[144:147], v[28:31]
    ds_read_b128 v[48:51], v10 offset:0
    ds_read_b128 v[52:55], v10 offset:1024
    v_mfma_f32_16x16x32_bf16 v[32:35], v[132:135], v[140:143], v[32:35]
    ds_read_b128 v[56:59], v11 offset:0
    ds_read_b64_tr_b16 v[80:81], v12 offset:9216
    v_mfma_f32_16x16x32_bf16 v[36:39], v[132:135], v[144:147], v[36:39]
    ds_read_b64_tr_b16 v[82:83], v12 offset:11264
    ds_read_b64_tr_b16 v[84:85], v13 offset:9216
    v_mfma_f32_16x16x32_bf16 v[40:43], v[136:139], v[140:143], v[40:43]
    ds_read_b64_tr_b16 v[86:87], v13 offset:11264
    ds_read_b128 v[68:71], v10 offset:9216
    v_mfma_f32_16x16x32_bf16 v[24:27], v[148:151], v[160:163], v[24:27]
    ds_read_b128 v[72:75], v10 offset:10240
    ds_read_b128 v[76:79], v11 offset:9216
    v_mfma_f32_16x16x32_bf16 v[28:31], v[148:151], v[164:167], v[28:31]
    ds_read_b64_tr_b16 v[100:101], v12 offset:18432
    ds_read_b64_tr_b16 v[102:103], v12 offset:20480
    v_mfma_f32_16x16x32_bf16 v[32:35], v[152:155], v[160:163], v[32:35]
    ds_read_b64_tr_b16 v[104:105], v13 offset:18432
    ds_read_b64_tr_b16 v[106:107], v13 offset:20480
    v_mfma_f32_16x16x32_bf16 v[36:39], v[152:155], v[164:167], v[36:39]
    ds_read_b128 v[88:91], v10 offset:18432
    ds_read_b128 v[92:95], v10 offset:19456
    v_mfma_f32_16x16x32_bf16 v[40:43], v[156:159], v[160:163], v[40:43]
    ds_read_b128 v[96:99], v11 offset:18432
    ds_read_b64_tr_b16 v[120:121], v12 offset:27648
    v_mfma_f32_16x16x32_bf16 v[24:27], v[168:171], v[180:183], v[24:27]
    ds_read_b64_tr_b16 v[122:123], v12 offset:29696
    ds_read_b64_tr_b16 v[124:125], v13 offset:27648
    v_mfma_f32_16x16x32_bf16 v[28:31], v[168:171], v[184:187], v[28:31]
    ds_read_b64_tr_b16 v[126:127], v13 offset:29696
    ds_read_b128 v[108:111], v10 offset:27648
    v_mfma_f32_16x16x32_bf16 v[32:35], v[172:175], v[180:183], v[32:35]
    ds_read_b128 v[112:115], v10 offset:28672
    ds_read_b128 v[116:119], v11 offset:27648
    v_mfma_f32_16x16x32_bf16 v[36:39], v[172:175], v[184:187], v[36:39]
    v_mfma_f32_16x16x32_bf16 v[40:43], v[176:179], v[180:183], v[40:43]
    v_mfma_f32_16x16x32_bf16 v[24:27], v[188:191], v[200:203], v[24:27]
    v_mfma_f32_16x16x32_bf16 v[28:31], v[188:191], v[204:207], v[28:31]
    v_mfma_f32_16x16x32_bf16 v[32:35], v[192:195], v[200:203], v[32:35]
    v_mfma_f32_16x16x32_bf16 v[36:39], v[192:195], v[204:207], v[36:39]
    v_mfma_f32_16x16x32_bf16 v[40:43], v[196:199], v[200:203], v[40:43]
    s_waitcnt lgkmcnt(0)
    s_barrier
    v_add_u32 v10, 118784, v4
    v_add_u32 v11, 118784, v5
    v_add_u32 v12, 118784, v6
    v_add_u32 v13, 118784, v7
    ds_read_b64_tr_b16 v[140:141], v12 offset:0
    ds_read_b64_tr_b16 v[142:143], v12 offset:2048
    v_mfma_f32_16x16x32_bf16 v[24:27], v[48:51], v[60:63], v[24:27]
    ds_read_b64_tr_b16 v[144:145], v13 offset:0
    ds_read_b64_tr_b16 v[146:147], v13 offset:2048
    v_mfma_f32_16x16x32_bf16 v[28:31], v[48:51], v[64:67], v[28:31]
    ds_read_b128 v[128:131], v10 offset:0
    ds_read_b128 v[132:135], v10 offset:1024
    v_mfma_f32_16x16x32_bf16 v[32:35], v[52:55], v[60:63], v[32:35]
    ds_read_b128 v[136:139], v11 offset:0
    ds_read_b64_tr_b16 v[160:161], v12 offset:9216
    v_mfma_f32_16x16x32_bf16 v[36:39], v[52:55], v[64:67], v[36:39]
    ds_read_b64_tr_b16 v[162:163], v12 offset:11264
    ds_read_b64_tr_b16 v[164:165], v13 offset:9216
    v_mfma_f32_16x16x32_bf16 v[40:43], v[56:59], v[60:63], v[40:43]
    ds_read_b64_tr_b16 v[166:167], v13 offset:11264
    ds_read_b128 v[148:151], v10 offset:9216
    v_mfma_f32_16x16x32_bf16 v[24:27], v[68:71], v[80:83], v[24:27]
    ds_read_b128 v[152:155], v10 offset:10240
    ds_read_b128 v[156:159], v11 offset:9216
    v_mfma_f32_16x16x32_bf16 v[28:31], v[68:71], v[84:87], v[28:31]
    ds_read_b64_tr_b16 v[180:181], v12 offset:18432
    ds_read_b64_tr_b16 v[182:183], v12 offset:20480
    v_mfma_f32_16x16x32_bf16 v[32:35], v[72:75], v[80:83], v[32:35]
    ds_read_b64_tr_b16 v[184:185], v13 offset:18432
    ds_read_b64_tr_b16 v[186:187], v13 offset:20480
    v_mfma_f32_16x16x32_bf16 v[36:39], v[72:75], v[84:87], v[36:39]
    ds_read_b128 v[168:171], v10 offset:18432
    ds_read_b128 v[172:175], v10 offset:19456
    v_mfma_f32_16x16x32_bf16 v[40:43], v[76:79], v[80:83], v[40:43]
    ds_read_b128 v[176:179], v11 offset:18432
    ds_read_b64_tr_b16 v[200:201], v12 offset:27648
    v_mfma_f32_16x16x32_bf16 v[24:27], v[88:91], v[100:103], v[24:27]
    ds_read_b64_tr_b16 v[202:203], v12 offset:29696
    ds_read_b64_tr_b16 v[204:205], v13 offset:27648
    v_mfma_f32_16x16x32_bf16 v[28:31], v[88:91], v[104:107], v[28:31]
    ds_read_b64_tr_b16 v[206:207], v13 offset:29696
    ds_read_b128 v[188:191], v10 offset:27648
    v_mfma_f32_16x16x32_bf16 v[32:35], v[92:95], v[100:103], v[32:35]
    ds_read_b128 v[192:195], v10 offset:28672
    ds_read_b128 v[196:199], v11 offset:27648
    v_mfma_f32_16x16x32_bf16 v[36:39], v[92:95], v[104:107], v[36:39]
    v_mfma_f32_16x16x32_bf16 v[40:43], v[96:99], v[100:103], v[40:43]
    v_mfma_f32_16x16x32_bf16 v[24:27], v[108:111], v[120:123], v[24:27]
    v_mfma_f32_16x16x32_bf16 v[28:31], v[108:111], v[124:127], v[28:31]
    v_mfma_f32_16x16x32_bf16 v[32:35], v[112:115], v[120:123], v[32:35]
    v_mfma_f32_16x16x32_bf16 v[36:39], v[112:115], v[124:127], v[36:39]
    v_mfma_f32_16x16x32_bf16 v[40:43], v[116:119], v[120:123], v[40:43]
    s_waitcnt lgkmcnt(0)
    s_barrier
    v_add_u32 v10, 0, v4
    v_add_u32 v11, 0, v5
    v_add_u32 v12, 0, v6
    v_add_u32 v13, 0, v7
    ds_read_b64_tr_b16 v[60:61], v12 offset:0
    ds_read_b64_tr_b16 v[62:63], v12 offset:2048
    v_mfma_f32_16x16x32_bf16 v[24:27], v[128:131], v[140:143], v[24:27]
    ds_read_b64_tr_b16 v[64:65], v13 offset:0
    ds_read_b64_tr_b16 v[66:67], v13 offset:2048
    v_mfma_f32_16x16x32_bf16 v[28:31], v[128:131], v[144:147], v[28:31]
    ds_read_b128 v[48:51], v10 offset:0
    ds_read_b128 v[52:55], v10 offset:1024
    v_mfma_f32_16x16x32_bf16 v[32:35], v[132:135], v[140:143], v[32:35]
    ds_read_b128 v[56:59], v11 offset:0
    ds_read_b64_tr_b16 v[80:81], v12 offset:9216
    v_mfma_f32_16x16x32_bf16 v[36:39], v[132:135], v[144:147], v[36:39]
    ds_read_b64_tr_b16 v[82:83], v12 offset:11264
    ds_read_b64_tr_b16 v[84:85], v13 offset:9216
    v_mfma_f32_16x16x32_bf16 v[40:43], v[136:139], v[140:143], v[40:43]
    ds_read_b64_tr_b16 v[86:87], v13 offset:11264
    ds_read_b128 v[68:71], v10 offset:9216
    v_mfma_f32_16x16x32_bf16 v[24:27], v[148:151], v[160:163], v[24:27]
    ds_read_b128 v[72:75], v10 offset:10240
    ds_read_b128 v[76:79], v11 offset:9216
    v_mfma_f32_16x16x32_bf16 v[28:31], v[148:151], v[164:167], v[28:31]
    ds_read_b64_tr_b16 v[100:101], v12 offset:18432
    ds_read_b64_tr_b16 v[102:103], v12 offset:20480
    v_mfma_f32_16x16x32_bf16 v[32:35], v[152:155], v[160:163], v[32:35]
    ds_read_b64_tr_b16 v[104:105], v13 offset:18432
    ds_read_b64_tr_b16 v[106:107], v13 offset:20480
    v_mfma_f32_16x16x32_bf16 v[36:39], v[152:155], v[164:167], v[36:39]
    ds_read_b128 v[88:91], v10 offset:18432
    ds_read_b128 v[92:95], v10 offset:19456
    v_mfma_f32_16x16x32_bf16 v[40:43], v[156:159], v[160:163], v[40:43]
    ds_read_b128 v[96:99], v11 offset:18432
    ds_read_b64_tr_b16 v[120:121], v12 offset:27648
    v_mfma_f32_16x16x32_bf16 v[24:27], v[168:171], v[180:183], v[24:27]
    ds_read_b64_tr_b16 v[122:123], v12 offset:29696
    ds_read_b64_tr_b16 v[124:125], v13 offset:27648
    v_mfma_f32_16x16x32_bf16 v[28:31], v[168:171], v[184:187], v[28:31]
    ds_read_b64_tr_b16 v[126:127], v13 offset:29696
    ds_read_b128 v[108:111], v10 offset:27648
    v_mfma_f32_16x16x32_bf16 v[32:35], v[172:175], v[180:183], v[32:35]
    ds_read_b128 v[112:115], v10 offset:28672
    ds_read_b128 v[116:119], v11 offset:27648
    v_mfma_f32_16x16x32_bf16 v[36:39], v[172:175], v[184:187], v[36:39]
    v_mfma_f32_16x16x32_bf16 v[40:43], v[176:179], v[180:183], v[40:43]
    v_mfma_f32_16x16x32_bf16 v[24:27], v[188:191], v[200:203], v[24:27]
    v_mfma_f32_16x16x32_bf16 v[28:31], v[188:191], v[204:207], v[28:31]
    v_mfma_f32_16x16x32_bf16 v[32:35], v[192:195], v[200:203], v[32:35]
    v_mfma_f32_16x16x32_bf16 v[36:39], v[192:195], v[204:207], v[36:39]
    v_mfma_f32_16x16x32_bf16 v[40:43], v[196:199], v[200:203], v[40:43]
    s_waitcnt lgkmcnt(0)
    s_barrier
    v_add_u32 v10, 36864, v4
    v_add_u32 v11, 36864, v5
    v_add_u32 v12, 36864, v6
    v_add_u32 v13, 36864, v7
    ds_read_b64_tr_b16 v[140:141], v12 offset:0
    ds_read_b64_tr_b16 v[142:143], v12 offset:2048
    v_mfma_f32_16x16x32_bf16 v[24:27], v[48:51], v[60:63], v[24:27]
    ds_read_b64_tr_b16 v[144:145], v13 offset:0
    ds_read_b64_tr_b16 v[146:147], v13 offset:2048
    v_mfma_f32_16x16x32_bf16 v[28:31], v[48:51], v[64:67], v[28:31]
    ds_read_b128 v[128:131], v10 offset:0
    ds_read_b128 v[132:135], v10 offset:1024
    v_mfma_f32_16x16x32_bf16 v[32:35], v[52:55], v[60:63], v[32:35]
    ds_read_b128 v[136:139], v11 offset:0
    ds_read_b64_tr_b16 v[160:161], v12 offset:9216
    v_mfma_f32_16x16x32_bf16 v[36:39], v[52:55], v[64:67], v[36:39]
    ds_read_b64_tr_b16 v[162:163], v12 offset:11264
    ds_read_b64_tr_b16 v[164:165], v13 offset:9216
    v_mfma_f32_16x16x32_bf16 v[40:43], v[56:59], v[60:63], v[40:43]
    ds_read_b64_tr_b16 v[166:167], v13 offset:11264
    ds_read_b128 v[148:151], v10 offset:9216
    v_mfma_f32_16x16x32_bf16 v[24:27], v[68:71], v[80:83], v[24:27]
    ds_read_b128 v[152:155], v10 offset:10240
    ds_read_b128 v[156:159], v11 offset:9216
    v_mfma_f32_16x16x32_bf16 v[28:31], v[68:71], v[84:87], v[28:31]
    ds_read_b64_tr_b16 v[180:181], v12 offset:18432
    ds_read_b64_tr_b16 v[182:183], v12 offset:20480
    v_mfma_f32_16x16x32_bf16 v[32:35], v[72:75], v[80:83], v[32:35]
    ds_read_b64_tr_b16 v[184:185], v13 offset:18432
    ds_read_b64_tr_b16 v[186:187], v13 offset:20480
    v_mfma_f32_16x16x32_bf16 v[36:39], v[72:75], v[84:87], v[36:39]
    ds_read_b128 v[168:171], v10 offset:18432
    ds_read_b128 v[172:175], v10 offset:19456
    v_mfma_f32_16x16x32_bf16 v[40:43], v[76:79], v[80:83], v[40:43]
    ds_read_b128 v[176:179], v11 offset:18432
    ds_read_b64_tr_b16 v[200:201], v12 offset:27648
    v_mfma_f32_16x16x32_bf16 v[24:27], v[88:91], v[100:103], v[24:27]
    ds_read_b64_tr_b16 v[202:203], v12 offset:29696
    ds_read_b64_tr_b16 v[204:205], v13 offset:27648
    v_mfma_f32_16x16x32_bf16 v[28:31], v[88:91], v[104:107], v[28:31]
    ds_read_b64_tr_b16 v[206:207], v13 offset:29696
    ds_read_b128 v[188:191], v10 offset:27648
    v_mfma_f32_16x16x32_bf16 v[32:35], v[92:95], v[100:103], v[32:35]
    ds_read_b128 v[192:195], v10 offset:28672
    ds_read_b128 v[196:199], v11 offset:27648
    v_mfma_f32_16x16x32_bf16 v[36:39], v[92:95], v[104:107], v[36:39]
    v_mfma_f32_16x16x32_bf16 v[40:43], v[96:99], v[100:103], v[40:43]
    v_mfma_f32_16x16x32_bf16 v[24:27], v[108:111], v[120:123], v[24:27]
    v_mfma_f32_16x16x32_bf16 v[28:31], v[108:111], v[124:127], v[28:31]
    v_mfma_f32_16x16x32_bf16 v[32:35], v[112:115], v[120:123], v[32:35]
    v_mfma_f32_16x16x32_bf16 v[36:39], v[112:115], v[124:127], v[36:39]
    v_mfma_f32_16x16x32_bf16 v[40:43], v[116:119], v[120:123], v[40:43]
    s_waitcnt lgkmcnt(0)
    s_barrier
    v_add_u32 v10, 81920, v4
    v_add_u32 v11, 81920, v5
    v_add_u32 v12, 81920, v6
    v_add_u32 v13, 81920, v7
    ds_read_b64_tr_b16 v[60:61], v12 offset:0
    ds_read_b64_tr_b16 v[62:63], v12 offset:2048
    v_mfma_f32_16x16x32_bf16 v[24:27], v[128:131], v[140:143], v[24:27]
    ds_read_b64_tr_b16 v[64:65], v13 offset:0
    ds_read_b64_tr_b16 v[66:67], v13 offset:2048
    v_mfma_f32_16x16x32_bf16 v[28:31], v[128:131], v[144:147], v[28:31]
    ds_read_b128 v[48:51], v10 offset:0
    ds_read_b128 v[52:55], v10 offset:1024
    v_mfma_f32_16x16x32_bf16 v[32:35], v[132:135], v[140:143], v[32:35]
    ds_read_b128 v[56:59], v11 offset:0
    ds_read_b64_tr_b16 v[80:81], v12 offset:9216
    v_mfma_f32_16x16x32_bf16 v[36:39], v[132:135], v[144:147], v[36:39]
    ds_read_b64_tr_b16 v[82:83], v12 offset:11264
    ds_read_b64_tr_b16 v[84:85], v13 offset:9216
    v_mfma_f32_16x16x32_bf16 v[40:43], v[136:139], v[140:143], v[40:43]
    ds_read_b64_tr_b16 v[86:87], v13 offset:11264
    ds_read_b128 v[68:71], v10 offset:9216
    v_mfma_f32_16x16x32_bf16 v[24:27], v[148:151], v[160:163], v[24:27]
    ds_read_b128 v[72:75], v10 offset:10240
    ds_read_b128 v[76:79], v11 offset:9216
    v_mfma_f32_16x16x32_bf16 v[28:31], v[148:151], v[164:167], v[28:31]
    ds_read_b64_tr_b16 v[100:101], v12 offset:18432
    ds_read_b64_tr_b16 v[102:103], v12 offset:20480
    v_mfma_f32_16x16x32_bf16 v[32:35], v[152:155], v[160:163], v[32:35]
    ds_read_b64_tr_b16 v[104:105], v13 offset:18432
    ds_read_b64_tr_b16 v[106:107], v13 offset:20480
    v_mfma_f32_16x16x32_bf16 v[36:39], v[152:155], v[164:167], v[36:39]
    ds_read_b128 v[88:91], v10 offset:18432
    ds_read_b128 v[92:95], v10 offset:19456
    v_mfma_f32_16x16x32_bf16 v[40:43], v[156:159], v[160:163], v[40:43]
    ds_read_b128 v[96:99], v11 offset:18432
    ds_read_b64_tr_b16 v[120:121], v12 offset:27648
    v_mfma_f32_16x16x32_bf16 v[24:27], v[168:171], v[180:183], v[24:27]
    ds_read_b64_tr_b16 v[122:123], v12 offset:29696
    ds_read_b64_tr_b16 v[124:125], v13 offset:27648
    v_mfma_f32_16x16x32_bf16 v[28:31], v[168:171], v[184:187], v[28:31]
    ds_read_b64_tr_b16 v[126:127], v13 offset:29696
    ds_read_b128 v[108:111], v10 offset:27648
    v_mfma_f32_16x16x32_bf16 v[32:35], v[172:175], v[180:183], v[32:35]
    ds_read_b128 v[112:115], v10 offset:28672
    ds_read_b128 v[116:119], v11 offset:27648
    v_mfma_f32_16x16x32_bf16 v[36:39], v[172:175], v[184:187], v[36:39]
    v_mfma_f32_16x16x32_bf16 v[40:43], v[176:179], v[180:183], v[40:43]
    v_mfma_f32_16x16x32_bf16 v[24:27], v[188:191], v[200:203], v[24:27]
    v_mfma_f32_16x16x32_bf16 v[28:31], v[188:191], v[204:207], v[28:31]
    v_mfma_f32_16x16x32_bf16 v[32:35], v[192:195], v[200:203], v[32:35]
    v_mfma_f32_16x16x32_bf16 v[36:39], v[192:195], v[204:207], v[36:39]
    v_mfma_f32_16x16x32_bf16 v[40:43], v[196:199], v[200:203], v[40:43]
    s_waitcnt lgkmcnt(0)
    s_barrier
    v_add_u32 v10, 118784, v4
    v_add_u32 v11, 118784, v5
    v_add_u32 v12, 118784, v6
    v_add_u32 v13, 118784, v7
    ds_read_b64_tr_b16 v[140:141], v12 offset:0
    ds_read_b64_tr_b16 v[142:143], v12 offset:2048
    v_mfma_f32_16x16x32_bf16 v[24:27], v[48:51], v[60:63], v[24:27]
    ds_read_b64_tr_b16 v[144:145], v13 offset:0
    ds_read_b64_tr_b16 v[146:147], v13 offset:2048
    v_mfma_f32_16x16x32_bf16 v[28:31], v[48:51], v[64:67], v[28:31]
    ds_read_b128 v[128:131], v10 offset:0
    ds_read_b128 v[132:135], v10 offset:1024
    v_mfma_f32_16x16x32_bf16 v[32:35], v[52:55], v[60:63], v[32:35]
    ds_read_b128 v[136:139], v11 offset:0
    ds_read_b64_tr_b16 v[160:161], v12 offset:9216
    v_mfma_f32_16x16x32_bf16 v[36:39], v[52:55], v[64:67], v[36:39]
    ds_read_b64_tr_b16 v[162:163], v12 offset:11264
    ds_read_b64_tr_b16 v[164:165], v13 offset:9216
    v_mfma_f32_16x16x32_bf16 v[40:43], v[56:59], v[60:63], v[40:43]
    ds_read_b64_tr_b16 v[166:167], v13 offset:11264
    ds_read_b128 v[148:151], v10 offset:9216
    v_mfma_f32_16x16x32_bf16 v[24:27], v[68:71], v[80:83], v[24:27]
    ds_read_b128 v[152:155], v10 offset:10240
    ds_read_b128 v[156:159], v11 offset:9216
    v_mfma_f32_16x16x32_bf16 v[28:31], v[68:71], v[84:87], v[28:31]
    v_mfma_f32_16x16x32_bf16 v[32:35], v[72:75], v[80:83], v[32:35]
    v_mfma_f32_16x16x32_bf16 v[36:39], v[72:75], v[84:87], v[36:39]
    v_mfma_f32_16x16x32_bf16 v[40:43], v[76:79], v[80:83], v[40:43]
    v_mfma_f32_16x16x32_bf16 v[24:27], v[88:91], v[100:103], v[24:27]
    v_mfma_f32_16x16x32_bf16 v[28:31], v[88:91], v[104:107], v[28:31]
    v_mfma_f32_16x16x32_bf16 v[32:35], v[92:95], v[100:103], v[32:35]
    v_mfma_f32_16x16x32_bf16 v[36:39], v[92:95], v[104:107], v[36:39]
    v_mfma_f32_16x16x32_bf16 v[40:43], v[96:99], v[100:103], v[40:43]
    v_mfma_f32_16x16x32_bf16 v[24:27], v[108:111], v[120:123], v[24:27]
    v_mfma_f32_16x16x32_bf16 v[28:31], v[108:111], v[124:127], v[28:31]
    v_mfma_f32_16x16x32_bf16 v[32:35], v[112:115], v[120:123], v[32:35]
    v_mfma_f32_16x16x32_bf16 v[36:39], v[112:115], v[124:127], v[36:39]
    v_mfma_f32_16x16x32_bf16 v[40:43], v[116:119], v[120:123], v[40:43]
    s_waitcnt lgkmcnt(0)
    s_barrier
    v_add_u32 v10, 0, v4
    v_add_u32 v11, 0, v5
    v_add_u32 v12, 0, v8
    v_add_u32 v13, 0, v9
    ds_read_b128 v[60:63], v12 offset:0
    ds_read_b128 v[64:67], v13 offset:0
    v_mfma_f32_16x16x32_bf16 v[24:27], v[128:131], v[140:143], v[24:27]
    ds_read_b128 v[48:51], v10 offset:0
    ds_read_b128 v[52:55], v10 offset:1024
    v_mfma_f32_16x16x32_bf16 v[28:31], v[128:131], v[144:147], v[28:31]
    ds_read_b128 v[56:59], v11 offset:0
    ds_read_b128 v[80:83], v12 offset:9216
    v_mfma_f32_16x16x32_bf16 v[32:35], v[132:135], v[140:143], v[32:35]
    ds_read_b128 v[84:87], v13 offset:9216
    ds_read_b128 v[68:71], v10 offset:9216
    v_mfma_f32_16x16x32_bf16 v[36:39], v[132:135], v[144:147], v[36:39]
    ds_read_b128 v[72:75], v10 offset:10240
    ds_read_b128 v[76:79], v11 offset:9216
    v_mfma_f32_16x16x32_bf16 v[40:43], v[136:139], v[140:143], v[40:43]
    ds_read_b128 v[100:103], v12 offset:18432
    ds_read_b128 v[104:107], v13 offset:18432
    v_mfma_f32_16x16x32_bf16 v[24:27], v[148:151], v[160:163], v[24:27]
    ds_read_b128 v[88:91], v10 offset:18432
    ds_read_b128 v[92:95], v10 offset:19456
    v_mfma_f32_16x16x32_bf16 v[28:31], v[148:151], v[164:167], v[28:31]
    ds_read_b128 v[96:99], v11 offset:18432
    ds_read_b128 v[120:123], v12 offset:27648
    v_mfma_f32_16x16x32_bf16 v[32:35], v[152:155], v[160:163], v[32:35]
    ds_read_b128 v[124:127], v13 offset:27648
    ds_read_b128 v[108:111], v10 offset:27648
    v_mfma_f32_16x16x32_bf16 v[36:39], v[152:155], v[164:167], v[36:39]
    ds_read_b128 v[112:115], v10 offset:28672
    ds_read_b128 v[116:119], v11 offset:27648
    v_mfma_f32_16x16x32_bf16 v[40:43], v[156:159], v[160:163], v[40:43]
    s_waitcnt lgkmcnt(0)
    s_barrier
    v_add_u32 v10, 36864, v4
    v_add_u32 v11, 36864, v5
    v_add_u32 v12, 36864, v8
    v_add_u32 v13, 36864, v9
    ds_read_b128 v[140:143], v12 offset:0
    ds_read_b128 v[144:147], v13 offset:0
    v_mfma_f32_16x16x32_bf16 v[24:27], v[48:51], v[60:63], v[24:27]
    ds_read_b128 v[128:131], v10 offset:0
    ds_read_b128 v[132:135], v10 offset:1024
    v_mfma_f32_16x16x32_bf16 v[28:31], v[48:51], v[64:67], v[28:31]
    ds_read_b128 v[136:139], v11 offset:0
    ds_read_b128 v[160:163], v12 offset:9216
    v_mfma_f32_16x16x32_bf16 v[32:35], v[52:55], v[60:63], v[32:35]
    ds_read_b128 v[164:167], v13 offset:9216
    ds_read_b128 v[148:151], v10 offset:9216
    v_mfma_f32_16x16x32_bf16 v[36:39], v[52:55], v[64:67], v[36:39]
    ds_read_b128 v[152:155], v10 offset:10240
    ds_read_b128 v[156:159], v11 offset:9216
    v_mfma_f32_16x16x32_bf16 v[40:43], v[56:59], v[60:63], v[40:43]
    ds_read_b128 v[180:183], v12 offset:18432
    ds_read_b128 v[184:187], v13 offset:18432
    v_mfma_f32_16x16x32_bf16 v[24:27], v[68:71], v[80:83], v[24:27]
    ds_read_b128 v[168:171], v10 offset:18432
    ds_read_b128 v[172:175], v10 offset:19456
    v_mfma_f32_16x16x32_bf16 v[28:31], v[68:71], v[84:87], v[28:31]
    ds_read_b128 v[176:179], v11 offset:18432
    ds_read_b128 v[200:203], v12 offset:27648
    v_mfma_f32_16x16x32_bf16 v[32:35], v[72:75], v[80:83], v[32:35]
    ds_read_b128 v[204:207], v13 offset:27648
    ds_read_b128 v[188:191], v10 offset:27648
    v_mfma_f32_16x16x32_bf16 v[36:39], v[72:75], v[84:87], v[36:39]
    ds_read_b128 v[192:195], v10 offset:28672
    ds_read_b128 v[196:199], v11 offset:27648
    v_mfma_f32_16x16x32_bf16 v[40:43], v[76:79], v[80:83], v[40:43]
    v_mfma_f32_16x16x32_bf16 v[24:27], v[88:91], v[100:103], v[24:27]
    v_mfma_f32_16x16x32_bf16 v[28:31], v[88:91], v[104:107], v[28:31]
    v_mfma_f32_16x16x32_bf16 v[32:35], v[92:95], v[100:103], v[32:35]
    v_mfma_f32_16x16x32_bf16 v[36:39], v[92:95], v[104:107], v[36:39]
    v_mfma_f32_16x16x32_bf16 v[40:43], v[96:99], v[100:103], v[40:43]
    v_mfma_f32_16x16x32_bf16 v[24:27], v[108:111], v[120:123], v[24:27]
    v_mfma_f32_16x16x32_bf16 v[28:31], v[108:111], v[124:127], v[28:31]
    v_mfma_f32_16x16x32_bf16 v[32:35], v[112:115], v[120:123], v[32:35]
    v_mfma_f32_16x16x32_bf16 v[36:39], v[112:115], v[124:127], v[36:39]
    v_mfma_f32_16x16x32_bf16 v[40:43], v[116:119], v[120:123], v[40:43]
    s_waitcnt lgkmcnt(0)
    s_barrier
    v_add_u32 v10, 81920, v4
    v_add_u32 v11, 81920, v5
    v_add_u32 v12, 81920, v8
    v_add_u32 v13, 81920, v9
    ds_read_b128 v[60:63], v12 offset:0
    ds_read_b128 v[64:67], v13 offset:0
    v_mfma_f32_16x16x32_bf16 v[24:27], v[128:131], v[140:143], v[24:27]
    ds_read_b128 v[48:51], v10 offset:0
    ds_read_b128 v[52:55], v10 offset:1024
    v_mfma_f32_16x16x32_bf16 v[28:31], v[128:131], v[144:147], v[28:31]
    ds_read_b128 v[56:59], v11 offset:0
    ds_read_b128 v[80:83], v12 offset:9216
    v_mfma_f32_16x16x32_bf16 v[32:35], v[132:135], v[140:143], v[32:35]
    ds_read_b128 v[84:87], v13 offset:9216
    ds_read_b128 v[68:71], v10 offset:9216
    v_mfma_f32_16x16x32_bf16 v[36:39], v[132:135], v[144:147], v[36:39]
    ds_read_b128 v[72:75], v10 offset:10240
    ds_read_b128 v[76:79], v11 offset:9216
    v_mfma_f32_16x16x32_bf16 v[40:43], v[136:139], v[140:143], v[40:43]
    ds_read_b128 v[100:103], v12 offset:18432
    ds_read_b128 v[104:107], v13 offset:18432
    v_mfma_f32_16x16x32_bf16 v[24:27], v[148:151], v[160:163], v[24:27]
    ds_read_b128 v[88:91], v10 offset:18432
    ds_read_b128 v[92:95], v10 offset:19456
    v_mfma_f32_16x16x32_bf16 v[28:31], v[148:151], v[164:167], v[28:31]
    ds_read_b128 v[96:99], v11 offset:18432
    ds_read_b128 v[120:123], v12 offset:27648
    v_mfma_f32_16x16x32_bf16 v[32:35], v[152:155], v[160:163], v[32:35]
    ds_read_b128 v[124:127], v13 offset:27648
    ds_read_b128 v[108:111], v10 offset:27648
    v_mfma_f32_16x16x32_bf16 v[36:39], v[152:155], v[164:167], v[36:39]
    ds_read_b128 v[112:115], v10 offset:28672
    ds_read_b128 v[116:119], v11 offset:27648
    v_mfma_f32_16x16x32_bf16 v[40:43], v[156:159], v[160:163], v[40:43]
    v_mfma_f32_16x16x32_bf16 v[24:27], v[168:171], v[180:183], v[24:27]
    v_mfma_f32_16x16x32_bf16 v[28:31], v[168:171], v[184:187], v[28:31]
    v_mfma_f32_16x16x32_bf16 v[32:35], v[172:175], v[180:183], v[32:35]
    v_mfma_f32_16x16x32_bf16 v[36:39], v[172:175], v[184:187], v[36:39]
    v_mfma_f32_16x16x32_bf16 v[40:43], v[176:179], v[180:183], v[40:43]
    v_mfma_f32_16x16x32_bf16 v[24:27], v[188:191], v[200:203], v[24:27]
    v_mfma_f32_16x16x32_bf16 v[28:31], v[188:191], v[204:207], v[28:31]
    v_mfma_f32_16x16x32_bf16 v[32:35], v[192:195], v[200:203], v[32:35]
    v_mfma_f32_16x16x32_bf16 v[36:39], v[192:195], v[204:207], v[36:39]
    v_mfma_f32_16x16x32_bf16 v[40:43], v[196:199], v[200:203], v[40:43]
    s_waitcnt lgkmcnt(0)
    s_barrier
    v_add_u32 v10, 118784, v4
    v_add_u32 v11, 118784, v5
    v_add_u32 v12, 118784, v8
    v_add_u32 v13, 118784, v9
    ds_read_b128 v[140:143], v12 offset:0
    ds_read_b128 v[144:147], v13 offset:0
    v_mfma_f32_16x16x32_bf16 v[24:27], v[48:51], v[60:63], v[24:27]
    ds_read_b128 v[128:131], v10 offset:0
    ds_read_b128 v[132:135], v10 offset:1024
    v_mfma_f32_16x16x32_bf16 v[28:31], v[48:51], v[64:67], v[28:31]
    ds_read_b128 v[136:139], v11 offset:0
    ds_read_b128 v[160:163], v12 offset:9216
    v_mfma_f32_16x16x32_bf16 v[32:35], v[52:55], v[60:63], v[32:35]
    ds_read_b128 v[164:167], v13 offset:9216
    ds_read_b128 v[148:151], v10 offset:9216
    v_mfma_f32_16x16x32_bf16 v[36:39], v[52:55], v[64:67], v[36:39]
    ds_read_b128 v[152:155], v10 offset:10240
    ds_read_b128 v[156:159], v11 offset:9216
    v_mfma_f32_16x16x32_bf16 v[40:43], v[56:59], v[60:63], v[40:43]
    ds_read_b128 v[180:183], v12 offset:18432
    ds_read_b128 v[184:187], v13 offset:18432
    v_mfma_f32_16x16x32_bf16 v[24:27], v[68:71], v[80:83], v[24:27]
    ds_read_b128 v[168:171], v10 offset:18432
    ds_read_b128 v[172:175], v10 offset:19456
    v_mfma_f32_16x16x32_bf16 v[28:31], v[68:71], v[84:87], v[28:31]
    ds_read_b128 v[176:179], v11 offset:18432
    ds_read_b128 v[200:203], v12 offset:27648
    v_mfma_f32_16x16x32_bf16 v[32:35], v[72:75], v[80:83], v[32:35]
    ds_read_b128 v[204:207], v13 offset:27648
    ds_read_b128 v[188:191], v10 offset:27648
    v_mfma_f32_16x16x32_bf16 v[36:39], v[72:75], v[84:87], v[36:39]
    ds_read_b128 v[192:195], v10 offset:28672
    ds_read_b128 v[196:199], v11 offset:27648
    v_mfma_f32_16x16x32_bf16 v[40:43], v[76:79], v[80:83], v[40:43]
    v_mfma_f32_16x16x32_bf16 v[24:27], v[88:91], v[100:103], v[24:27]
    v_mfma_f32_16x16x32_bf16 v[28:31], v[88:91], v[104:107], v[28:31]
    v_mfma_f32_16x16x32_bf16 v[32:35], v[92:95], v[100:103], v[32:35]
    v_mfma_f32_16x16x32_bf16 v[36:39], v[92:95], v[104:107], v[36:39]
    v_mfma_f32_16x16x32_bf16 v[40:43], v[96:99], v[100:103], v[40:43]
    v_mfma_f32_16x16x32_bf16 v[24:27], v[108:111], v[120:123], v[24:27]
    v_mfma_f32_16x16x32_bf16 v[28:31], v[108:111], v[124:127], v[28:31]
    v_mfma_f32_16x16x32_bf16 v[32:35], v[112:115], v[120:123], v[32:35]
    v_mfma_f32_16x16x32_bf16 v[36:39], v[112:115], v[124:127], v[36:39]
    v_mfma_f32_16x16x32_bf16 v[40:43], v[116:119], v[120:123], v[40:43]
    s_waitcnt lgkmcnt(0)
    s_barrier
    v_add_u32 v10, 0, v4
    v_add_u32 v11, 0, v5
    v_add_u32 v12, 0, v8
    v_add_u32 v13, 0, v9
    ds_read_b128 v[60:63], v12 offset:0
    ds_read_b128 v[64:67], v13 offset:0
    v_mfma_f32_16x16x32_bf16 v[24:27], v[128:131], v[140:143], v[24:27]
    ds_read_b128 v[48:51], v10 offset:0
    ds_read_b128 v[52:55], v10 offset:1024
    v_mfma_f32_16x16x32_bf16 v[28:31], v[128:131], v[144:147], v[28:31]
    ds_read_b128 v[56:59], v11 offset:0
    ds_read_b128 v[80:83], v12 offset:9216
    v_mfma_f32_16x16x32_bf16 v[32:35], v[132:135], v[140:143], v[32:35]
    ds_read_b128 v[84:87], v13 offset:9216
    ds_read_b128 v[68:71], v10 offset:9216
    v_mfma_f32_16x16x32_bf16 v[36:39], v[132:135], v[144:147], v[36:39]
    ds_read_b128 v[72:75], v10 offset:10240
    ds_read_b128 v[76:79], v11 offset:9216
    v_mfma_f32_16x16x32_bf16 v[40:43], v[136:139], v[140:143], v[40:43]
    ds_read_b128 v[100:103], v12 offset:18432
    ds_read_b128 v[104:107], v13 offset:18432
    v_mfma_f32_16x16x32_bf16 v[24:27], v[148:151], v[160:163], v[24:27]
    ds_read_b128 v[88:91], v10 offset:18432
    ds_read_b128 v[92:95], v10 offset:19456
    v_mfma_f32_16x16x32_bf16 v[28:31], v[148:151], v[164:167], v[28:31]
    ds_read_b128 v[96:99], v11 offset:18432
    ds_read_b128 v[120:123], v12 offset:27648
    v_mfma_f32_16x16x32_bf16 v[32:35], v[152:155], v[160:163], v[32:35]
    ds_read_b128 v[124:127], v13 offset:27648
    ds_read_b128 v[108:111], v10 offset:27648
    v_mfma_f32_16x16x32_bf16 v[36:39], v[152:155], v[164:167], v[36:39]
    ds_read_b128 v[112:115], v10 offset:28672
    ds_read_b128 v[116:119], v11 offset:27648
    v_mfma_f32_16x16x32_bf16 v[40:43], v[156:159], v[160:163], v[40:43]
    v_mfma_f32_16x16x32_bf16 v[24:27], v[168:171], v[180:183], v[24:27]
    v_mfma_f32_16x16x32_bf16 v[28:31], v[168:171], v[184:187], v[28:31]
    v_mfma_f32_16x16x32_bf16 v[32:35], v[172:175], v[180:183], v[32:35]
    v_mfma_f32_16x16x32_bf16 v[36:39], v[172:175], v[184:187], v[36:39]
    v_mfma_f32_16x16x32_bf16 v[40:43], v[176:179], v[180:183], v[40:43]
    v_mfma_f32_16x16x32_bf16 v[24:27], v[188:191], v[200:203], v[24:27]
    v_mfma_f32_16x16x32_bf16 v[28:31], v[188:191], v[204:207], v[28:31]
    v_mfma_f32_16x16x32_bf16 v[32:35], v[192:195], v[200:203], v[32:35]
    v_mfma_f32_16x16x32_bf16 v[36:39], v[192:195], v[204:207], v[36:39]
    v_mfma_f32_16x16x32_bf16 v[40:43], v[196:199], v[200:203], v[40:43]
    s_waitcnt lgkmcnt(0)
    v_mfma_f32_16x16x32_bf16 v[24:27], v[48:51], v[60:63], v[24:27]
    v_mfma_f32_16x16x32_bf16 v[28:31], v[48:51], v[64:67], v[28:31]
    v_mfma_f32_16x16x32_bf16 v[32:35], v[52:55], v[60:63], v[32:35]
    v_mfma_f32_16x16x32_bf16 v[36:39], v[52:55], v[64:67], v[36:39]
    v_mfma_f32_16x16x32_bf16 v[40:43], v[56:59], v[60:63], v[40:43]
    v_mfma_f32_16x16x32_bf16 v[24:27], v[68:71], v[80:83], v[24:27]
    v_mfma_f32_16x16x32_bf16 v[28:31], v[68:71], v[84:87], v[28:31]
    v_mfma_f32_16x16x32_bf16 v[32:35], v[72:75], v[80:83], v[32:35]
    v_mfma_f32_16x16x32_bf16 v[36:39], v[72:75], v[84:87], v[36:39]
    v_mfma_f32_16x16x32_bf16 v[40:43], v[76:79], v[80:83], v[40:43]
    v_mfma_f32_16x16x32_bf16 v[24:27], v[88:91], v[100:103], v[24:27]
    v_mfma_f32_16x16x32_bf16 v[28:31], v[88:91], v[104:107], v[28:31]
    v_mfma_f32_16x16x32_bf16 v[32:35], v[92:95], v[100:103], v[32:35]
    v_mfma_f32_16x16x32_bf16 v[36:39], v[92:95], v[104:107], v[36:39]
    v_mfma_f32_16x16x32_bf16 v[40:43], v[96:99], v[100:103], v[40:43]
    v_mfma_f32_16x16x32_bf16 v[24:27], v[108:111], v[120:123], v[24:27]
    v_mfma_f32_16x16x32_bf16 v[28:31], v[108:111], v[124:127], v[28:31]
    v_mfma_f32_16x16x32_bf16 v[32:35], v[112:115], v[120:123], v[32:35]
    v_mfma_f32_16x16x32_bf16 v[36:39], v[112:115], v[124:127], v[36:39]
    v_mfma_f32_16x16x32_bf16 v[40:43], v[116:119], v[120:123], v[40:43]
    s_mov_b32 s37, 0xffff0000
    s_waitcnt vmcnt(0)
    v_lshlrev_b32 v58, 16, v218
    v_lshlrev_b32 v60, 16, v219
    v_lshlrev_b32 v64, 16, v208
    v_and_b32 v65, s37, v208
    v_lshlrev_b32 v66, 16, v209
    v_and_b32 v67, s37, v209
    v_pk_add_f32 v[64:65], v[64:65], v[58:59] op_sel_hi:[1,0]
    v_pk_add_f32 v[66:67], v[66:67], v[58:59] op_sel_hi:[1,0]
    v_lshlrev_b32 v68, 16, v210
    v_and_b32 v69, s37, v210
    v_lshlrev_b32 v70, 16, v211
    v_and_b32 v71, s37, v211
    v_pk_add_f32 v[68:69], v[68:69], v[60:61] op_sel_hi:[1,0]
    v_pk_add_f32 v[70:71], v[70:71], v[60:61] op_sel_hi:[1,0]
    v_lshlrev_b32 v72, 16, v212
    v_and_b32 v73, s37, v212
    v_lshlrev_b32 v74, 16, v213
    v_and_b32 v75, s37, v213
    v_pk_add_f32 v[72:73], v[72:73], v[58:59] op_sel_hi:[1,0]
    v_pk_add_f32 v[74:75], v[74:75], v[58:59] op_sel_hi:[1,0]
    v_lshlrev_b32 v76, 16, v214
    v_and_b32 v77, s37, v214
    v_lshlrev_b32 v78, 16, v215
    v_and_b32 v79, s37, v215
    v_pk_add_f32 v[76:77], v[76:77], v[60:61] op_sel_hi:[1,0]
    v_pk_add_f32 v[78:79], v[78:79], v[60:61] op_sel_hi:[1,0]
    v_lshlrev_b32 v80, 16, v216
    v_and_b32 v81, s37, v216
    v_lshlrev_b32 v82, 16, v217
    v_and_b32 v83, s37, v217
    v_pk_add_f32 v[80:81], v[80:81], v[58:59] op_sel_hi:[1,0]
    v_pk_add_f32 v[82:83], v[82:83], v[58:59] op_sel_hi:[1,0]
    v_pk_add_f32 v[24:25], v[24:25], v[64:65]
    v_pk_add_f32 v[26:27], v[26:27], v[66:67]
    v_cvt_pk_bf16_f32 v24, v24, v25
    v_cvt_pk_bf16_f32 v25, v26, v27
    buffer_store_dwordx2 v[24:25], v220, s[52:55], s38 offen offset:0
    v_pk_add_f32 v[28:29], v[28:29], v[68:69]
    v_pk_add_f32 v[30:31], v[30:31], v[70:71]
    v_cvt_pk_bf16_f32 v28, v28, v29
    v_cvt_pk_bf16_f32 v29, v30, v31
    buffer_store_dwordx2 v[28:29], v221, s[52:55], s38 offen offset:0
    v_pk_add_f32 v[32:33], v[32:33], v[72:73]
    v_pk_add_f32 v[34:35], v[34:35], v[74:75]
    v_cvt_pk_bf16_f32 v32, v32, v33
    v_cvt_pk_bf16_f32 v33, v34, v35
    buffer_store_dwordx2 v[32:33], v220, s[52:55], s38 offen offset:32
    v_pk_add_f32 v[36:37], v[36:37], v[76:77]
    v_pk_add_f32 v[38:39], v[38:39], v[78:79]
    v_cvt_pk_bf16_f32 v36, v36, v37
    v_cvt_pk_bf16_f32 v37, v38, v39
    buffer_store_dwordx2 v[36:37], v221, s[52:55], s38 offen offset:32
    v_pk_add_f32 v[40:41], v[40:41], v[80:81]
    v_pk_add_f32 v[42:43], v[42:43], v[82:83]
    v_cvt_pk_bf16_f32 v40, v40, v41
    v_cvt_pk_bf16_f32 v41, v42, v43
    buffer_store_dwordx2 v[40:41], v220, s[52:55], s39 offen offset:64
    s_endpgm
L_loader:
    v_lshrrev_b32 v16, 3, v0
    v_bfe_u32 v17, v0, 4, 1
    v_add_u32 v16, 0, v16
    v_mul_u32_u24 v16, 3840, v16
    v_lshlrev_b32 v17, 1, v17
    v_and_b32 v4, 7, v0
    v_xor_b32 v4, v4, v17
    v_lshl_add_u32 v4, v4, 4, v16
    v_lshrrev_b32 v16, 3, v0
    v_bfe_u32 v17, v0, 4, 1
    v_or_b32 v17, 2, v17
    v_add_u32 v16, 8, v16
    v_mul_u32_u24 v16, 3840, v16
    v_lshlrev_b32 v17, 1, v17
    v_and_b32 v5, 7, v0
    v_xor_b32 v5, v5, v17
    v_lshl_add_u32 v5, v5, 4, v16
    v_subrev_u32 v5, 1024, v5
    v_lshrrev_b32 v16, 3, v0
    v_bfe_u32 v17, v0, 4, 1
    v_add_u32 v16, 16, v16
    v_mul_u32_u24 v16, 3840, v16
    v_lshlrev_b32 v17, 1, v17
    v_and_b32 v6, 7, v0
    v_xor_b32 v6, v6, v17
    v_lshl_add_u32 v6, v6, 4, v16
    v_subrev_u32 v6, 2048, v6
    v_lshrrev_b32 v16, 3, v0
    v_bfe_u32 v17, v0, 4, 1
    v_or_b32 v17, 2, v17
    v_add_u32 v16, 24, v16
    v_mul_u32_u24 v16, 3840, v16
    v_lshlrev_b32 v17, 1, v17
    v_and_b32 v7, 7, v0
    v_xor_b32 v7, v7, v17
    v_lshl_add_u32 v7, v7, 4, v16
    v_subrev_u32 v7, 3072, v7
    s_lshl_b32 s36, s13, 12
    s_add_u32 s36, s36, 81920
    s_lshl_b32 s37, s23, 7
    s_mul_i32 s3, s3, 491520
    s_add_u32 s37, s37, s3
    s_cmp_ge_u32 s23, 30
    s_cselect_b32 s37, 0x7f000000, s37
    s_add_u32 m0, s36, 0
    s_nop 0
    buffer_load_dwordx4 v4, s[28:31], s37 offen offset:0 lds
    buffer_load_dwordx4 v5, s[28:31], s37 offen offset:1024 lds
    buffer_load_dwordx4 v6, s[28:31], s37 offen offset:2048 lds
    buffer_load_dwordx4 v7, s[28:31], s37 offen offset:3072 lds
    s_add_u32 s37, s37, 122880
    s_add_u32 m0, s36, 16384
    s_nop 0
    buffer_load_dwordx4 v4, s[28:31], s37 offen offset:0 lds
    buffer_load_dwordx4 v5, s[28:31], s37 offen offset:1024 lds
    buffer_load_dwordx4 v6, s[28:31], s37 offen offset:2048 lds
    buffer_load_dwordx4 v7, s[28:31], s37 offen offset:3072 lds
    s_add_u32 s37, s37, 122880
    s_waitcnt vmcnt(8)
    s_mov_b32 s49, 0x3f803f80
    v_mov_b32 v24, 0
    v_mov_b32 v25, 0
    v_mov_b32 v26, 0
    v_mov_b32 v27, 0
    v_mov_b32 v28, s49
    s_add_u32 m0, s36, 32768
    s_nop 0
    buffer_load_dwordx4 v4, s[28:31], s37 offen offset:0 lds
    v_dot2_f32_bf16 v24, v64, v28, v24
    v_dot2_f32_bf16 v25, v64, v64, v25
    v_dot2_f32_bf16 v26, v84, v28, v26
    v_dot2_f32_bf16 v27, v84, v84, v27
    v_dot2_f32_bf16 v24, v65, v28, v24
    v_dot2_f32_bf16 v25, v65, v65, v25
    v_dot2_f32_bf16 v26, v85, v28, v26
    v_dot2_f32_bf16 v27, v85, v85, v27
    v_dot2_f32_bf16 v24, v66, v28, v24
    v_dot2_f32_bf16 v25, v66, v66, v25
    v_dot2_f32_bf16 v26, v86, v28, v26
    v_dot2_f32_bf16 v27, v86, v86, v27
    v_dot2_f32_bf16 v24, v67, v28, v24
    v_dot2_f32_bf16 v25, v67, v67, v25
    v_dot2_f32_bf16 v26, v87, v28, v26
    v_dot2_f32_bf16 v27, v87, v87, v27
    v_dot2_f32_bf16 v24, v68, v28, v24
    v_dot2_f32_bf16 v25, v68, v68, v25
    v_dot2_f32_bf16 v26, v88, v28, v26
    v_dot2_f32_bf16 v27, v88, v88, v27
    v_dot2_f32_bf16 v24, v69, v28, v24
    v_dot2_f32_bf16 v25, v69, v69, v25
    v_dot2_f32_bf16 v26, v89, v28, v26
    v_dot2_f32_bf16 v27, v89, v89, v27
    v_dot2_f32_bf16 v24, v70, v28, v24
    v_dot2_f32_bf16 v25, v70, v70, v25
    v_dot2_f32_bf16 v26, v90, v28, v26
    v_dot2_f32_bf16 v27, v90, v90, v27
    buffer_load_dwordx4 v5, s[28:31], s37 offen offset:1024 lds
    v_dot2_f32_bf16 v24, v71, v28, v24
    v_dot2_f32_bf16 v25, v71, v71, v25
    v_dot2_f32_bf16 v26, v91, v28, v26
    v_dot2_f32_bf16 v27, v91, v91, v27
    v_dot2_f32_bf16 v24, v72, v28, v24
    v_dot2_f32_bf16 v25, v72, v72, v25
    v_dot2_f32_bf16 v26, v92, v28, v26
    v_dot2_f32_bf16 v27, v92, v92, v27
    v_dot2_f32_bf16 v24, v73, v28, v24
    v_dot2_f32_bf16 v25, v73, v73, v25
    v_dot2_f32_bf16 v26, v93, v28, v26
    v_dot2_f32_bf16 v27, v93, v93, v27
    v_dot2_f32_bf16 v24, v74, v28, v24
    v_dot2_f32_bf16 v25, v74, v74, v25
    v_dot2_f32_bf16 v26, v94, v28, v26
    v_dot2_f32_bf16 v27, v94, v94, v27
    v_dot2_f32_bf16 v24, v75, v28, v24
    v_dot2_f32_bf16 v25, v75, v75, v25
    v_dot2_f32_bf16 v26, v95, v28, v26
    v_dot2_f32_bf16 v27, v95, v95, v27
    v_dot2_f32_bf16 v24, v76, v28, v24
    v_dot2_f32_bf16 v25, v76, v76, v25
    v_dot2_f32_bf16 v26, v96, v28, v26
    v_dot2_f32_bf16 v27, v96, v96, v27
    v_dot2_f32_bf16 v24, v77, v28, v24
    v_dot2_f32_bf16 v25, v77, v77, v25
    v_dot2_f32_bf16 v26, v97, v28, v26
    v_dot2_f32_bf16 v27, v97, v97, v27
    buffer_load_dwordx4 v6, s[28:31], s37 offen offset:2048 lds
    v_dot2_f32_bf16 v24, v78, v28, v24
    v_dot2_f32_bf16 v25, v78, v78, v25
    v_dot2_f32_bf16 v26, v98, v28, v26
    v_dot2_f32_bf16 v27, v98, v98, v27
    v_dot2_f32_bf16 v24, v79, v28, v24
    v_dot2_f32_bf16 v25, v79, v79, v25
    v_dot2_f32_bf16 v26, v99, v28, v26
    v_dot2_f32_bf16 v27, v99, v99, v27
    v_dot2_f32_bf16 v24, v80, v28, v24
    v_dot2_f32_bf16 v25, v80, v80, v25
    v_dot2_f32_bf16 v26, v100, v28, v26
    v_dot2_f32_bf16 v27, v100, v100, v27
    v_dot2_f32_bf16 v24, v81, v28, v24
    v_dot2_f32_bf16 v25, v81, v81, v25
    v_dot2_f32_bf16 v26, v101, v28, v26
    v_dot2_f32_bf16 v27, v101, v101, v27
    v_dot2_f32_bf16 v24, v82, v28, v24
    v_dot2_f32_bf16 v25, v82, v82, v25
    v_dot2_f32_bf16 v26, v102, v28, v26
    v_dot2_f32_bf16 v27, v102, v102, v27
    v_dot2_f32_bf16 v24, v83, v28, v24
    v_dot2_f32_bf16 v25, v83, v83, v25
    v_dot2_f32_bf16 v26, v103, v28, v26
    v_dot2_f32_bf16 v27, v103, v103, v27
    s_nop 2
    v_add_f32_dpp v24, v24, v24 row_ror:8 row_mask:0xf bank_mask:0xf
    v_add_f32_dpp v25, v25, v25 row_ror:8 row_mask:0xf bank_mask:0xf
    v_add_f32_dpp v26, v26, v26 row_ror:8 row_mask:0xf bank_mask:0xf
    v_add_f32_dpp v27, v27, v27 row_ror:8 row_mask:0xf bank_mask:0xf
    v_add_f32_dpp v24, v24, v24 row_ror:4 row_mask:0xf bank_mask:0xf
    v_add_f32_dpp v25, v25, v25 row_ror:4 row_mask:0xf bank_mask:0xf
    v_add_f32_dpp v26, v26, v26 row_ror:4 row_mask:0xf bank_mask:0xf
    v_add_f32_dpp v27, v27, v27 row_ror:4 row_mask:0xf bank_mask:0xf
    v_add_f32_dpp v24, v24, v24 row_ror:2 row_mask:0xf bank_mask:0xf
    v_add_f32_dpp v25, v25, v25 row_ror:2 row_mask:0xf bank_mask:0xf
    v_add_f32_dpp v26, v26, v26 row_ror:2 row_mask:0xf bank_mask:0xf
    v_add_f32_dpp v27, v27, v27 row_ror:2 row_mask:0xf bank_mask:0xf
    v_add_f32_dpp v24, v24, v24 row_ror:1 row_mask:0xf bank_mask:0xf
    v_add_f32_dpp v25, v25, v25 row_ror:1 row_mask:0xf bank_mask:0xf
    v_add_f32_dpp v26, v26, v26 row_ror:1 row_mask:0xf bank_mask:0xf
    v_add_f32_dpp v27, v27, v27 row_ror:1 row_mask:0xf bank_mask:0xf
    s_mov_b32 s50, 0x3acccccd
    s_mov_b32 s51, 0x3727c5ac
    v_mul_f32 v30, s50, v24
    v_mul_f32 v31, s50, v25
    v_fma_f32 v31, -v30, v30, v31
    v_max_f32 v31, 0, v31
    v_add_f32 v32, s51, v31
    v_rsq_f32 v32, v32
    s_nop 0
    v_mul_f32 v31, v31, v32
    v_mul_f32 v34, -v30, v32
    v_fma_f32 v40, v31, v32, s51
    v_rsq_f32 v40, v40
    v_mul_f32 v30, s50, v26
    v_mul_f32 v31, s50, v27
    v_fma_f32 v31, -v30, v30, v31
    v_max_f32 v31, 0, v31
    v_add_f32 v36, s51, v31
    v_rsq_f32 v36, v36
    s_nop 0
    v_mul_f32 v31, v31, v36
    v_mul_f32 v38, -v30, v36
    v_fma_f32 v41, v31, v36, s51
    v_rsq_f32 v41, v41
    v_lshrrev_b32 v20, 4, v0
    v_add_u32 v23, s52, v20
    v_add_u32 v20, s8, v23
    v_xor_b32 v21, v20, v0
    v_and_b32 v21, 15, v21
    v_mul_u32_u24 v22, 1280, v20
    v_lshl_add_u32 v42, v21, 4, v22
    v_lshlrev_b32 v22, 2, v20
    v_add_u32 v22, 151552, v22
    ds_write_b32 v22, v40
    v_add_u32 v20, s9, v23
    v_xor_b32 v21, v20, v0
    v_and_b32 v21, 15, v21
    v_mul_u32_u24 v22, 1280, v20
    v_lshl_add_u32 v43, v21, 4, v22
    v_lshlrev_b32 v22, 2, v20
    v_add_u32 v22, 151552, v22
    ds_write_b32 v22, v41
    s_mov_b32 s53, 0xffff0000
    buffer_load_dwordx4 v7, s[28:31], s37 offen offset:3072 lds
    s_add_u32 s37, s37, 122880
    v_lshlrev_b32 v44, 16, v64
    v_and_b32 v45, s53, v64
    v_lshlrev_b32 v46, 16, v65
    v_and_b32 v47, s53, v65
    v_lshlrev_b32 v48, 16, v66
    v_and_b32 v49, s53, v66
    v_lshlrev_b32 v50, 16, v67
    v_and_b32 v51, s53, v67
    v_pk_fma_f32 v[44:45], v[44:45], v[32:33], v[34:35] op_sel_hi:[1,0,0]
    v_pk_fma_f32 v[46:47], v[46:47], v[32:33], v[34:35] op_sel_hi:[1,0,0]
    v_pk_fma_f32 v[48:49], v[48:49], v[32:33], v[34:35] op_sel_hi:[1,0,0]
    v_pk_fma_f32 v[50:51], v[50:51], v[32:33], v[34:35] op_sel_hi:[1,0,0]
    v_cvt_pk_bf16_f32 v64, v44, v45
    v_cvt_pk_bf16_f32 v65, v46, v47
    v_cvt_pk_bf16_f32 v66, v48, v49
    v_cvt_pk_bf16_f32 v67, v50, v51
    ds_write_b128 v42, v[64:67] offset:0
    s_add_u32 m0, s36, 49152
    s_nop 0
    buffer_load_dwordx4 v4, s[28:31], s37 offen offset:0 lds
    v_lshlrev_b32 v44, 16, v68
    v_and_b32 v45, s53, v68
    v_lshlrev_b32 v46, 16, v69
    v_and_b32 v47, s53, v69
    v_lshlrev_b32 v48, 16, v70
    v_and_b32 v49, s53, v70
    v_lshlrev_b32 v50, 16, v71
    v_and_b32 v51, s53, v71
    v_pk_fma_f32 v[44:45], v[44:45], v[32:33], v[34:35] op_sel_hi:[1,0,0]
    v_pk_fma_f32 v[46:47], v[46:47], v[32:33], v[34:35] op_sel_hi:[1,0,0]
    v_pk_fma_f32 v[48:49], v[48:49], v[32:33], v[34:35] op_sel_hi:[1,0,0]
    v_pk_fma_f32 v[50:51], v[50:51], v[32:33], v[34:35] op_sel_hi:[1,0,0]
    v_cvt_pk_bf16_f32 v68, v44, v45
    v_cvt_pk_bf16_f32 v69, v46, v47
    v_cvt_pk_bf16_f32 v70, v48, v49
    v_cvt_pk_bf16_f32 v71, v50, v51
    ds_write_b128 v42, v[68:71] offset:256
    buffer_load_dwordx4 v5, s[28:31], s37 offen offset:1024 lds
    v_lshlrev_b32 v44, 16, v72
    v_and_b32 v45, s53, v72
    v_lshlrev_b32 v46, 16, v73
    v_and_b32 v47, s53, v73
    v_lshlrev_b32 v48, 16, v74
    v_and_b32 v49, s53, v74
    v_lshlrev_b32 v50, 16, v75
    v_and_b32 v51, s53, v75
    v_pk_fma_f32 v[44:45], v[44:45], v[32:33], v[34:35] op_sel_hi:[1,0,0]
    v_pk_fma_f32 v[46:47], v[46:47], v[32:33], v[34:35] op_sel_hi:[1,0,0]
    v_pk_fma_f32 v[48:49], v[48:49], v[32:33], v[34:35] op_sel_hi:[1,0,0]
    v_pk_fma_f32 v[50:51], v[50:51], v[32:33], v[34:35] op_sel_hi:[1,0,0]
    v_cvt_pk_bf16_f32 v72, v44, v45
    v_cvt_pk_bf16_f32 v73, v46, v47
    v_cvt_pk_bf16_f32 v74, v48, v49
    v_cvt_pk_bf16_f32 v75, v50, v51
    ds_write_b128 v42, v[72:75] offset:512
    buffer_load_dwordx4 v6, s[28:31], s37 offen offset:2048 lds
    v_lshlrev_b32 v44, 16, v76
    v_and_b32 v45, s53, v76
    v_lshlrev_b32 v46, 16, v77
    v_and_b32 v47, s53, v77
    v_lshlrev_b32 v48, 16, v78
    v_and_b32 v49, s53, v78
    v_lshlrev_b32 v50, 16, v79
    v_and_b32 v51, s53, v79
    v_pk_fma_f32 v[44:45], v[44:45], v[32:33], v[34:35] op_sel_hi:[1,0,0]
    v_pk_fma_f32 v[46:47], v[46:47], v[32:33], v[34:35] op_sel_hi:[1,0,0]
    v_pk_fma_f32 v[48:49], v[48:49], v[32:33], v[34:35] op_sel_hi:[1,0,0]
    v_pk_fma_f32 v[50:51], v[50:51], v[32:33], v[34:35] op_sel_hi:[1,0,0]
    v_cvt_pk_bf16_f32 v76, v44, v45
    v_cvt_pk_bf16_f32 v77, v46, v47
    v_cvt_pk_bf16_f32 v78, v48, v49
    v_cvt_pk_bf16_f32 v79, v50, v51
    ds_write_b128 v42, v[76:79] offset:768
    buffer_load_dwordx4 v7, s[28:31], s37 offen offset:3072 lds
    s_add_u32 s37, s37, 122880
    s_sub_u32 s3, s37, 2457600
    s_cmp_ge_u32 s37, 2457600
    s_cselect_b32 s37, s3, s37
    v_lshlrev_b32 v44, 16, v80
    v_and_b32 v45, s53, v80
    v_lshlrev_b32 v46, 16, v81
    v_and_b32 v47, s53, v81
    v_lshlrev_b32 v48, 16, v82
    v_and_b32 v49, s53, v82
    v_lshlrev_b32 v50, 16, v83
    v_and_b32 v51, s53, v83
    v_pk_fma_f32 v[44:45], v[44:45], v[32:33], v[34:35] op_sel_hi:[1,0,0]
    v_pk_fma_f32 v[46:47], v[46:47], v[32:33], v[34:35] op_sel_hi:[1,0,0]
    v_pk_fma_f32 v[48:49], v[48:49], v[32:33], v[34:35] op_sel_hi:[1,0,0]
    v_pk_fma_f32 v[50:51], v[50:51], v[32:33], v[34:35] op_sel_hi:[1,0,0]
    v_cvt_pk_bf16_f32 v80, v44, v45
    v_cvt_pk_bf16_f32 v81, v46, v47
    v_cvt_pk_bf16_f32 v82, v48, v49
    v_cvt_pk_bf16_f32 v83, v50, v51
    ds_write_b128 v42, v[80:83] offset:1024
    v_lshlrev_b32 v44, 16, v84
    v_and_b32 v45, s53, v84
    v_lshlrev_b32 v46, 16, v85
    v_and_b32 v47, s53, v85
    v_lshlrev_b32 v48, 16, v86
    v_and_b32 v49, s53, v86
    v_lshlrev_b32 v50, 16, v87
    v_and_b32 v51, s53, v87
    v_pk_fma_f32 v[44:45], v[44:45], v[36:37], v[38:39] op_sel_hi:[1,0,0]
    v_pk_fma_f32 v[46:47], v[46:47], v[36:37], v[38:39] op_sel_hi:[1,0,0]
    v_pk_fma_f32 v[48:49], v[48:49], v[36:37], v[38:39] op_sel_hi:[1,0,0]
    v_pk_fma_f32 v[50:51], v[50:51], v[36:37], v[38:39] op_sel_hi:[1,0,0]
    v_cvt_pk_bf16_f32 v84, v44, v45
    v_cvt_pk_bf16_f32 v85, v46, v47
    v_cvt_pk_bf16_f32 v86, v48, v49
    v_cvt_pk_bf16_f32 v87, v50, v51
    ds_write_b128 v43, v[84:87] offset:0
    v_lshlrev_b32 v44, 16, v88
    v_and_b32 v45, s53, v88
    v_lshlrev_b32 v46, 16, v89
    v_and_b32 v47, s53, v89
    v_lshlrev_b32 v48, 16, v90
    v_and_b32 v49, s53, v90
    v_lshlrev_b32 v50, 16, v91
    v_and_b32 v51, s53, v91
    v_pk_fma_f32 v[44:45], v[44:45], v[36:37], v[38:39] op_sel_hi:[1,0,0]
    v_pk_fma_f32 v[46:47], v[46:47], v[36:37], v[38:39] op_sel_hi:[1,0,0]
    v_pk_fma_f32 v[48:49], v[48:49], v[36:37], v[38:39] op_sel_hi:[1,0,0]
    v_pk_fma_f32 v[50:51], v[50:51], v[36:37], v[38:39] op_sel_hi:[1,0,0]
    v_cvt_pk_bf16_f32 v88, v44, v45
    v_cvt_pk_bf16_f32 v89, v46, v47
    v_cvt_pk_bf16_f32 v90, v48, v49
    v_cvt_pk_bf16_f32 v91, v50, v51
    ds_write_b128 v43, v[88:91] offset:256
    v_lshlrev_b32 v44, 16, v92
    v_and_b32 v45, s53, v92
    v_lshlrev_b32 v46, 16, v93
    v_and_b32 v47, s53, v93
    v_lshlrev_b32 v48, 16, v94
    v_and_b32 v49, s53, v94
    v_lshlrev_b32 v50, 16, v95
    v_and_b32 v51, s53, v95
    v_pk_fma_f32 v[44:45], v[44:45], v[36:37], v[38:39] op_sel_hi:[1,0,0]
    v_pk_fma_f32 v[46:47], v[46:47], v[36:37], v[38:39] op_sel_hi:[1,0,0]
    v_pk_fma_f32 v[48:49], v[48:49], v[36:37], v[38:39] op_sel_hi:[1,0,0]
    v_pk_fma_f32 v[50:51], v[50:51], v[36:37], v[38:39] op_sel_hi:[1,0,0]
    v_cvt_pk_bf16_f32 v92, v44, v45
    v_cvt_pk_bf16_f32 v93, v46, v47
    v_cvt_pk_bf16_f32 v94, v48, v49
    v_cvt_pk_bf16_f32 v95, v50, v51
    ds_write_b128 v43, v[92:95] offset:512
    v_lshlrev_b32 v44, 16, v96
    v_and_b32 v45, s53, v96
    v_lshlrev_b32 v46, 16, v97
    v_and_b32 v47, s53, v97
    v_lshlrev_b32 v48, 16, v98
    v_and_b32 v49, s53, v98
    v_lshlrev_b32 v50, 16, v99
    v_and_b32 v51, s53, v99
    v_pk_fma_f32 v[44:45], v[44:45], v[36:37], v[38:39] op_sel_hi:[1,0,0]
    v_pk_fma_f32 v[46:47], v[46:47], v[36:37], v[38:39] op_sel_hi:[1,0,0]
    v_pk_fma_f32 v[48:49], v[48:49], v[36:37], v[38:39] op_sel_hi:[1,0,0]
    v_pk_fma_f32 v[50:51], v[50:51], v[36:37], v[38:39] op_sel_hi:[1,0,0]
    v_cvt_pk_bf16_f32 v96, v44, v45
    v_cvt_pk_bf16_f32 v97, v46, v47
    v_cvt_pk_bf16_f32 v98, v48, v49
    v_cvt_pk_bf16_f32 v99, v50, v51
    ds_write_b128 v43, v[96:99] offset:768
    v_lshlrev_b32 v44, 16, v100
    v_and_b32 v45, s53, v100
    v_lshlrev_b32 v46, 16, v101
    v_and_b32 v47, s53, v101
    v_lshlrev_b32 v48, 16, v102
    v_and_b32 v49, s53, v102
    v_lshlrev_b32 v50, 16, v103
    v_and_b32 v51, s53, v103
    v_pk_fma_f32 v[44:45], v[44:45], v[36:37], v[38:39] op_sel_hi:[1,0,0]
    v_pk_fma_f32 v[46:47], v[46:47], v[36:37], v[38:39] op_sel_hi:[1,0,0]
    v_pk_fma_f32 v[48:49], v[48:49], v[36:37], v[38:39] op_sel_hi:[1,0,0]
    v_pk_fma_f32 v[50:51], v[50:51], v[36:37], v[38:39] op_sel_hi:[1,0,0]
    v_cvt_pk_bf16_f32 v100, v44, v45
    v_cvt_pk_bf16_f32 v101, v46, v47
    v_cvt_pk_bf16_f32 v102, v48, v49
    v_cvt_pk_bf16_f32 v103, v50, v51
    ds_write_b128 v43, v[100:103] offset:1024
    s_waitcnt lgkmcnt(0)
    s_waitcnt vmcnt(12)
    s_barrier
    buffer_load_dword v251, v252, s[56:59], 0 offen sc1
    v_lshrrev_b32 v16, 3, v0
    v_bfe_u32 v17, v0, 4, 2
    v_add_u32 v16, 0, v16
    v_mul_u32_u24 v16, 3456, v16
    v_lshlrev_b32 v17, 1, v17
    v_and_b32 v8, 7, v0
    v_xor_b32 v8, v8, v17
    v_lshl_add_u32 v8, v8, 4, v16
    v_lshrrev_b32 v16, 3, v0
    v_bfe_u32 v17, v0, 4, 2
    v_add_u32 v16, 8, v16
    v_mul_u32_u24 v16, 3456, v16
    v_lshlrev_b32 v17, 1, v17
    v_and_b32 v9, 7, v0
    v_xor_b32 v9, v9, v17
    v_lshl_add_u32 v9, v9, 4, v16
    v_subrev_u32 v9, 1024, v9
    v_lshrrev_b32 v16, 3, v0
    v_bfe_u32 v17, v0, 4, 2
    v_add_u32 v16, 16, v16
    v_mul_u32_u24 v16, 3456, v16
    v_lshlrev_b32 v17, 1, v17
    v_and_b32 v10, 7, v0
    v_xor_b32 v10, v10, v17
    v_lshl_add_u32 v10, v10, 4, v16
    v_subrev_u32 v10, 2048, v10
    v_lshrrev_b32 v16, 3, v0
    v_bfe_u32 v17, v0, 4, 2
    v_add_u32 v16, 24, v16
    v_mul_u32_u24 v16, 3456, v16
    v_lshlrev_b32 v17, 1, v17
    v_and_b32 v11, 7, v0
    v_xor_b32 v11, v11, v17
    v_lshl_add_u32 v11, v11, 4, v16
    v_subrev_u32 v11, 3072, v11
    v_lshrrev_b32 v16, 3, v0
    v_bfe_u32 v17, v0, 4, 2
    v_add_u32 v16, 0, v16
    v_mul_u32_u24 v16, 4096, v16
    v_lshlrev_b32 v17, 1, v17
    v_and_b32 v240, 7, v0
    v_xor_b32 v240, v240, v17
    v_lshl_add_u32 v240, v240, 4, v16
    v_lshrrev_b32 v16, 3, v0
    v_bfe_u32 v17, v0, 4, 2
    v_add_u32 v16, 8, v16
    v_mul_u32_u24 v16, 4096, v16
    v_lshlrev_b32 v17, 1, v17
    v_and_b32 v241, 7, v0
    v_xor_b32 v241, v241, v17
    v_lshl_add_u32 v241, v241, 4, v16
    v_subrev_u32 v241, 1024, v241
    v_lshrrev_b32 v16, 3, v0
    v_bfe_u32 v17, v0, 4, 2
    v_add_u32 v16, 16, v16
    v_mul_u32_u24 v16, 4096, v16
    v_lshlrev_b32 v17, 1, v17
    v_and_b32 v242, 7, v0
    v_xor_b32 v242, v242, v17
    v_lshl_add_u32 v242, v242, 4, v16
    v_subrev_u32 v242, 2048, v242
    v_lshrrev_b32 v16, 3, v0
    v_bfe_u32 v17, v0, 4, 2
    v_add_u32 v16, 24, v16
    v_mul_u32_u24 v16, 4096, v16
    v_lshlrev_b32 v17, 1, v17
    v_and_b32 v243, 7, v0
    v_xor_b32 v243, v243, v17
    v_lshl_add_u32 v243, v243, 4, v16
    v_subrev_u32 v243, 3072, v243
    v_lshlrev_b32 v244, 4, v0
    v_add_u32 v245, 0x1000, v244
    s_mul_i32 s40, s13, 9216
    s_mul_i32 s41, s13, 110592
    s_lshl_b32 s21, s10, 7
    s_add_u32 s41, s41, s21
    s_lshl_b32 s42, s11, 6
    s_add_u32 s42, s42, s13
    s_mul_i32 s42, s42, 5120
    s_lshl_b32 s38, s13, 17
    s_lshl_b32 s21, s16, 7
    s_add_u32 s38, s38, s21
    s_mul_i32 s39, s13, 5120
    s_and_b32 s60, s10, 4
    s_lshl_b32 s60, s60, 1
    s_mul_i32 s43, s16, 20
    s_add_u32 s43, s43, s13
    s_lshl_b32 s43, s43, 12
    s_add_u32 s43, s43, 14155776
    s_mul_i32 s61, s18, 20
    s_add_u32 s61, s61, s13
    s_mul_i32 s61, s61, 5120
    s_add_u32 s61, s61, 13107200
    s_mov_b32 s44, s72
    s_mov_b32 s45, s73
    s_mov_b32 s46, 0x6c0000
    s_mov_b32 s47, 0x20000
    s_mov_b32 s48, s76
    s_mov_b32 s49, s77
    s_mov_b32 s50, 0x6c0000
    s_mov_b32 s51, 0x20000
    s_waitcnt vmcnt(9)
    s_barrier
    s_add_u32 m0, s36, 65536
    s_nop 0
    buffer_load_dwordx4 v4, s[28:31], s37 offen offset:0 lds
    buffer_load_dwordx4 v5, s[28:31], s37 offen offset:1024 lds
    buffer_load_dwordx4 v6, s[28:31], s37 offen offset:2048 lds
    buffer_load_dwordx4 v7, s[28:31], s37 offen offset:3072 lds
    s_add_u32 s37, s37, 122880
    s_add_u32 m0, s36, 0
    s_nop 0
    buffer_load_dwordx4 v4, s[28:31], s37 offen offset:0 lds
    buffer_load_dwordx4 v5, s[28:31], s37 offen offset:1024 lds
    buffer_load_dwordx4 v6, s[28:31], s37 offen offset:2048 lds
    buffer_load_dwordx4 v7, s[28:31], s37 offen offset:3072 lds
    s_add_u32 s37, s37, 122880
    s_waitcnt vmcnt(13)
    s_barrier
    s_add_u32 m0, s36, 16384
    s_nop 0
    buffer_load_dwordx4 v4, s[28:31], s37 offen offset:0 lds
    buffer_load_dwordx4 v5, s[28:31], s37 offen offset:1024 lds
    buffer_load_dwordx4 v6, s[28:31], s37 offen offset:2048 lds
    buffer_load_dwordx4 v7, s[28:31], s37 offen offset:3072 lds
    s_add_u32 s37, s37, 122880
    s_waitcnt vmcnt(13)
    s_barrier
    s_add_u32 m0, s36, 32768
    s_nop 0
    buffer_load_dwordx4 v4, s[28:31], s37 offen offset:0 lds
    buffer_load_dwordx4 v5, s[28:31], s37 offen offset:1024 lds
    buffer_load_dwordx4 v6, s[28:31], s37 offen offset:2048 lds
    buffer_load_dwordx4 v7, s[28:31], s37 offen offset:3072 lds
    s_add_u32 s37, s37, 122880
    s_sub_u32 s3, s37, 2457600
    s_cmp_ge_u32 s37, 2457600
    s_cselect_b32 s37, s3, s37
    s_waitcnt vmcnt(12)
    s_barrier
    s_add_u32 m0, s36, 49152
    s_nop 0
    buffer_load_dwordx4 v4, s[28:31], s37 offen offset:0 lds
    buffer_load_dwordx4 v5, s[28:31], s37 offen offset:1024 lds
    buffer_load_dwordx4 v6, s[28:31], s37 offen offset:2048 lds
    buffer_load_dwordx4 v7, s[28:31], s37 offen offset:3072 lds
    s_add_u32 s37, s37, 122880
    s_mov_b32 s63, 200000
LN3:
    v_readfirstlane_b32 s62, v251
    s_cmp_lg_u32 s62, 0
    s_cbranch_scc1 LNo3
    s_sub_u32 s63, s63, 1
    s_cmp_eq_u32 s63, 0
    s_cbranch_scc1 LNo3
    buffer_load_dword v251, v252, s[56:59], 0 offen sc1
    s_waitcnt vmcnt(0)
    s_branch LN3
LNo3:
    v_and_b32 v16, 31, v0
    v_lshlrev_b32 v16, 7, v16
    s_lshl_b32 s21, s11, 12
    s_add_u32 s21, s21, 17301504
    v_add_u32 v250, s21, v16
    s_waitcnt vmcnt(12)
    s_barrier
    s_add_u32 m0, s36, 65536
    s_nop 0
    buffer_load_dwordx4 v4, s[28:31], s37 offen offset:0 lds
    buffer_load_dwordx4 v5, s[28:31], s37 offen offset:1024 lds
    buffer_load_dwordx4 v6, s[28:31], s37 offen offset:2048 lds
    buffer_load_dwordx4 v7, s[28:31], s37 offen offset:3072 lds
    s_add_u32 s37, s37, 122880
    s_waitcnt vmcnt(12)
    s_barrier
    s_add_u32 m0, s36, 0
    s_nop 0
    buffer_load_dwordx4 v4, s[28:31], s37 offen offset:0 lds
    buffer_load_dwordx4 v5, s[28:31], s37 offen offset:1024 lds
    buffer_load_dwordx4 v6, s[28:31], s37 offen offset:2048 lds
    buffer_load_dwordx4 v7, s[28:31], s37 offen offset:3072 lds
    s_add_u32 s37, s37, 122880
    s_waitcnt vmcnt(12)
    s_barrier
    s_add_u32 m0, s36, 16384
    s_nop 0
    buffer_load_dwordx4 v4, s[28:31], s37 offen offset:0 lds
    buffer_load_dwordx4 v5, s[28:31], s37 offen offset:1024 lds
    buffer_load_dwordx4 v6, s[28:31], s37 offen offset:2048 lds
    buffer_load_dwordx4 v7, s[28:31], s37 offen offset:3072 lds
    s_add_u32 s37, s37, 122880
    s_sub_u32 s3, s37, 2457600
    s_cmp_ge_u32 s37, 2457600
    s_cselect_b32 s37, s3, s37
    s_waitcnt vmcnt(12)
    s_barrier
    s_add_u32 m0, s36, 32768
    s_nop 0
    buffer_load_dwordx4 v4, s[28:31], s37 offen offset:0 lds
    buffer_load_dwordx4 v5, s[28:31], s37 offen offset:1024 lds
    buffer_load_dwordx4 v6, s[28:31], s37 offen offset:2048 lds
    buffer_load_dwordx4 v7, s[28:31], s37 offen offset:3072 lds
    s_add_u32 s37, s37, 122880
    s_waitcnt vmcnt(12)
    s_barrier
    s_add_u32 m0, s36, 49152
    s_nop 0
    buffer_load_dwordx4 v4, s[28:31], s37 offen offset:0 lds
    buffer_load_dwordx4 v5, s[28:31], s37 offen offset:1024 lds
    buffer_load_dwordx4 v6, s[28:31], s37 offen offset:2048 lds
    buffer_load_dwordx4 v7, s[28:31], s37 offen offset:3072 lds
    s_add_u32 s37, s37, 122880
    s_waitcnt vmcnt(12)
    s_barrier
    s_add_u32 m0, s36, 65536
    s_nop 0
    buffer_load_dwordx4 v4, s[28:31], s37 offen offset:0 lds
    buffer_load_dwordx4 v5, s[28:31], s37 offen offset:1024 lds
    buffer_load_dwordx4 v6, s[28:31], s37 offen offset:2048 lds
    buffer_load_dwordx4 v7, s[28:31], s37 offen offset:3072 lds
    s_add_u32 s37, s37, 122880
    s_waitcnt vmcnt(12)
    s_barrier
    s_add_u32 m0, s36, 0
    s_nop 0
    buffer_load_dwordx4 v4, s[28:31], s37 offen offset:0 lds
    buffer_load_dwordx4 v5, s[28:31], s37 offen offset:1024 lds
    buffer_load_dwordx4 v6, s[28:31], s37 offen offset:2048 lds
    buffer_load_dwordx4 v7, s[28:31], s37 offen offset:3072 lds
    s_add_u32 s37, s37, 122880
    s_sub_u32 s3, s37, 2457600
    s_cmp_ge_u32 s37, 2457600
    s_cselect_b32 s37, s3, s37
    s_waitcnt vmcnt(12)
    s_barrier
    s_add_u32 m0, s36, 16384
    s_nop 0
    buffer_load_dwordx4 v4, s[28:31], s37 offen offset:0 lds
    buffer_load_dwordx4 v5, s[28:31], s37 offen offset:1024 lds
    buffer_load_dwordx4 v6, s[28:31], s37 offen offset:2048 lds
    buffer_load_dwordx4 v7, s[28:31], s37 offen offset:3072 lds
    s_add_u32 s37, s37, 122880
    s_waitcnt vmcnt(12)
    s_barrier
    s_add_u32 m0, s36, 32768
    s_nop 0
    buffer_load_dwordx4 v4, s[28:31], s37 offen offset:0 lds
    buffer_load_dwordx4 v5, s[28:31], s37 offen offset:1024 lds
    buffer_load_dwordx4 v6, s[28:31], s37 offen offset:2048 lds
    buffer_load_dwordx4 v7, s[28:31], s37 offen offset:3072 lds
    s_add_u32 s37, s37, 122880
    s_waitcnt vmcnt(12)
    s_barrier
    s_add_u32 m0, s36, 49152
    s_nop 0
    buffer_load_dwordx4 v4, s[28:31], s37 offen offset:0 lds
    buffer_load_dwordx4 v5, s[28:31], s37 offen offset:1024 lds
    buffer_load_dwordx4 v6, s[28:31], s37 offen offset:2048 lds
    buffer_load_dwordx4 v7, s[28:31], s37 offen offset:3072 lds
    s_add_u32 s37, s37, 122880
    s_waitcnt vmcnt(12)
    s_barrier
    s_add_u32 m0, s36, 65536
    s_nop 0
    buffer_load_dwordx4 v4, s[28:31], s37 offen offset:0 lds
    buffer_load_dwordx4 v5, s[28:31], s37 offen offset:1024 lds
    buffer_load_dwordx4 v6, s[28:31], s37 offen offset:2048 lds
    buffer_load_dwordx4 v7, s[28:31], s37 offen offset:3072 lds
    s_add_u32 s37, s37, 122880
    s_sub_u32 s3, s37, 2457600
    s_cmp_ge_u32 s37, 2457600
    s_cselect_b32 s37, s3, s37
    s_waitcnt vmcnt(12)
    s_barrier
    s_waitcnt vmcnt(8)
    s_barrier
    buffer_load_dwordx4 v[246:249], v250, s[32:35], 0 offen sc1
    s_waitcnt vmcnt(1)
    s_barrier
    s_cmp_ge_u32 s15, 27
    s_cbranch_scc1 L_ldh
    s_add_u32 s3, s98, 0
    s_and_b32 s3, s3, 3
    s_mul_i32 s3, s3, 442368
    s_add_u32 s3, s3, s41
    s_add_u32 m0, s40, 87040
    s_nop 0
    buffer_load_dwordx4 v8, s[44:47], s3 offen offset:0 lds
    buffer_load_dwordx4 v9, s[44:47], s3 offen offset:1024 lds
    buffer_load_dwordx4 v10, s[44:47], s3 offen offset:2048 lds
    buffer_load_dwordx4 v11, s[44:47], s3 offen offset:3072 lds
    s_barrier
    s_waitcnt vmcnt(4)
    s_mov_b32 s63, 200000
LP4:
    v_xor_b32 v246, s62, v246
    v_xor_b32 v247, s62, v247
    v_xor_b32 v248, s62, v248
    v_xor_b32 v249, s62, v249
    v_or3_b32 v246, v246, v247, v248
    v_or_b32 v246, v246, v249
    v_cmp_ne_u32 vcc, 0, v246
    s_nop 1
    s_cmp_eq_u64 vcc, 0
    s_cbranch_scc1 LPo4
    s_sub_u32 s63, s63, 1
    s_cmp_eq_u32 s63, 0
    s_cbranch_scc1 LPo4
    buffer_load_dwordx4 v[246:249], v250, s[32:35], 0 offen sc1
    s_waitcnt vmcnt(0)
    s_branch LP4
LPo4:
    s_add_u32 s3, s98, 0
    s_and_b32 s3, s3, 3
    s_mul_i32 s3, s3, 20480
    s_add_u32 s3, s3, s42
    s_add_u32 m0, s40, 81920
    s_nop 0
    buffer_load_dwordx4 v244, s[32:35], s3 offen offset:0 sc1 lds
    buffer_load_dwordx4 v244, s[32:35], s3 offen offset:1024 sc1 lds
    buffer_load_dwordx4 v244, s[32:35], s3 offen offset:2048 sc1 lds
    buffer_load_dwordx4 v244, s[32:35], s3 offen offset:3072 sc1 lds
    s_add_u32 m0, s40, 86016
    s_nop 0
    buffer_load_dwordx4 v245, s[32:35], s3 offen offset:0 sc1 lds
    s_add_u32 s3, s98, 0
    s_and_b32 s3, s3, 3
    s_add_u32 s3, s3, 4
    s_mul_i32 s3, s3, 442368
    s_add_u32 s3, s3, s41
    s_add_u32 m0, s40, 123904
    s_nop 0
    buffer_load_dwordx4 v8, s[44:47], s3 offen offset:0 lds
    buffer_load_dwordx4 v9, s[44:47], s3 offen offset:1024 lds
    buffer_load_dwordx4 v10, s[44:47], s3 offen offset:2048 lds
    buffer_load_dwordx4 v11, s[44:47], s3 offen offset:3072 lds
    s_add_u32 s3, s98, 0
    s_and_b32 s3, s3, 3
    s_add_u32 s3, s3, 4
    s_mul_i32 s3, s3, 20480
    s_add_u32 s3, s3, s42
    s_add_u32 m0, s40, 118784
    s_nop 0
    buffer_load_dwordx4 v244, s[32:35], s3 offen offset:0 sc1 lds
    buffer_load_dwordx4 v244, s[32:35], s3 offen offset:1024 sc1 lds
    buffer_load_dwordx4 v244, s[32:35], s3 offen offset:2048 sc1 lds
    buffer_load_dwordx4 v244, s[32:35], s3 offen offset:3072 sc1 lds
    s_add_u32 m0, s40, 122880
    s_nop 0
    buffer_load_dwordx4 v245, s[32:35], s3 offen offset:0 sc1 lds
    s_add_u32 s3, s98, 1
    s_and_b32 s3, s3, 3
    s_mul_i32 s3, s3, 442368
    s_add_u32 s3, s3, s41
    s_add_u32 m0, s40, 5120
    s_nop 0
    buffer_load_dwordx4 v8, s[44:47], s3 offen offset:0 lds
    buffer_load_dwordx4 v9, s[44:47], s3 offen offset:1024 lds
    buffer_load_dwordx4 v10, s[44:47], s3 offen offset:2048 lds
    buffer_load_dwordx4 v11, s[44:47], s3 offen offset:3072 lds
    s_add_u32 s3, s98, 1
    s_and_b32 s3, s3, 3
    s_mul_i32 s3, s3, 20480
    s_add_u32 s3, s3, s42
    s_add_u32 m0, s40, 0
    s_nop 0
    buffer_load_dwordx4 v244, s[32:35], s3 offen offset:0 sc1 lds
    buffer_load_dwordx4 v244, s[32:35], s3 offen offset:1024 sc1 lds
    buffer_load_dwordx4 v244, s[32:35], s3 offen offset:2048 sc1 lds
    buffer_load_dwordx4 v244, s[32:35], s3 offen offset:3072 sc1 lds
    s_add_u32 m0, s40, 4096
    s_nop 0
    buffer_load_dwordx4 v245, s[32:35], s3 offen offset:0 sc1 lds
    s_waitcnt vmcnt(18)
    s_barrier
    s_add_u32 s3, s98, 2
    s_and_b32 s3, s3, 3
    s_mul_i32 s3, s3, 442368
    s_add_u32 s3, s3, s41
    s_add_u32 m0, s40, 41984
    s_nop 0
    buffer_load_dwordx4 v8, s[44:47], s3 offen offset:0 lds
    buffer_load_dwordx4 v9, s[44:47], s3 offen offset:1024 lds
    buffer_load_dwordx4 v10, s[44:47], s3 offen offset:2048 lds
    buffer_load_dwordx4 v11, s[44:47], s3 offen offset:3072 lds
    s_add_u32 s3, s98, 2
    s_and_b32 s3, s3, 3
    s_mul_i32 s3, s3, 20480
    s_add_u32 s3, s3, s42
    s_add_u32 m0, s40, 36864
    s_nop 0
    buffer_load_dwordx4 v244, s[32:35], s3 offen offset:0 sc1 lds
    buffer_load_dwordx4 v244, s[32:35], s3 offen offset:1024 sc1 lds
    buffer_load_dwordx4 v244, s[32:35], s3 offen offset:2048 sc1 lds
    buffer_load_dwordx4 v244, s[32:35], s3 offen offset:3072 sc1 lds
    s_add_u32 m0, s40, 40960
    s_nop 0
    buffer_load_dwordx4 v245, s[32:35], s3 offen offset:0 sc1 lds
    s_waitcnt vmcnt(18)
    s_barrier
    s_add_u32 s3, s98, 0
    s_and_b32 s3, s3, 3
    s_add_u32 s3, s3, 8
    s_mul_i32 s3, s3, 442368
    s_add_u32 s3, s3, s41
    s_add_u32 m0, s40, 87040
    s_nop 0
    buffer_load_dwordx4 v8, s[44:47], s3 offen offset:0 lds
    buffer_load_dwordx4 v9, s[44:47], s3 offen offset:1024 lds
    buffer_load_dwordx4 v10, s[44:47], s3 offen offset:2048 lds
    buffer_load_dwordx4 v11, s[44:47], s3 offen offset:3072 lds
    s_add_u32 s3, s98, 0
    s_and_b32 s3, s3, 3
    s_add_u32 s3, s3, 8
    s_mul_i32 s3, s3, 20480
    s_add_u32 s3, s3, s42
    s_add_u32 m0, s40, 81920
    s_nop 0
    buffer_load_dwordx4 v244, s[32:35], s3 offen offset:0 sc1 lds
    buffer_load_dwordx4 v244, s[32:35], s3 offen offset:1024 sc1 lds
    buffer_load_dwordx4 v244, s[32:35], s3 offen offset:2048 sc1 lds
    buffer_load_dwordx4 v244, s[32:35], s3 offen offset:3072 sc1 lds
    s_add_u32 m0, s40, 86016
    s_nop 0
    buffer_load_dwordx4 v245, s[32:35], s3 offen offset:0 sc1 lds
    s_waitcnt vmcnt(18)
    s_barrier
    s_add_u32 s3, s98, 3
    s_and_b32 s3, s3, 3
    s_mul_i32 s3, s3, 442368
    s_add_u32 s3, s3, s41
    s_add_u32 m0, s40, 123904
    s_nop 0
    buffer_load_dwordx4 v8, s[44:47], s3 offen offset:0 lds
    buffer_load_dwordx4 v9, s[44:47], s3 offen offset:1024 lds
    buffer_load_dwordx4 v10, s[44:47], s3 offen offset:2048 lds
    buffer_load_dwordx4 v11, s[44:47], s3 offen offset:3072 lds
    s_add_u32 s3, s98, 3
    s_and_b32 s3, s3, 3
    s_mul_i32 s3, s3, 20480
    s_add_u32 s3, s3, s42
    s_add_u32 m0, s40, 118784
    s_nop 0
    buffer_load_dwordx4 v244, s[32:35], s3 offen offset:0 sc1 lds
    buffer_load_dwordx4 v244, s[32:35], s3 offen offset:1024 sc1 lds
    buffer_load_dwordx4 v244, s[32:35], s3 offen offset:2048 sc1 lds
    buffer_load_dwordx4 v244, s[32:35], s3 offen offset:3072 sc1 lds
    s_add_u32 m0, s40, 122880
    s_nop 0
    buffer_load_dwordx4 v245, s[32:35], s3 offen offset:0 sc1 lds
    s_waitcnt vmcnt(18)
    s_barrier
    s_add_u32 s3, s98, 1
    s_and_b32 s3, s3, 3
    s_add_u32 s3, s3, 4
    s_mul_i32 s3, s3, 442368
    s_add_u32 s3, s3, s41
    s_add_u32 m0, s40, 5120
    s_nop 0
    buffer_load_dwordx4 v8, s[44:47], s3 offen offset:0 lds
    buffer_load_dwordx4 v9, s[44:47], s3 offen offset:1024 lds
    buffer_load_dwordx4 v10, s[44:47], s3 offen offset:2048 lds
    buffer_load_dwordx4 v11, s[44:47], s3 offen offset:3072 lds
    s_add_u32 s3, s98, 1
    s_and_b32 s3, s3, 3
    s_add_u32 s3, s3, 4
    s_mul_i32 s3, s3, 20480
    s_add_u32 s3, s3, s42
    s_add_u32 m0, s40, 0
    s_nop 0
    buffer_load_dwordx4 v244, s[32:35], s3 offen offset:0 sc1 lds
    buffer_load_dwordx4 v244, s[32:35], s3 offen offset:1024 sc1 lds
    buffer_load_dwordx4 v244, s[32:35], s3 offen offset:2048 sc1 lds
    buffer_load_dwordx4 v244, s[32:35], s3 offen offset:3072 sc1 lds
    s_add_u32 m0, s40, 4096
    s_nop 0
    buffer_load_dwordx4 v245, s[32:35], s3 offen offset:0 sc1 lds
    s_waitcnt vmcnt(18)
    s_barrier
    s_add_u32 s3, s98, 2
    s_and_b32 s3, s3, 3
    s_add_u32 s3, s3, 4
    s_mul_i32 s3, s3, 442368
    s_add_u32 s3, s3, s41
    s_add_u32 m0, s40, 41984
    s_nop 0
    buffer_load_dwordx4 v8, s[44:47], s3 offen offset:0 lds
    buffer_load_dwordx4 v9, s[44:47], s3 offen offset:1024 lds
    buffer_load_dwordx4 v10, s[44:47], s3 offen offset:2048 lds
    buffer_load_dwordx4 v11, s[44:47], s3 offen offset:3072 lds
    s_add_u32 s3, s98, 2
    s_and_b32 s3, s3, 3
    s_add_u32 s3, s3, 4
    s_mul_i32 s3, s3, 20480
    s_add_u32 s3, s3, s42
    s_add_u32 m0, s40, 36864
    s_nop 0
    buffer_load_dwordx4 v244, s[32:35], s3 offen offset:0 sc1 lds
    buffer_load_dwordx4 v244, s[32:35], s3 offen offset:1024 sc1 lds
    buffer_load_dwordx4 v244, s[32:35], s3 offen offset:2048 sc1 lds
    buffer_load_dwordx4 v244, s[32:35], s3 offen offset:3072 sc1 lds
    s_add_u32 m0, s40, 40960
    s_nop 0
    buffer_load_dwordx4 v245, s[32:35], s3 offen offset:0 sc1 lds
    s_waitcnt vmcnt(18)
    s_barrier
    s_add_u32 s3, s98, 0
    s_and_b32 s3, s3, 3
    s_add_u32 s3, s3, 12
    s_mul_i32 s3, s3, 442368
    s_add_u32 s3, s3, s41
    s_add_u32 m0, s40, 87040
    s_nop 0
    buffer_load_dwordx4 v8, s[44:47], s3 offen offset:0 lds
    buffer_load_dwordx4 v9, s[44:47], s3 offen offset:1024 lds
    buffer_load_dwordx4 v10, s[44:47], s3 offen offset:2048 lds
    buffer_load_dwordx4 v11, s[44:47], s3 offen offset:3072 lds
    s_add_u32 s3, s98, 0
    s_and_b32 s3, s3, 3
    s_add_u32 s3, s3, 12
    s_mul_i32 s3, s3, 20480
    s_add_u32 s3, s3, s42
    s_add_u32 m0, s40, 81920
    s_nop 0
    buffer_load_dwordx4 v244, s[32:35], s3 offen offset:0 sc1 lds
    buffer_load_dwordx4 v244, s[32:35], s3 offen offset:1024 sc1 lds
    buffer_load_dwordx4 v244, s[32:35], s3 offen offset:2048 sc1 lds
    buffer_load_dwordx4 v244, s[32:35], s3 offen offset:3072 sc1 lds
    s_add_u32 m0, s40, 86016
    s_nop 0
    buffer_load_dwordx4 v245, s[32:35], s3 offen offset:0 sc1 lds
    s_waitcnt vmcnt(18)
    s_barrier
    s_add_u32 s3, s98, 3
    s_and_b32 s3, s3, 3
    s_add_u32 s3, s3, 4
    s_mul_i32 s3, s3, 442368
    s_add_u32 s3, s3, s41
    s_add_u32 m0, s40, 123904
    s_nop 0
    buffer_load_dwordx4 v8, s[44:47], s3 offen offset:0 lds
    buffer_load_dwordx4 v9, s[44:47], s3 offen offset:1024 lds
    buffer_load_dwordx4 v10, s[44:47], s3 offen offset:2048 lds
    buffer_load_dwordx4 v11, s[44:47], s3 offen offset:3072 lds
    s_add_u32 s3, s98, 3
    s_and_b32 s3, s3, 3
    s_add_u32 s3, s3, 4
    s_mul_i32 s3, s3, 20480
    s_add_u32 s3, s3, s42
    s_add_u32 m0, s40, 118784
    s_nop 0
    buffer_load_dwordx4 v244, s[32:35], s3 offen offset:0 sc1 lds
    buffer_load_dwordx4 v244, s[32:35], s3 offen offset:1024 sc1 lds
    buffer_load_dwordx4 v244, s[32:35], s3 offen offset:2048 sc1 lds
    buffer_load_dwordx4 v244, s[32:35], s3 offen offset:3072 sc1 lds
    s_add_u32 m0, s40, 122880
    s_nop 0
    buffer_load_dwordx4 v245, s[32:35], s3 offen offset:0 sc1 lds
    s_waitcnt vmcnt(18)
    s_barrier
    s_add_u32 s3, s98, 1
    s_and_b32 s3, s3, 3
    s_add_u32 s3, s3, 8
    s_mul_i32 s3, s3, 442368
    s_add_u32 s3, s3, s41
    s_add_u32 m0, s40, 5120
    s_nop 0
    buffer_load_dwordx4 v8, s[44:47], s3 offen offset:0 lds
    buffer_load_dwordx4 v9, s[44:47], s3 offen offset:1024 lds
    buffer_load_dwordx4 v10, s[44:47], s3 offen offset:2048 lds
    buffer_load_dwordx4 v11, s[44:47], s3 offen offset:3072 lds
    s_add_u32 s3, s98, 1
    s_and_b32 s3, s3, 3
    s_add_u32 s3, s3, 8
    s_mul_i32 s3, s3, 20480
    s_add_u32 s3, s3, s42
    s_add_u32 m0, s40, 0
    s_nop 0
    buffer_load_dwordx4 v244, s[32:35], s3 offen offset:0 sc1 lds
    buffer_load_dwordx4 v244, s[32:35], s3 offen offset:1024 sc1 lds
    buffer_load_dwordx4 v244, s[32:35], s3 offen offset:2048 sc1 lds
    buffer_load_dwordx4 v244, s[32:35], s3 offen offset:3072 sc1 lds
    s_add_u32 m0, s40, 4096
    s_nop 0
    buffer_load_dwordx4 v245, s[32:35], s3 offen offset:0 sc1 lds
    s_waitcnt vmcnt(18)
    s_barrier
    s_add_u32 s3, s98, 2
    s_and_b32 s3, s3, 3
    s_add_u32 s3, s3, 8
    s_mul_i32 s3, s3, 442368
    s_add_u32 s3, s3, s41
    s_add_u32 m0, s40, 41984
    s_nop 0
    buffer_load_dwordx4 v8, s[44:47], s3 offen offset:0 lds
    buffer_load_dwordx4 v9, s[44:47], s3 offen offset:1024 lds
    buffer_load_dwordx4 v10, s[44:47], s3 offen offset:2048 lds
    buffer_load_dwordx4 v11, s[44:47], s3 offen offset:3072 lds
    s_add_u32 s3, s98, 2
    s_and_b32 s3, s3, 3
    s_add_u32 s3, s3, 8
    s_mul_i32 s3, s3, 20480
    s_add_u32 s3, s3, s42
    s_add_u32 m0, s40, 36864
    s_nop 0
    buffer_load_dwordx4 v244, s[32:35], s3 offen offset:0 sc1 lds
    buffer_load_dwordx4 v244, s[32:35], s3 offen offset:1024 sc1 lds
    buffer_load_dwordx4 v244, s[32:35], s3 offen offset:2048 sc1 lds
    buffer_load_dwordx4 v244, s[32:35], s3 offen offset:3072 sc1 lds
    s_add_u32 m0, s40, 40960
    s_nop 0
    buffer_load_dwordx4 v245, s[32:35], s3 offen offset:0 sc1 lds
    s_waitcnt vmcnt(18)
    s_barrier
    s_add_u32 s3, s98, 3
    s_and_b32 s3, s3, 3
    s_add_u32 s3, s3, 8
    s_mul_i32 s3, s3, 442368
    s_add_u32 s3, s3, s41
    s_add_u32 m0, s40, 87040
    s_nop 0
    buffer_load_dwordx4 v8, s[44:47], s3 offen offset:0 lds
    buffer_load_dwordx4 v9, s[44:47], s3 offen offset:1024 lds
    buffer_load_dwordx4 v10, s[44:47], s3 offen offset:2048 lds
    buffer_load_dwordx4 v11, s[44:47], s3 offen offset:3072 lds
    s_add_u32 s3, s98, 3
    s_and_b32 s3, s3, 3
    s_add_u32 s3, s3, 8
    s_mul_i32 s3, s3, 20480
    s_add_u32 s3, s3, s42
    s_add_u32 m0, s40, 81920
    s_nop 0
    buffer_load_dwordx4 v244, s[32:35], s3 offen offset:0 sc1 lds
    buffer_load_dwordx4 v244, s[32:35], s3 offen offset:1024 sc1 lds
    buffer_load_dwordx4 v244, s[32:35], s3 offen offset:2048 sc1 lds
    buffer_load_dwordx4 v244, s[32:35], s3 offen offset:3072 sc1 lds
    s_add_u32 m0, s40, 86016
    s_nop 0
    buffer_load_dwordx4 v245, s[32:35], s3 offen offset:0 sc1 lds
    s_waitcnt vmcnt(18)
    s_barrier
    s_add_u32 s3, s98, 1
    s_and_b32 s3, s3, 3
    s_add_u32 s3, s3, 12
    s_mul_i32 s3, s3, 442368
    s_add_u32 s3, s3, s41
    s_add_u32 m0, s40, 123904
    s_nop 0
    buffer_load_dwordx4 v8, s[44:47], s3 offen offset:0 lds
    buffer_load_dwordx4 v9, s[44:47], s3 offen offset:1024 lds
    buffer_load_dwordx4 v10, s[44:47], s3 offen offset:2048 lds
    buffer_load_dwordx4 v11, s[44:47], s3 offen offset:3072 lds
    s_add_u32 s3, s98, 1
    s_and_b32 s3, s3, 3
    s_add_u32 s3, s3, 12
    s_mul_i32 s3, s3, 20480
    s_add_u32 s3, s3, s42
    s_add_u32 m0, s40, 118784
    s_nop 0
    buffer_load_dwordx4 v244, s[32:35], s3 offen offset:0 sc1 lds
    buffer_load_dwordx4 v244, s[32:35], s3 offen offset:1024 sc1 lds
    buffer_load_dwordx4 v244, s[32:35], s3 offen offset:2048 sc1 lds
    buffer_load_dwordx4 v244, s[32:35], s3 offen offset:3072 sc1 lds
    s_add_u32 m0, s40, 122880
    s_nop 0
    buffer_load_dwordx4 v245, s[32:35], s3 offen offset:0 sc1 lds
    s_waitcnt vmcnt(18)
    s_barrier
    s_add_u32 s3, s98, 2
    s_and_b32 s3, s3, 3
    s_add_u32 s3, s3, 12
    s_mul_i32 s3, s3, 442368
    s_add_u32 s3, s3, s41
    s_add_u32 m0, s40, 5120
    s_nop 0
    buffer_load_dwordx4 v8, s[44:47], s3 offen offset:0 lds
    buffer_load_dwordx4 v9, s[44:47], s3 offen offset:1024 lds
    buffer_load_dwordx4 v10, s[44:47], s3 offen offset:2048 lds
    buffer_load_dwordx4 v11, s[44:47], s3 offen offset:3072 lds
    s_add_u32 s3, s98, 2
    s_and_b32 s3, s3, 3
    s_add_u32 s3, s3, 12
    s_mul_i32 s3, s3, 20480
    s_add_u32 s3, s3, s42
    s_add_u32 m0, s40, 0
    s_nop 0
    buffer_load_dwordx4 v244, s[32:35], s3 offen offset:0 sc1 lds
    buffer_load_dwordx4 v244, s[32:35], s3 offen offset:1024 sc1 lds
    buffer_load_dwordx4 v244, s[32:35], s3 offen offset:2048 sc1 lds
    buffer_load_dwordx4 v244, s[32:35], s3 offen offset:3072 sc1 lds
    s_add_u32 m0, s40, 4096
    s_nop 0
    buffer_load_dwordx4 v245, s[32:35], s3 offen offset:0 sc1 lds
    s_waitcnt vmcnt(18)
    s_barrier
    s_add_u32 s3, s98, 3
    s_and_b32 s3, s3, 3
    s_add_u32 s3, s3, 12
    s_mul_i32 s3, s3, 442368
    s_add_u32 s3, s3, s41
    s_add_u32 m0, s40, 41984
    s_nop 0
    buffer_load_dwordx4 v8, s[44:47], s3 offen offset:0 lds
    buffer_load_dwordx4 v9, s[44:47], s3 offen offset:1024 lds
    buffer_load_dwordx4 v10, s[44:47], s3 offen offset:2048 lds
    buffer_load_dwordx4 v11, s[44:47], s3 offen offset:3072 lds
    s_add_u32 s3, s98, 3
    s_and_b32 s3, s3, 3
    s_add_u32 s3, s3, 12
    s_mul_i32 s3, s3, 20480
    s_add_u32 s3, s3, s42
    s_add_u32 m0, s40, 36864
    s_nop 0
    buffer_load_dwordx4 v244, s[32:35], s3 offen offset:0 sc1 lds
    buffer_load_dwordx4 v244, s[32:35], s3 offen offset:1024 sc1 lds
    buffer_load_dwordx4 v244, s[32:35], s3 offen offset:2048 sc1 lds
    buffer_load_dwordx4 v244, s[32:35], s3 offen offset:3072 sc1 lds
    s_add_u32 m0, s40, 40960
    s_nop 0
    buffer_load_dwordx4 v245, s[32:35], s3 offen offset:0 sc1 lds
    s_waitcnt vmcnt(18)
    s_barrier
    s_add_u32 s3, s99, 0
    s_and_b32 s3, s3, 3
    s_mul_i32 s3, s3, 524288
    s_add_u32 s3, s3, s38
    s_add_u32 m0, s40, 87040
    s_nop 0
    buffer_load_dwordx4 v240, s[48:51], s3 offen offset:0 lds
    buffer_load_dwordx4 v241, s[48:51], s3 offen offset:1024 lds
    buffer_load_dwordx4 v242, s[48:51], s3 offen offset:2048 lds
    buffer_load_dwordx4 v243, s[48:51], s3 offen offset:3072 lds
    s_waitcnt vmcnt(13)
    s_barrier
    s_add_u32 s3, s99, 0
    s_and_b32 s3, s3, 3
    s_add_u32 s3, s3, 4
    s_mul_i32 s3, s3, 524288
    s_add_u32 s3, s3, s38
    s_add_u32 m0, s40, 123904
    s_nop 0
    buffer_load_dwordx4 v240, s[48:51], s3 offen offset:0 lds
    buffer_load_dwordx4 v241, s[48:51], s3 offen offset:1024 lds
    buffer_load_dwordx4 v242, s[48:51], s3 offen offset:2048 lds
    buffer_load_dwordx4 v243, s[48:51], s3 offen offset:3072 lds
    s_waitcnt vmcnt(8)
    s_barrier
    s_barrier
    s_add_u32 s3, s99, 0
    s_and_b32 s3, s3, 3
    s_add_u32 s3, s3, 8
    s_mul_i32 s3, s3, 524288
    s_add_u32 s3, s3, s38
    s_add_u32 m0, s40, 5120
    s_nop 0
    buffer_load_dwordx4 v240, s[48:51], s3 offen offset:0 lds
    buffer_load_dwordx4 v241, s[48:51], s3 offen offset:1024 lds
    buffer_load_dwordx4 v242, s[48:51], s3 offen offset:2048 lds
    buffer_load_dwordx4 v243, s[48:51], s3 offen offset:3072 lds
L_w19:
    s_mov_b32 s48, s76
    s_mov_b32 s49, s77
    s_mov_b32 s50, 0x6c0000
    s_mov_b32 s51, 0x20000
    s_mul_i32 s22, s18, 276480
    s_add_u32 s22, s22, 10485760
    s_add_u32 s52, s84, s22
    s_addc_u32 s53, s85, 0
    s_mov_b32 s54, 0x43800
    s_mov_b32 s55, 0x20000
    s_add_u32 s3, s38, 6291456
    s_add_u32 m0, s40, 41984
    s_nop 0
    buffer_load_dwordx4 v240, s[48:51], s3 offen offset:0 lds
    buffer_load_dwordx4 v241, s[48:51], s3 offen offset:1024 lds
    buffer_load_dwordx4 v242, s[48:51], s3 offen offset:2048 lds
    buffer_load_dwordx4 v243, s[48:51], s3 offen offset:3072 lds
    v_min_u32 v16, 26, v0
    v_lshlrev_b32 v16, 7, v16
    s_lshl_b32 s21, s18, 12
    s_add_u32 s21, s21, 17399808
    v_add_u32 v250, s21, v16
    s_cmp_lg_u32 s13, 0
    s_cbranch_scc1 L_nop
    buffer_load_dwordx4 v[246:249], v250, s[32:35], 0 offen sc1
    s_waitcnt vmcnt(0)
    s_mov_b32 s63, 200000
LP5:
    v_xor_b32 v246, s62, v246
    v_xor_b32 v247, s62, v247
    v_xor_b32 v248, s62, v248
    v_xor_b32 v249, s62, v249
    v_or3_b32 v246, v246, v247, v248
    v_or_b32 v246, v246, v249
    v_cmp_ne_u32 vcc, 0, v246
    s_nop 1
    s_cmp_eq_u64 vcc, 0
    s_cbranch_scc1 LPo5
    s_sub_u32 s63, s63, 1
    s_cmp_eq_u32 s63, 0
    s_cbranch_scc1 LPo5
    buffer_load_dwordx4 v[246:249], v250, s[32:35], 0 offen sc1
    s_waitcnt vmcnt(0)
    s_branch LP5
LPo5:
L_nop:
    s_sub_u32 s21, s15, 27
    s_cmp_ge_u32 s21, 4
    s_cbranch_scc1 L_nof
    s_waitcnt vmcnt(0)
    v_mov_b32 v251, s62
    s_mov_b64 exec, 1
    buffer_store_dword v251, v252, s[32:35], s31 offen sc1
    s_mov_b64 exec, -1
L_nof:
    s_barrier
    s_add_u32 s3, s99, 0
    s_and_b32 s3, s3, 3
    s_mul_i32 s3, s3, 20480
    s_add_u32 s3, s3, s39
    s_add_u32 m0, s40, 81920
    s_nop 0
    buffer_load_dwordx4 v244, s[52:55], s3 offen offset:0 sc1 lds
    buffer_load_dwordx4 v244, s[52:55], s3 offen offset:1024 sc1 lds
    buffer_load_dwordx4 v244, s[52:55], s3 offen offset:2048 sc1 lds
    buffer_load_dwordx4 v244, s[52:55], s3 offen offset:3072 sc1 lds
    s_add_u32 m0, s40, 86016
    s_nop 0
    buffer_load_dwordx4 v245, s[52:55], s3 offen offset:0 sc1 lds
    s_add_u32 s3, s99, 0
    s_and_b32 s3, s3, 3
    s_add_u32 s3, s3, 4
    s_mul_i32 s3, s3, 20480
    s_add_u32 s3, s3, s39
    s_add_u32 m0, s40, 118784
    s_nop 0
    buffer_load_dwordx4 v244, s[52:55], s3 offen offset:0 sc1 lds
    buffer_load_dwordx4 v244, s[52:55], s3 offen offset:1024 sc1 lds
    buffer_load_dwordx4 v244, s[52:55], s3 offen offset:2048 sc1 lds
    buffer_load_dwordx4 v244, s[52:55], s3 offen offset:3072 sc1 lds
    s_add_u32 m0, s40, 122880
    s_nop 0
    buffer_load_dwordx4 v245, s[52:55], s3 offen offset:0 sc1 lds
    s_add_u32 s3, s99, 0
    s_and_b32 s3, s3, 3
    s_add_u32 s3, s3, 8
    s_mul_i32 s3, s3, 20480
    s_add_u32 s3, s3, s39
    s_add_u32 m0, s40, 0
    s_nop 0
    buffer_load_dwordx4 v244, s[52:55], s3 offen offset:0 sc1 lds
    buffer_load_dwordx4 v244, s[52:55], s3 offen offset:1024 sc1 lds
    buffer_load_dwordx4 v244, s[52:55], s3 offen offset:2048 sc1 lds
    buffer_load_dwordx4 v244, s[52:55], s3 offen offset:3072 sc1 lds
    s_add_u32 m0, s40, 4096
    s_nop 0
    buffer_load_dwordx4 v245, s[52:55], s3 offen offset:0 sc1 lds
    s_add_u32 s3, s39, 245760
    s_add_u32 m0, s40, 36864
    s_nop 0
    buffer_load_dwordx4 v244, s[52:55], s3 offen offset:0 sc1 lds
    buffer_load_dwordx4 v244, s[52:55], s3 offen offset:1024 sc1 lds
    buffer_load_dwordx4 v244, s[52:55], s3 offen offset:2048 sc1 lds
    buffer_load_dwordx4 v244, s[52:55], s3 offen offset:3072 sc1 lds
    s_add_u32 m0, s40, 40960
    s_nop 0
    buffer_load_dwordx4 v245, s[52:55], s3 offen offset:0 sc1 lds
    v_and_b32 v16, 31, v0
    v_lshlrev_b32 v16, 7, v16
    s_lshr_b32 s21, s16, 4
    s_lshl_b32 s21, s21, 4
    s_add_u32 s21, s21, 17367040
    v_add_u32 v250, s21, v16
    s_waitcnt vmcnt(15)
    s_barrier
    s_waitcnt vmcnt(10)
    s_barrier
    s_add_u32 s3, s99, 1
    s_and_b32 s3, s3, 3
    s_mul_i32 s3, s3, 524288
    s_add_u32 s3, s3, s38
    s_add_u32 m0, s40, 87040
    s_nop 0
    buffer_load_dwordx4 v240, s[48:51], s3 offen offset:0 lds
    buffer_load_dwordx4 v241, s[48:51], s3 offen offset:1024 lds
    buffer_load_dwordx4 v242, s[48:51], s3 offen offset:2048 lds
    buffer_load_dwordx4 v243, s[48:51], s3 offen offset:3072 lds
    s_add_u32 s3, s99, 1
    s_and_b32 s3, s3, 3
    s_mul_i32 s3, s3, 20480
    s_add_u32 s3, s3, s39
    s_add_u32 m0, s40, 81920
    s_nop 0
    buffer_load_dwordx4 v244, s[52:55], s3 offen offset:0 sc1 lds
    buffer_load_dwordx4 v244, s[52:55], s3 offen offset:1024 sc1 lds
    buffer_load_dwordx4 v244, s[52:55], s3 offen offset:2048 sc1 lds
    buffer_load_dwordx4 v244, s[52:55], s3 offen offset:3072 sc1 lds
    s_add_u32 m0, s40, 86016
    s_nop 0
    buffer_load_dwordx4 v245, s[52:55], s3 offen offset:0 sc1 lds
    s_waitcnt vmcnt(14)
    s_barrier
    s_add_u32 s3, s99, 2
    s_and_b32 s3, s3, 3
    s_mul_i32 s3, s3, 524288
    s_add_u32 s3, s3, s38
    s_add_u32 m0, s40, 123904
    s_nop 0
    buffer_load_dwordx4 v240, s[48:51], s3 offen offset:0 lds
    buffer_load_dwordx4 v241, s[48:51], s3 offen offset:1024 lds
    buffer_load_dwordx4 v242, s[48:51], s3 offen offset:2048 lds
    buffer_load_dwordx4 v243, s[48:51], s3 offen offset:3072 lds
    s_add_u32 s3, s99, 2
    s_and_b32 s3, s3, 3
    s_mul_i32 s3, s3, 20480
    s_add_u32 s3, s3, s39
    s_add_u32 m0, s40, 118784
    s_nop 0
    buffer_load_dwordx4 v244, s[52:55], s3 offen offset:0 sc1 lds
    buffer_load_dwordx4 v244, s[52:55], s3 offen offset:1024 sc1 lds
    buffer_load_dwordx4 v244, s[52:55], s3 offen offset:2048 sc1 lds
    buffer_load_dwordx4 v244, s[52:55], s3 offen offset:3072 sc1 lds
    s_add_u32 m0, s40, 122880
    s_nop 0
    buffer_load_dwordx4 v245, s[52:55], s3 offen offset:0 sc1 lds
    s_waitcnt vmcnt(18)
    s_barrier
    s_add_u32 s3, s99, 3
    s_and_b32 s3, s3, 3
    s_mul_i32 s3, s3, 524288
    s_add_u32 s3, s3, s38
    s_add_u32 m0, s40, 5120
    s_nop 0
    buffer_load_dwordx4 v240, s[48:51], s3 offen offset:0 lds
    buffer_load_dwordx4 v241, s[48:51], s3 offen offset:1024 lds
    buffer_load_dwordx4 v242, s[48:51], s3 offen offset:2048 lds
    buffer_load_dwordx4 v243, s[48:51], s3 offen offset:3072 lds
    s_add_u32 s3, s99, 3
    s_and_b32 s3, s3, 3
    s_mul_i32 s3, s3, 20480
    s_add_u32 s3, s3, s39
    s_add_u32 m0, s40, 0
    s_nop 0
    buffer_load_dwordx4 v244, s[52:55], s3 offen offset:0 sc1 lds
    buffer_load_dwordx4 v244, s[52:55], s3 offen offset:1024 sc1 lds
    buffer_load_dwordx4 v244, s[52:55], s3 offen offset:2048 sc1 lds
    buffer_load_dwordx4 v244, s[52:55], s3 offen offset:3072 sc1 lds
    s_add_u32 m0, s40, 4096
    s_nop 0
    buffer_load_dwordx4 v245, s[52:55], s3 offen offset:0 sc1 lds
    s_waitcnt vmcnt(18)
    s_barrier
    s_add_u32 s3, s99, 1
    s_and_b32 s3, s3, 3
    s_add_u32 s3, s3, 4
    s_mul_i32 s3, s3, 524288
    s_add_u32 s3, s3, s38
    s_add_u32 m0, s40, 41984
    s_nop 0
    buffer_load_dwordx4 v240, s[48:51], s3 offen offset:0 lds
    buffer_load_dwordx4 v241, s[48:51], s3 offen offset:1024 lds
    buffer_load_dwordx4 v242, s[48:51], s3 offen offset:2048 lds
    buffer_load_dwordx4 v243, s[48:51], s3 offen offset:3072 lds
    s_add_u32 s3, s99, 1
    s_and_b32 s3, s3, 3
    s_add_u32 s3, s3, 4
    s_mul_i32 s3, s3, 20480
    s_add_u32 s3, s3, s39
    s_add_u32 m0, s40, 36864
    s_nop 0
    buffer_load_dwordx4 v244, s[52:55], s3 offen offset:0 sc1 lds
    buffer_load_dwordx4 v244, s[52:55], s3 offen offset:1024 sc1 lds
    buffer_load_dwordx4 v244, s[52:55], s3 offen offset:2048 sc1 lds
    buffer_load_dwordx4 v244, s[52:55], s3 offen offset:3072 sc1 lds
    s_add_u32 m0, s40, 40960
    s_nop 0
    buffer_load_dwordx4 v245, s[52:55], s3 offen offset:0 sc1 lds
    s_waitcnt vmcnt(18)
    s_barrier
    s_add_u32 s3, s99, 2
    s_and_b32 s3, s3, 3
    s_add_u32 s3, s3, 4
    s_mul_i32 s3, s3, 524288
    s_add_u32 s3, s3, s38
    s_add_u32 m0, s40, 87040
    s_nop 0
    buffer_load_dwordx4 v240, s[48:51], s3 offen offset:0 lds
    buffer_load_dwordx4 v241, s[48:51], s3 offen offset:1024 lds
    buffer_load_dwordx4 v242, s[48:51], s3 offen offset:2048 lds
    buffer_load_dwordx4 v243, s[48:51], s3 offen offset:3072 lds
    s_add_u32 s3, s99, 2
    s_and_b32 s3, s3, 3
    s_add_u32 s3, s3, 4
    s_mul_i32 s3, s3, 20480
    s_add_u32 s3, s3, s39
    s_add_u32 m0, s40, 81920
    s_nop 0
    buffer_load_dwordx4 v244, s[52:55], s3 offen offset:0 sc1 lds
    buffer_load_dwordx4 v244, s[52:55], s3 offen offset:1024 sc1 lds
    buffer_load_dwordx4 v244, s[52:55], s3 offen offset:2048 sc1 lds
    buffer_load_dwordx4 v244, s[52:55], s3 offen offset:3072 sc1 lds
    s_add_u32 m0, s40, 86016
    s_nop 0
    buffer_load_dwordx4 v245, s[52:55], s3 offen offset:0 sc1 lds
    s_waitcnt vmcnt(18)
    s_barrier
    s_add_u32 s3, s99, 3
    s_and_b32 s3, s3, 3
    s_add_u32 s3, s3, 4
    s_mul_i32 s3, s3, 524288
    s_add_u32 s3, s3, s38
    s_add_u32 m0, s40, 123904
    s_nop 0
    buffer_load_dwordx4 v240, s[48:51], s3 offen offset:0 lds
    buffer_load_dwordx4 v241, s[48:51], s3 offen offset:1024 lds
    buffer_load_dwordx4 v242, s[48:51], s3 offen offset:2048 lds
    buffer_load_dwordx4 v243, s[48:51], s3 offen offset:3072 lds
    s_add_u32 s3, s99, 3
    s_and_b32 s3, s3, 3
    s_add_u32 s3, s3, 4
    s_mul_i32 s3, s3, 20480
    s_add_u32 s3, s3, s39
    s_add_u32 m0, s40, 118784
    s_nop 0
    buffer_load_dwordx4 v244, s[52:55], s3 offen offset:0 sc1 lds
    buffer_load_dwordx4 v244, s[52:55], s3 offen offset:1024 sc1 lds
    buffer_load_dwordx4 v244, s[52:55], s3 offen offset:2048 sc1 lds
    buffer_load_dwordx4 v244, s[52:55], s3 offen offset:3072 sc1 lds
    s_add_u32 m0, s40, 122880
    s_nop 0
    buffer_load_dwordx4 v245, s[52:55], s3 offen offset:0 sc1 lds
    s_waitcnt vmcnt(18)
    s_barrier
    s_add_u32 s3, s99, 1
    s_and_b32 s3, s3, 3
    s_add_u32 s3, s3, 8
    s_mul_i32 s3, s3, 524288
    s_add_u32 s3, s3, s38
    s_add_u32 m0, s40, 5120
    s_nop 0
    buffer_load_dwordx4 v240, s[48:51], s3 offen offset:0 lds
    buffer_load_dwordx4 v241, s[48:51], s3 offen offset:1024 lds
    buffer_load_dwordx4 v242, s[48:51], s3 offen offset:2048 lds
    buffer_load_dwordx4 v243, s[48:51], s3 offen offset:3072 lds
    s_add_u32 s3, s99, 1
    s_and_b32 s3, s3, 3
    s_add_u32 s3, s3, 8
    s_mul_i32 s3, s3, 20480
    s_add_u32 s3, s3, s39
    s_add_u32 m0, s40, 0
    s_nop 0
    buffer_load_dwordx4 v244, s[52:55], s3 offen offset:0 sc1 lds
    buffer_load_dwordx4 v244, s[52:55], s3 offen offset:1024 sc1 lds
    buffer_load_dwordx4 v244, s[52:55], s3 offen offset:2048 sc1 lds
    buffer_load_dwordx4 v244, s[52:55], s3 offen offset:3072 sc1 lds
    s_add_u32 m0, s40, 4096
    s_nop 0
    buffer_load_dwordx4 v245, s[52:55], s3 offen offset:0 sc1 lds
    s_waitcnt vmcnt(18)
    s_barrier
    s_add_u32 s3, s99, 2
    s_and_b32 s3, s3, 3
    s_add_u32 s3, s3, 8
    s_mul_i32 s3, s3, 524288
    s_add_u32 s3, s3, s38
    s_add_u32 m0, s40, 41984
    s_nop 0
    buffer_load_dwordx4 v240, s[48:51], s3 offen offset:0 lds
    buffer_load_dwordx4 v241, s[48:51], s3 offen offset:1024 lds
    buffer_load_dwordx4 v242, s[48:51], s3 offen offset:2048 lds
    buffer_load_dwordx4 v243, s[48:51], s3 offen offset:3072 lds
    s_add_u32 s3, s99, 2
    s_and_b32 s3, s3, 3
    s_add_u32 s3, s3, 8
    s_mul_i32 s3, s3, 20480
    s_add_u32 s3, s3, s39
    s_add_u32 m0, s40, 36864
    s_nop 0
    buffer_load_dwordx4 v244, s[52:55], s3 offen offset:0 sc1 lds
    buffer_load_dwordx4 v244, s[52:55], s3 offen offset:1024 sc1 lds
    buffer_load_dwordx4 v244, s[52:55], s3 offen offset:2048 sc1 lds
    buffer_load_dwordx4 v244, s[52:55], s3 offen offset:3072 sc1 lds
    s_add_u32 m0, s40, 40960
    s_nop 0
    buffer_load_dwordx4 v245, s[52:55], s3 offen offset:0 sc1 lds
    buffer_load_dwordx4 v[246:249], v250, s[32:35], 0 offen sc1
    s_waitcnt vmcnt(19)
    s_barrier
    s_add_u32 s3, s99, 3
    s_and_b32 s3, s3, 3
    s_add_u32 s3, s3, 8
    s_mul_i32 s3, s3, 524288
    s_add_u32 s3, s3, s38
    s_add_u32 m0, s40, 87040
    s_nop 0
    buffer_load_dwordx4 v240, s[48:51], s3 offen offset:0 lds
    buffer_load_dwordx4 v241, s[48:51], s3 offen offset:1024 lds
    buffer_load_dwordx4 v242, s[48:51], s3 offen offset:2048 lds
    buffer_load_dwordx4 v243, s[48:51], s3 offen offset:3072 lds
    s_add_u32 s3, s99, 3
    s_and_b32 s3, s3, 3
    s_add_u32 s3, s3, 8
    s_mul_i32 s3, s3, 20480
    s_add_u32 s3, s3, s39
    s_add_u32 m0, s40, 81920
    s_nop 0
    buffer_load_dwordx4 v244, s[52:55], s3 offen offset:0 sc1 lds
    buffer_load_dwordx4 v244, s[52:55], s3 offen offset:1024 sc1 lds
    buffer_load_dwordx4 v244, s[52:55], s3 offen offset:2048 sc1 lds
    buffer_load_dwordx4 v244, s[52:55], s3 offen offset:3072 sc1 lds
    s_add_u32 m0, s40, 86016
    s_nop 0
    buffer_load_dwordx4 v245, s[52:55], s3 offen offset:0 sc1 lds
    s_waitcnt vmcnt(19)
    s_barrier
    s_add_u32 s3, s38, 6815744
    s_add_u32 m0, s40, 123904
    s_nop 0
    buffer_load_dwordx4 v240, s[48:51], s3 offen offset:0 lds
    buffer_load_dwordx4 v241, s[48:51], s3 offen offset:1024 lds
    buffer_load_dwordx4 v242, s[48:51], s3 offen offset:2048 lds
    buffer_load_dwordx4 v243, s[48:51], s3 offen offset:3072 lds
    s_add_u32 s3, s39, 266240
    s_add_u32 m0, s40, 118784
    s_nop 0
    buffer_load_dwordx4 v244, s[52:55], s3 offen offset:0 sc1 lds
    buffer_load_dwordx4 v244, s[52:55], s3 offen offset:1024 sc1 lds
    buffer_load_dwordx4 v244, s[52:55], s3 offen offset:2048 sc1 lds
    buffer_load_dwordx4 v244, s[52:55], s3 offen offset:3072 sc1 lds
    s_add_u32 m0, s40, 122880
    s_nop 0
    buffer_load_dwordx4 v245, s[52:55], s3 offen offset:0 sc1 lds
    s_waitcnt vmcnt(19)
    s_barrier
    s_waitcnt vmcnt(18)
    s_mov_b32 s63, 200000
LP6:
    v_xor_b32 v246, s62, v246
    v_xor_b32 v247, s62, v247
    v_xor_b32 v248, s62, v248
    v_xor_b32 v249, s62, v249
    v_or3_b32 v246, v246, v247, v248
    v_or_b32 v246, v246, v249
    v_cmp_ne_u32 vcc, 0, v246
    s_nop 1
    s_cmp_eq_u64 vcc, 0
    s_cbranch_scc1 LPo6
    s_sub_u32 s63, s63, 1
    s_cmp_eq_u32 s63, 0
    s_cbranch_scc1 LPo6
    buffer_load_dwordx4 v[246:249], v250, s[32:35], 0 offen sc1
    s_waitcnt vmcnt(0)
    s_branch LP6
LPo6:
    s_add_u32 s3, s99, 0
    s_and_b32 s3, s3, 3
    s_mul_i32 s3, s3, 16384
    s_add_u32 s3, s3, s43
    s_add_u32 m0, s40, 5120
    s_nop 0
    buffer_load_dwordx4 v244, s[32:35], s3 offen offset:0 sc1 lds
    buffer_load_dwordx4 v244, s[32:35], s3 offen offset:1024 sc1 lds
    buffer_load_dwordx4 v244, s[32:35], s3 offen offset:2048 sc1 lds
    buffer_load_dwordx4 v244, s[32:35], s3 offen offset:3072 sc1 lds
    s_add_u32 s3, s99, 0
    s_and_b32 s3, s3, 3
    s_mul_i32 s3, s3, 20480
    s_add_u32 s3, s3, s61
    s_add_u32 m0, s40, 0
    s_nop 0
    buffer_load_dwordx4 v244, s[32:35], s3 offen offset:0 sc1 lds
    buffer_load_dwordx4 v244, s[32:35], s3 offen offset:1024 sc1 lds
    buffer_load_dwordx4 v244, s[32:35], s3 offen offset:2048 sc1 lds
    buffer_load_dwordx4 v244, s[32:35], s3 offen offset:3072 sc1 lds
    s_add_u32 m0, s40, 4096
    s_nop 0
    buffer_load_dwordx4 v245, s[32:35], s3 offen offset:0 sc1 lds
    s_waitcnt vmcnt(18)
    s_barrier
    s_add_u32 s3, s43, 65536
    s_add_u32 m0, s40, 41984
    s_nop 0
    buffer_load_dwordx4 v244, s[32:35], s3 offen offset:0 sc1 lds
    buffer_load_dwordx4 v244, s[32:35], s3 offen offset:1024 sc1 lds
    buffer_load_dwordx4 v244, s[32:35], s3 offen offset:2048 sc1 lds
    buffer_load_dwordx4 v244, s[32:35], s3 offen offset:3072 sc1 lds
    s_add_u32 s3, s61, 81920
    s_add_u32 m0, s40, 36864
    s_nop 0
    buffer_load_dwordx4 v244, s[32:35], s3 offen offset:0 sc1 lds
    buffer_load_dwordx4 v244, s[32:35], s3 offen offset:1024 sc1 lds
    buffer_load_dwordx4 v244, s[32:35], s3 offen offset:2048 sc1 lds
    buffer_load_dwordx4 v244, s[32:35], s3 offen offset:3072 sc1 lds
    s_add_u32 m0, s40, 40960
    s_nop 0
    buffer_load_dwordx4 v245, s[32:35], s3 offen offset:0 sc1 lds
    s_waitcnt vmcnt(18)
    s_barrier
    s_add_u32 s3, s99, 1
    s_and_b32 s3, s3, 3
    s_mul_i32 s3, s3, 16384
    s_add_u32 s3, s3, s43
    s_add_u32 m0, s40, 87040
    s_nop 0
    buffer_load_dwordx4 v244, s[32:35], s3 offen offset:0 sc1 lds
    buffer_load_dwordx4 v244, s[32:35], s3 offen offset:1024 sc1 lds
    buffer_load_dwordx4 v244, s[32:35], s3 offen offset:2048 sc1 lds
    buffer_load_dwordx4 v244, s[32:35], s3 offen offset:3072 sc1 lds
    s_add_u32 s3, s99, 1
    s_and_b32 s3, s3, 3
    s_mul_i32 s3, s3, 20480
    s_add_u32 s3, s3, s61
    s_add_u32 m0, s40, 81920
    s_nop 0
    buffer_load_dwordx4 v244, s[32:35], s3 offen offset:0 sc1 lds
    buffer_load_dwordx4 v244, s[32:35], s3 offen offset:1024 sc1 lds
    buffer_load_dwordx4 v244, s[32:35], s3 offen offset:2048 sc1 lds
    buffer_load_dwordx4 v244, s[32:35], s3 offen offset:3072 sc1 lds
    s_add_u32 m0, s40, 86016
    s_nop 0
    buffer_load_dwordx4 v245, s[32:35], s3 offen offset:0 sc1 lds
    s_waitcnt vmcnt(18)
    s_barrier
    s_add_u32 s3, s99, 2
    s_and_b32 s3, s3, 3
    s_mul_i32 s3, s3, 16384
    s_add_u32 s3, s3, s43
    s_add_u32 m0, s40, 123904
    s_nop 0
    buffer_load_dwordx4 v244, s[32:35], s3 offen offset:0 sc1 lds
    buffer_load_dwordx4 v244, s[32:35], s3 offen offset:1024 sc1 lds
    buffer_load_dwordx4 v244, s[32:35], s3 offen offset:2048 sc1 lds
    buffer_load_dwordx4 v244, s[32:35], s3 offen offset:3072 sc1 lds
    s_add_u32 s3, s99, 2
    s_and_b32 s3, s3, 3
    s_mul_i32 s3, s3, 20480
    s_add_u32 s3, s3, s61
    s_add_u32 m0, s40, 118784
    s_nop 0
    buffer_load_dwordx4 v244, s[32:35], s3 offen offset:0 sc1 lds
    buffer_load_dwordx4 v244, s[32:35], s3 offen offset:1024 sc1 lds
    buffer_load_dwordx4 v244, s[32:35], s3 offen offset:2048 sc1 lds
    buffer_load_dwordx4 v244, s[32:35], s3 offen offset:3072 sc1 lds
    s_add_u32 m0, s40, 122880
    s_nop 0
    buffer_load_dwordx4 v245, s[32:35], s3 offen offset:0 sc1 lds
    s_waitcnt vmcnt(18)
    s_barrier
    s_add_u32 s3, s99, 3
    s_and_b32 s3, s3, 3
    s_mul_i32 s3, s3, 16384
    s_add_u32 s3, s3, s43
    s_add_u32 m0, s40, 5120
    s_nop 0
    buffer_load_dwordx4 v244, s[32:35], s3 offen offset:0 sc1 lds
    buffer_load_dwordx4 v244, s[32:35], s3 offen offset:1024 sc1 lds
    buffer_load_dwordx4 v244, s[32:35], s3 offen offset:2048 sc1 lds
    buffer_load_dwordx4 v244, s[32:35], s3 offen offset:3072 sc1 lds
    s_add_u32 s3, s99, 3
    s_and_b32 s3, s3, 3
    s_mul_i32 s3, s3, 20480
    s_add_u32 s3, s3, s61
    s_add_u32 m0, s40, 0
    s_nop 0
    buffer_load_dwordx4 v244, s[32:35], s3 offen offset:0 sc1 lds
    buffer_load_dwordx4 v244, s[32:35], s3 offen offset:1024 sc1 lds
    buffer_load_dwordx4 v244, s[32:35], s3 offen offset:2048 sc1 lds
    buffer_load_dwordx4 v244, s[32:35], s3 offen offset:3072 sc1 lds
    s_add_u32 m0, s40, 4096
    s_nop 0
    buffer_load_dwordx4 v245, s[32:35], s3 offen offset:0 sc1 lds
    s_waitcnt vmcnt(18)
    s_barrier
    s_waitcnt vmcnt(9)
    s_barrier
    s_waitcnt vmcnt(0)
    s_barrier
    s_endpgm
L_ldh:
    s_barrier
    s_add_u32 s3, s99, 0
    s_and_b32 s3, s3, 3
    s_mul_i32 s3, s3, 524288
    s_add_u32 s3, s3, s38
    s_add_u32 m0, s40, 87040
    s_nop 0
    buffer_load_dwordx4 v240, s[48:51], s3 offen offset:0 lds
    buffer_load_dwordx4 v241, s[48:51], s3 offen offset:1024 lds
    buffer_load_dwordx4 v242, s[48:51], s3 offen offset:2048 lds
    buffer_load_dwordx4 v243, s[48:51], s3 offen offset:3072 lds
    s_add_u32 s3, s99, 0
    s_and_b32 s3, s3, 3
    s_add_u32 s3, s3, 4
    s_mul_i32 s3, s3, 524288
    s_add_u32 s3, s3, s38
    s_add_u32 m0, s40, 123904
    s_nop 0
    buffer_load_dwordx4 v240, s[48:51], s3 offen offset:0 lds
    buffer_load_dwordx4 v241, s[48:51], s3 offen offset:1024 lds
    buffer_load_dwordx4 v242, s[48:51], s3 offen offset:2048 lds
    buffer_load_dwordx4 v243, s[48:51], s3 offen offset:3072 lds
    s_add_u32 s3, s99, 0
    s_and_b32 s3, s3, 3
    s_add_u32 s3, s3, 8
    s_mul_i32 s3, s3, 524288
    s_add_u32 s3, s3, s38
    s_add_u32 m0, s40, 5120
    s_nop 0
    buffer_load_dwordx4 v240, s[48:51], s3 offen offset:0 lds
    buffer_load_dwordx4 v241, s[48:51], s3 offen offset:1024 lds
    buffer_load_dwordx4 v242, s[48:51], s3 offen offset:2048 lds
    buffer_load_dwordx4 v243, s[48:51], s3 offen offset:3072 lds
    s_and_b32 s3, s18, 3
    s_lshl_b32 s3, s3, 2
    s_add_u32 s3, s3, s13
    s_mul_i32 s3, s3, 12
    s_add_u32 s3, s3, 1536
    s_lshl_b32 s3, s3, 5
    s_add_u32 s3, s3, s16
    s_lshl_b32 s3, s3, 7
    v_min_u32 v16, 11, v0
    v_lshlrev_b32 v16, 12, v16
    buffer_load_dword v253, v16, s[48:51], s3 offen
    s_cmp_lg_u32 s15, 31
    s_cbranch_scc1 L_ldh2
    s_branch L_w19
L_ldh2:
L_head:
    s_lshl_b32 s21, s14, 2
    s_add_u32 s21, s21, s15
    s_sub_u32 s21, s21, 27
    s_mul_i32 s22, s21, 81920
    s_and_b32 s23, s21, 1
    s_mul_i32 s3, s21, 20
    v_and_b32 v1, 1, v0
    v_mul_u32_u24 v1, 19, v1
    v_add_u32 v1, s3, v1
    v_lshrrev_b32 v1, 6, v1
    v_bfe_u32 v2, v0, 1, 2
    v_min_u32 v2, 2, v2
    v_mul_u32_u24 v2, 10, v2
    v_add_u32 v1, v1, v2
    v_lshrrev_b32 v1, 2, v1
    v_lshlrev_b32 v1, 12, v1
    v_bfe_u32 v2, v0, 3, 2
    v_lshl_add_u32 v1, v2, 7, v1
    s_lshl_b32 s3, s20, 9
    s_add_u32 s3, s3, 17334272
    v_add_u32 v250, s3, v1
    s_lshl_b32 s6, s21, 3
    s_add_u32 s6, s6, s20
    s_cmp_lt_u32 s6, 200
    s_cbranch_scc1 L_wo
    s_cmp_ge_u32 s20, 4
    s_cbranch_scc1 L_hq0
    s_waitcnt vmcnt(0)
    v_mov_b32 v251, s62
    s_mov_b64 exec, 1
    buffer_store_dword v251, v252, s[32:35], s37 offen sc1
    s_mov_b64 exec, -1
L_hq0:
    s_branch L_nowo
L_wo:
    s_mul_i32 s4, s6, 0xccd
    s_lshr_b32 s4, s4, 16
    s_mul_i32 s5, s4, 20
    s_sub_u32 s5, s6, s5
    s_mov_b32 s24, s68
    s_mov_b32 s25, s69
    s_mov_b32 s26, 0xc8000
    s_mov_b32 s27, 0x20000
    v_lshrrev_b32 v16, 3, v0
    v_bfe_u32 v17, v0, 4, 1
    v_add_u32 v16, 0, v16
    v_mul_u32_u24 v16, 1280, v16
    v_lshlrev_b32 v17, 1, v17
    v_and_b32 v8, 7, v0
    v_xor_b32 v8, v8, v17
    v_lshl_add_u32 v8, v8, 4, v16
    v_lshrrev_b32 v16, 3, v0
    v_bfe_u32 v17, v0, 4, 1
    v_or_b32 v17, 2, v17
    v_add_u32 v16, 8, v16
    v_mul_u32_u24 v16, 1280, v16
    v_lshlrev_b32 v17, 1, v17
    v_and_b32 v9, 7, v0
    v_xor_b32 v9, v9, v17
    v_lshl_add_u32 v9, v9, 4, v16
    v_subrev_u32 v9, 1024, v9
    v_lshrrev_b32 v16, 3, v0
    v_bfe_u32 v17, v0, 4, 1
    v_add_u32 v16, 16, v16
    v_mul_u32_u24 v16, 1280, v16
    v_lshlrev_b32 v17, 1, v17
    v_and_b32 v10, 7, v0
    v_xor_b32 v10, v10, v17
    v_lshl_add_u32 v10, v10, 4, v16
    v_subrev_u32 v10, 2048, v10
    v_lshrrev_b32 v16, 3, v0
    v_bfe_u32 v17, v0, 4, 1
    v_or_b32 v17, 2, v17
    v_add_u32 v16, 24, v16
    v_mul_u32_u24 v16, 1280, v16
    v_lshlrev_b32 v17, 1, v17
    v_and_b32 v11, 7, v0
    v_xor_b32 v11, v11, v17
    v_lshl_add_u32 v11, v11, 4, v16
    v_subrev_u32 v11, 3072, v11
    s_mul_i32 s3, s5, 40960
    s_lshl_b32 s12, s4, 7
    s_add_u32 s3, s3, s12
    s_lshl_b32 s7, s20, 12
    s_add_u32 s7, s7, 36864
    s_mov_b32 m0, s7
    s_nop 0
    buffer_load_dwordx4 v8, s[24:27], s3 offen offset:0 lds
    buffer_load_dwordx4 v9, s[24:27], s3 offen offset:1024 lds
    buffer_load_dwordx4 v10, s[24:27], s3 offen offset:2048 lds
    buffer_load_dwordx4 v11, s[24:27], s3 offen offset:3072 lds
    v_lshrrev_b32 v16, 4, v0
    v_lshlrev_b32 v16, 3, v16
    v_bfe_u32 v17, v0, 2, 2
    v_add_u32 v16, v16, v17
    v_lshlrev_b32 v16, 7, v16
    v_and_b32 v17, 3, v0
    v_lshl_add_u32 v16, v17, 3, v16
    v_add_u32 v16, s7, v16
    v_bfe_u32 v17, v0, 3, 2
    v_xor_b32 v12, 0, v17
    v_lshl_add_u32 v12, v12, 5, v16
    v_xor_b32 v13, 1, v17
    v_lshl_add_u32 v13, v13, 5, v16
    v_xor_b32 v14, 2, v17
    v_lshl_add_u32 v14, v14, 5, v16
    v_xor_b32 v15, 3, v17
    v_lshl_add_u32 v15, v15, 5, v16
    s_lshl_b32 s3, s4, 2
    s_add_u32 s3, s3, 0
    s_mul_i32 s12, s3, 0x3334
    s_lshr_b32 s12, s12, 16
    s_mul_i32 s8, s12, 5
    s_sub_u32 s3, s3, s8
    s_mul_i32 s12, s12, 20
    s_add_u32 s12, s12, s5
    s_mul_i32 s12, s12, 5
    s_add_u32 s12, s12, s3
    s_lshl_b32 s12, s12, 10
    s_add_u32 s28, s12, 13107200
    s_lshl_b32 s3, s4, 2
    s_add_u32 s3, s3, 1
    s_mul_i32 s12, s3, 0x3334
    s_lshr_b32 s12, s12, 16
    s_mul_i32 s8, s12, 5
    s_sub_u32 s3, s3, s8
    s_mul_i32 s12, s12, 20
    s_add_u32 s12, s12, s5
    s_mul_i32 s12, s12, 5
    s_add_u32 s12, s12, s3
    s_lshl_b32 s12, s12, 10
    s_add_u32 s29, s12, 13107200
    s_lshl_b32 s3, s4, 2
    s_add_u32 s3, s3, 2
    s_mul_i32 s12, s3, 0x3334
    s_lshr_b32 s12, s12, 16
    s_mul_i32 s8, s12, 5
    s_sub_u32 s3, s3, s8
    s_mul_i32 s12, s12, 20
    s_add_u32 s12, s12, s5
    s_mul_i32 s12, s12, 5
    s_add_u32 s12, s12, s3
    s_lshl_b32 s12, s12, 10
    s_add_u32 s30, s12, 13107200
    s_lshl_b32 s3, s4, 2
    s_add_u32 s3, s3, 3
    s_mul_i32 s12, s3, 0x3334
    s_lshr_b32 s12, s12, 16
    s_mul_i32 s8, s12, 5
    s_sub_u32 s3, s3, s8
    s_mul_i32 s12, s12, 20
    s_add_u32 s12, s12, s5
    s_mul_i32 s12, s12, 5
    s_add_u32 s12, s12, s3
    s_lshl_b32 s12, s12, 10
    s_add_u32 s31, s12, 13107200
    v_lshlrev_b32 v18, 4, v0
    s_waitcnt vmcnt(0)
    s_cmp_ge_u32 s20, 4
    s_cbranch_scc1 L_hq1
    s_waitcnt vmcnt(0)
    v_mov_b32 v251, s62
    s_mov_b64 exec, 1
    buffer_store_dword v251, v252, s[32:35], s37 offen sc1
    s_mov_b64 exec, -1
L_hq1:
    ds_read_b64_tr_b16 v[20:21], v12
    ds_read_b64_tr_b16 v[22:23], v12 offset:512
    ds_read_b64_tr_b16 v[24:25], v13
    ds_read_b64_tr_b16 v[26:27], v13 offset:512
    ds_read_b64_tr_b16 v[28:29], v14
    ds_read_b64_tr_b16 v[30:31], v14 offset:512
    ds_read_b64_tr_b16 v[32:33], v15
    ds_read_b64_tr_b16 v[34:35], v15 offset:512
    s_waitcnt lgkmcnt(0)
    buffer_store_dwordx4 v[20:23], v18, s[32:35], s28 offen sc1
    buffer_store_dwordx4 v[24:27], v18, s[32:35], s29 offen sc1
    buffer_store_dwordx4 v[28:31], v18, s[32:35], s30 offen sc1
    buffer_store_dwordx4 v[32:35], v18, s[32:35], s31 offen sc1
L_nowo:
    buffer_load_dwordx4 v[246:249], v250, s[32:35], 0 offen sc1
    v_and_b32 v1, 31, v0
    v_lshrrev_b32 v2, 5, v0
    v_and_b32 v3, 3, v1
    v_bfe_u32 v4, v1, 2, 1
    v_lshl_or_b32 v3, v4, 3, v3
    v_bfe_u32 v4, v1, 3, 1
    v_lshl_or_b32 v3, v4, 2, v3
    v_cmp_le_u32 vcc, 16, v1
    s_nop 1
    v_cndmask_b32 v3, v3, v1, vcc
    v_subrev_u32 v4, 12, v1
    v_cmp_le_u32 vcc, 20, v1
    s_nop 1
    v_cndmask_b32 v3, v3, v4, vcc
    v_lshrrev_b32 v4, 2, v3
    v_lshlrev_b32 v5, 6, v2
    v_lshl_add_u32 v5, v4, 14, v5
    v_and_b32 v4, 3, v3
    v_lshl_add_u32 v6, v4, 4, v5
    s_lshl_b32 s3, s23, 2
    v_add_u32 v3, s3, v3
    v_subrev_u32 v4, 20, v3
    v_cmp_le_u32 vcc, 20, v3
    s_nop 1
    v_cndmask_b32 v3, v3, v4, vcc
    v_lshrrev_b32 v4, 2, v3
    v_lshlrev_b32 v5, 6, v2
    v_lshl_add_u32 v5, v4, 14, v5
    v_and_b32 v4, 3, v3
    v_lshl_add_u32 v7, v4, 4, v5
    s_lshl_b32 s4, s20, 15
    s_lshl_b32 s4, s20, 11
    s_add_u32 s4, s4, s22
    s_add_u32 s7, s4, 7864320
    s_add_u32 s4, s4, 5242880
    s_lshl_b32 s24, s20, 11
    s_add_u32 s24, s24, s22
    s_add_u32 s24, s24, 2621440
    s_add_u32 s25, s24, 0x4000
    s_add_u32 s26, s24, 0x10000
    s_mov_b32 s12, 0x3f803f80
    v_mov_b32 v80, s12
    v_mov_b32 v81, s12
    v_mov_b32 v82, s12
    v_mov_b32 v83, s12
    v_mov_b32 v84, s12
    v_mov_b32 v85, s12
    v_mov_b32 v86, s12
    v_mov_b32 v87, s12
    v_mov_b32 v88, s12
    v_mov_b32 v89, s12
    v_mov_b32 v90, s12
    v_mov_b32 v91, s12
    v_mov_b32 v92, s12
    v_mov_b32 v93, s12
    v_mov_b32 v94, s12
    v_mov_b32 v95, s12
    v_mov_b32 v96, s12
    v_mov_b32 v97, s12
    v_mov_b32 v98, s12
    v_mov_b32 v99, s12
    v_mov_b32 v100, s12
    v_mov_b32 v101, s12
    v_mov_b32 v102, s12
    v_mov_b32 v103, s12
    v_mov_b32 v104, s12
    v_mov_b32 v105, s12
    v_mov_b32 v106, s12
    v_mov_b32 v107, s12
    v_mov_b32 v108, s12
    v_mov_b32 v109, s12
    v_mov_b32 v110, s12
    v_mov_b32 v111, s12
    v_mov_b32 v112, s12
    v_mov_b32 v113, s12
    v_mov_b32 v114, s12
    v_mov_b32 v115, s12
    v_mov_b32 v116, s12
    v_mov_b32 v117, s12
    v_mov_b32 v118, s12
    v_mov_b32 v119, s12
    v_mov_b32 v120, s12
    v_mov_b32 v121, s12
    v_mov_b32 v122, s12
    v_mov_b32 v123, s12
    v_mov_b32 v124, s12
    v_mov_b32 v125, s12
    v_mov_b32 v126, s12
    v_mov_b32 v127, s12
    v_mov_b32 v128, s12
    v_mov_b32 v129, s12
    v_mov_b32 v130, s12
    v_mov_b32 v131, s12
    v_mov_b32 v132, s12
    v_mov_b32 v133, s12
    v_mov_b32 v134, s12
    v_mov_b32 v135, s12
    v_mov_b32 v136, s12
    v_mov_b32 v137, s12
    v_mov_b32 v138, s12
    v_mov_b32 v139, s12
    v_mov_b32 v140, s12
    v_mov_b32 v141, s12
    v_mov_b32 v142, s12
    v_mov_b32 v143, s12
    v_lshlrev_b32 v8, 4, v1
    v_lshl_add_u32 v9, v2, 15, v8
    v_mov_b32 v192, 0
    v_mov_b32 v193, 0
    s_mul_i32 s3, s21, 20
    s_lshl_b32 s12, s23, 2
    s_add_u32 s3, s3, s12
    s_lshr_b32 s3, s3, 3
    v_add_u32 v3, s3, v2
    v_lshrrev_b32 v4, 4, v1
    v_lshlrev_b32 v4, 11, v4
    v_and_b32 v5, 15, v1
    v_lshl_add_u32 v4, v5, 4, v4
    v_lshrrev_b32 v5, 2, v3
    v_lshl_add_u32 v10, v5, 12, v4
    v_and_b32 v5, 3, v3
    v_lshl_add_u32 v10, v5, 8, v10
    s_lshr_b32 s3, s21, 1
    s_mul_i32 s3, s3, 5
    s_add_u32 s3, s3, 2
    s_lshr_b32 s12, s3, 2
    s_lshl_b32 s12, s12, 12
    s_and_b32 s3, s3, 3
    s_lshl_b32 s3, s3, 8
    s_add_u32 s3, s3, s12
    s_lshl_b32 s12, s23, 3
    s_add_u32 s3, s3, s12
    v_add_u32 v11, s3, v4
    s_mul_i32 s3, s20, 327680
    s_add_u32 s27, s3, 14155776
    s_add_u32 s28, s3, 14237696
    s_add_u32 s29, s3, 14319616
    s_add_u32 s30, s3, 14401536
    v_lshlrev_b32 v12, 4, v0
    v_add_u32 v12, 36864, v12
    s_lshl_b32 s3, s20, 12
    v_add_u32 v13, s3, v12
    s_waitcnt vmcnt(0)
    s_mov_b32 s63, 200000
LP7:
    v_xor_b32 v246, s62, v246
    v_xor_b32 v247, s62, v247
    v_xor_b32 v248, s62, v248
    v_xor_b32 v249, s62, v249
    v_or3_b32 v246, v246, v247, v248
    v_or_b32 v246, v246, v249
    v_cmp_ne_u32 vcc, 0, v246
    s_nop 1
    s_cmp_eq_u64 vcc, 0
    s_cbranch_scc1 LPo7
    s_sub_u32 s63, s63, 1
    s_cmp_eq_u32 s63, 0
    s_cbranch_scc1 LPo7
    buffer_load_dwordx4 v[246:249], v250, s[32:35], 0 offen sc1
    s_waitcnt vmcnt(0)
    s_branch LP7
LPo7:
    buffer_load_dwordx4 v[16:19], v6, s[32:35], s4 offen offset:0 sc1
    s_mov_b32 exec_lo, 0x00ffffff
    s_mov_b32 exec_hi, 0x00ffffff
    buffer_load_dwordx4 v[80:83], v7, s[32:35], s7 offen offset:0 sc1
    s_mov_b64 exec, -1
    buffer_load_dwordx4 v[20:23], v6, s[32:35], s4 offen offset:128 sc1
    s_mov_b32 exec_lo, 0x00ffffff
    s_mov_b32 exec_hi, 0x00ffffff
    buffer_load_dwordx4 v[84:87], v7, s[32:35], s7 offen offset:128 sc1
    s_mov_b64 exec, -1
    s_add_u32 s4, s4, 256
    s_add_u32 s7, s7, 256
    buffer_load_dwordx4 v[24:27], v6, s[32:35], s4 offen offset:0 sc1
    s_mov_b32 exec_lo, 0x00ffffff
    s_mov_b32 exec_hi, 0x00ffffff
    buffer_load_dwordx4 v[88:91], v7, s[32:35], s7 offen offset:0 sc1
    s_mov_b64 exec, -1
    buffer_load_dwordx4 v[28:31], v6, s[32:35], s4 offen offset:128 sc1
    s_mov_b32 exec_lo, 0x00ffffff
    s_mov_b32 exec_hi, 0x00ffffff
    buffer_load_dwordx4 v[92:95], v7, s[32:35], s7 offen offset:128 sc1
    s_mov_b64 exec, -1
    s_add_u32 s4, s4, 256
    s_add_u32 s7, s7, 256
    buffer_load_dwordx4 v[32:35], v6, s[32:35], s4 offen offset:0 sc1
    s_mov_b32 exec_lo, 0x00ffffff
    s_mov_b32 exec_hi, 0x00ffffff
    buffer_load_dwordx4 v[96:99], v7, s[32:35], s7 offen offset:0 sc1
    s_mov_b64 exec, -1
    buffer_load_dwordx4 v[36:39], v6, s[32:35], s4 offen offset:128 sc1
    s_mov_b32 exec_lo, 0x00ffffff
    s_mov_b32 exec_hi, 0x00ffffff
    buffer_load_dwordx4 v[100:103], v7, s[32:35], s7 offen offset:128 sc1
    s_mov_b64 exec, -1
    s_add_u32 s4, s4, 256
    s_add_u32 s7, s7, 256
    buffer_load_dwordx4 v[40:43], v6, s[32:35], s4 offen offset:0 sc1
    s_mov_b32 exec_lo, 0x00ffffff
    s_mov_b32 exec_hi, 0x00ffffff
    buffer_load_dwordx4 v[104:107], v7, s[32:35], s7 offen offset:0 sc1
    s_mov_b64 exec, -1
    buffer_load_dwordx4 v[44:47], v6, s[32:35], s4 offen offset:128 sc1
    s_mov_b32 exec_lo, 0x00ffffff
    s_mov_b32 exec_hi, 0x00ffffff
    buffer_load_dwordx4 v[108:111], v7, s[32:35], s7 offen offset:128 sc1
    s_mov_b64 exec, -1
    s_add_u32 s4, s4, 256
    s_add_u32 s7, s7, 256
    buffer_load_dwordx4 v[48:51], v6, s[32:35], s4 offen offset:0 sc1
    s_mov_b32 exec_lo, 0x00ffffff
    s_mov_b32 exec_hi, 0x00ffffff
    buffer_load_dwordx4 v[112:115], v7, s[32:35], s7 offen offset:0 sc1
    s_mov_b64 exec, -1
    buffer_load_dwordx4 v[52:55], v6, s[32:35], s4 offen offset:128 sc1
    s_mov_b32 exec_lo, 0x00ffffff
    s_mov_b32 exec_hi, 0x00ffffff
    buffer_load_dwordx4 v[116:119], v7, s[32:35], s7 offen offset:128 sc1
    s_mov_b64 exec, -1
    s_add_u32 s4, s4, 256
    s_add_u32 s7, s7, 256
    buffer_load_dwordx4 v[56:59], v6, s[32:35], s4 offen offset:0 sc1
    s_mov_b32 exec_lo, 0x00ffffff
    s_mov_b32 exec_hi, 0x00ffffff
    buffer_load_dwordx4 v[120:123], v7, s[32:35], s7 offen offset:0 sc1
    s_mov_b64 exec, -1
    buffer_load_dwordx4 v[60:63], v6, s[32:35], s4 offen offset:128 sc1
    s_mov_b32 exec_lo, 0x00ffffff
    s_mov_b32 exec_hi, 0x00ffffff
    buffer_load_dwordx4 v[124:127], v7, s[32:35], s7 offen offset:128 sc1
    s_mov_b64 exec, -1
    s_add_u32 s4, s4, 256
    s_add_u32 s7, s7, 256
    buffer_load_dwordx4 v[64:67], v6, s[32:35], s4 offen offset:0 sc1
    s_mov_b32 exec_lo, 0x00ffffff
    s_mov_b32 exec_hi, 0x00ffffff
    buffer_load_dwordx4 v[128:131], v7, s[32:35], s7 offen offset:0 sc1
    s_mov_b64 exec, -1
    buffer_load_dwordx4 v[68:71], v6, s[32:35], s4 offen offset:128 sc1
    s_mov_b32 exec_lo, 0x00ffffff
    s_mov_b32 exec_hi, 0x00ffffff
    buffer_load_dwordx4 v[132:135], v7, s[32:35], s7 offen offset:128 sc1
    s_mov_b64 exec, -1
    s_add_u32 s4, s4, 256
    s_add_u32 s7, s7, 256
    buffer_load_dwordx4 v[72:75], v6, s[32:35], s4 offen offset:0 sc1
    s_mov_b32 exec_lo, 0x00ffffff
    s_mov_b32 exec_hi, 0x00ffffff
    buffer_load_dwordx4 v[136:139], v7, s[32:35], s7 offen offset:0 sc1
    s_mov_b64 exec, -1
    buffer_load_dwordx4 v[76:79], v6, s[32:35], s4 offen offset:128 sc1
    s_mov_b32 exec_lo, 0x00ffffff
    s_mov_b32 exec_hi, 0x00ffffff
    buffer_load_dwordx4 v[140:143], v7, s[32:35], s7 offen offset:128 sc1
    s_mov_b64 exec, -1
    s_add_u32 s4, s4, 256
    s_add_u32 s7, s7, 256
    buffer_load_dwordx4 v[144:147], v9, s[32:35], s24 offen offset:0 sc1
    buffer_load_dwordx4 v[148:151], v9, s[32:35], s25 offen offset:0 sc1
    buffer_load_dwordx4 v[176:179], v8, s[32:35], s26 offen offset:0 sc1
    buffer_load_dwordx4 v[152:155], v9, s[32:35], s24 offen offset:512 sc1
    buffer_load_dwordx4 v[156:159], v9, s[32:35], s25 offen offset:512 sc1
    buffer_load_dwordx4 v[180:183], v8, s[32:35], s26 offen offset:512 sc1
    buffer_load_dwordx4 v[160:163], v9, s[32:35], s24 offen offset:1024 sc1
    buffer_load_dwordx4 v[164:167], v9, s[32:35], s25 offen offset:1024 sc1
    buffer_load_dwordx4 v[184:187], v8, s[32:35], s26 offen offset:1024 sc1
    buffer_load_dwordx4 v[168:171], v9, s[32:35], s24 offen offset:1536 sc1
    buffer_load_dwordx4 v[172:175], v9, s[32:35], s25 offen offset:1536 sc1
    buffer_load_dwordx4 v[188:191], v8, s[32:35], s26 offen offset:1536 sc1
    s_waitcnt vmcnt(42)
    v_mfma_f32_32x32x16_bf16 v[208:223], v[16:19], v[80:83], 0
    s_waitcnt vmcnt(40)
    v_mfma_f32_32x32x16_bf16 v[208:223], v[20:23], v[84:87], v[208:223]
    s_waitcnt vmcnt(38)
    v_mfma_f32_32x32x16_bf16 v[208:223], v[24:27], v[88:91], v[208:223]
    s_waitcnt vmcnt(36)
    v_mfma_f32_32x32x16_bf16 v[208:223], v[28:31], v[92:95], v[208:223]
    s_waitcnt vmcnt(34)
    v_mfma_f32_32x32x16_bf16 v[208:223], v[32:35], v[96:99], v[208:223]
    s_waitcnt vmcnt(32)
    v_mfma_f32_32x32x16_bf16 v[208:223], v[36:39], v[100:103], v[208:223]
    s_waitcnt vmcnt(30)
    v_mfma_f32_32x32x16_bf16 v[208:223], v[40:43], v[104:107], v[208:223]
    s_waitcnt vmcnt(28)
    v_mfma_f32_32x32x16_bf16 v[208:223], v[44:47], v[108:111], v[208:223]
    s_waitcnt vmcnt(26)
    v_mfma_f32_32x32x16_bf16 v[208:223], v[48:51], v[112:115], v[208:223]
    s_waitcnt vmcnt(24)
    v_mfma_f32_32x32x16_bf16 v[208:223], v[52:55], v[116:119], v[208:223]
    s_waitcnt vmcnt(22)
    v_mfma_f32_32x32x16_bf16 v[208:223], v[56:59], v[120:123], v[208:223]
    s_waitcnt vmcnt(20)
    v_mfma_f32_32x32x16_bf16 v[208:223], v[60:63], v[124:127], v[208:223]
    s_waitcnt vmcnt(18)
    v_mfma_f32_32x32x16_bf16 v[208:223], v[64:67], v[128:131], v[208:223]
    s_waitcnt vmcnt(16)
    v_mfma_f32_32x32x16_bf16 v[208:223], v[68:71], v[132:135], v[208:223]
    s_waitcnt vmcnt(14)
    v_mfma_f32_32x32x16_bf16 v[208:223], v[72:75], v[136:139], v[208:223]
    s_waitcnt vmcnt(12)
    v_mfma_f32_32x32x16_bf16 v[208:223], v[76:79], v[140:143], v[208:223]
    s_nop 11
    ds_write_b128 v13, v[208:211] offset:0
    ds_write_b128 v13, v[212:215] offset:1024
    ds_write_b128 v13, v[216:219] offset:2048
    s_waitcnt lgkmcnt(0)
    s_barrier
    ds_read_b128 v[16:19], v12 offset:0
    ds_read_b128 v[20:23], v12 offset:1024
    ds_read_b128 v[24:27], v12 offset:2048
    ds_read_b128 v[28:31], v12 offset:4096
    ds_read_b128 v[32:35], v12 offset:5120
    ds_read_b128 v[36:39], v12 offset:6144
    ds_read_b128 v[40:43], v12 offset:8192
    ds_read_b128 v[44:47], v12 offset:9216
    ds_read_b128 v[48:51], v12 offset:10240
    ds_read_b128 v[52:55], v12 offset:12288
    ds_read_b128 v[56:59], v12 offset:13312
    ds_read_b128 v[60:63], v12 offset:14336
    s_waitcnt lgkmcnt(0)
    ds_read_b128 v[64:67], v12 offset:16384
    ds_read_b128 v[68:71], v12 offset:17408
    ds_read_b128 v[72:75], v12 offset:18432
    ds_read_b128 v[76:79], v12 offset:20480
    ds_read_b128 v[80:83], v12 offset:21504
    ds_read_b128 v[84:87], v12 offset:22528
    ds_read_b128 v[88:91], v12 offset:24576
    ds_read_b128 v[92:95], v12 offset:25600
    ds_read_b128 v[96:99], v12 offset:26624
    ds_read_b128 v[100:103], v12 offset:28672
    ds_read_b128 v[104:107], v12 offset:29696
    ds_read_b128 v[108:111], v12 offset:30720
    s_waitcnt lgkmcnt(0)
    s_barrier
    v_pk_add_f32 v[16:17], v[16:17], v[28:29]
    v_pk_add_f32 v[18:19], v[18:19], v[30:31]
    v_pk_add_f32 v[20:21], v[20:21], v[32:33]
    v_pk_add_f32 v[22:23], v[22:23], v[34:35]
    v_pk_add_f32 v[24:25], v[24:25], v[36:37]
    v_pk_add_f32 v[26:27], v[26:27], v[38:39]
    v_pk_add_f32 v[16:17], v[16:17], v[40:41]
    v_pk_add_f32 v[18:19], v[18:19], v[42:43]
    v_pk_add_f32 v[20:21], v[20:21], v[44:45]
    v_pk_add_f32 v[22:23], v[22:23], v[46:47]
    v_pk_add_f32 v[24:25], v[24:25], v[48:49]
    v_pk_add_f32 v[26:27], v[26:27], v[50:51]
    v_pk_add_f32 v[16:17], v[16:17], v[52:53]
    v_pk_add_f32 v[18:19], v[18:19], v[54:55]
    v_pk_add_f32 v[20:21], v[20:21], v[56:57]
    v_pk_add_f32 v[22:23], v[22:23], v[58:59]
    v_pk_add_f32 v[24:25], v[24:25], v[60:61]
    v_pk_add_f32 v[26:27], v[26:27], v[62:63]
    v_pk_add_f32 v[16:17], v[16:17], v[64:65]
    v_pk_add_f32 v[18:19], v[18:19], v[66:67]
    v_pk_add_f32 v[20:21], v[20:21], v[68:69]
    v_pk_add_f32 v[22:23], v[22:23], v[70:71]
    v_pk_add_f32 v[24:25], v[24:25], v[72:73]
    v_pk_add_f32 v[26:27], v[26:27], v[74:75]
    v_pk_add_f32 v[16:17], v[16:17], v[76:77]
    v_pk_add_f32 v[18:19], v[18:19], v[78:79]
    v_pk_add_f32 v[20:21], v[20:21], v[80:81]
    v_pk_add_f32 v[22:23], v[22:23], v[82:83]
    v_pk_add_f32 v[24:25], v[24:25], v[84:85]
    v_pk_add_f32 v[26:27], v[26:27], v[86:87]
    v_pk_add_f32 v[16:17], v[16:17], v[88:89]
    v_pk_add_f32 v[18:19], v[18:19], v[90:91]
    v_pk_add_f32 v[20:21], v[20:21], v[92:93]
    v_pk_add_f32 v[22:23], v[22:23], v[94:95]
    v_pk_add_f32 v[24:25], v[24:25], v[96:97]
    v_pk_add_f32 v[26:27], v[26:27], v[98:99]
    v_pk_add_f32 v[16:17], v[16:17], v[100:101]
    v_pk_add_f32 v[18:19], v[18:19], v[102:103]
    v_pk_add_f32 v[20:21], v[20:21], v[104:105]
    v_pk_add_f32 v[22:23], v[22:23], v[106:107]
    v_pk_add_f32 v[24:25], v[24:25], v[108:109]
    v_pk_add_f32 v[26:27], v[26:27], v[110:111]
    v_cvt_pk_bf16_f32 v128, v16, v17
    v_cvt_pk_bf16_f32 v129, v18, v19
    v_cvt_pk_bf16_f32 v130, v20, v21
    v_cvt_pk_bf16_f32 v131, v22, v23
    v_cvt_pk_bf16_f32 v132, v24, v25
    v_cvt_pk_bf16_f32 v133, v26, v27
    v_mov_b32 v134, 0
    v_mov_b32 v135, 0
    s_mov_b32 exec_lo, 0
    v_mov_b32 v132, 0
    v_mov_b32 v133, 0
    s_mov_b64 exec, -1
    s_mov_b32 s31, 0x358637bd
    s_waitcnt vmcnt(0)
    v_swap_b32 v146, v148
    v_swap_b32 v147, v149
    v_swap_b32 v154, v156
    v_swap_b32 v155, v157
    v_swap_b32 v162, v164
    v_swap_b32 v163, v165
    v_swap_b32 v170, v172
    v_swap_b32 v171, v173
    s_nop 1
    v_mfma_f32_32x32x16_bf16 v[16:31], v[128:131], v[144:147], 0
    v_mfma_f32_32x32x16_bf16 v[16:31], v[132:135], v[176:179], v[16:31]
    v_mfma_f32_32x32x16_bf16 v[32:47], v[128:131], v[148:151], 0
    v_mfma_f32_32x32x16_bf16 v[32:47], v[132:135], v[178:181], v[32:47]
    v_mfma_f32_32x32x16_bf16 v[48:63], v[128:131], v[152:155], 0
    v_mfma_f32_32x32x16_bf16 v[48:63], v[132:135], v[180:183], v[48:63]
    v_mfma_f32_32x32x16_bf16 v[64:79], v[128:131], v[156:159], 0
    v_mfma_f32_32x32x16_bf16 v[64:79], v[132:135], v[182:185], v[64:79]
    v_mfma_f32_32x32x16_bf16 v[80:95], v[128:131], v[160:163], 0
    v_mfma_f32_32x32x16_bf16 v[80:95], v[132:135], v[184:187], v[80:95]
    v_mfma_f32_32x32x16_bf16 v[96:111], v[128:131], v[164:167], 0
    v_mfma_f32_32x32x16_bf16 v[96:111], v[132:135], v[186:189], v[96:111]
    v_mfma_f32_32x32x16_bf16 v[112:127], v[128:131], v[168:171], 0
    v_mfma_f32_32x32x16_bf16 v[112:127], v[132:135], v[188:191], v[112:127]
    v_mfma_f32_32x32x16_bf16 v[208:223], v[128:131], v[172:175], 0
    v_mfma_f32_32x32x16_bf16 v[208:223], v[132:135], v[190:193], v[208:223]
    v_add_f32 v28, s31, v28
    v_rcp_f32 v28, v28
    s_nop 0
    v_pk_mul_f32 v[16:17], v[16:17], v[28:29] op_sel_hi:[1,0]
    v_pk_mul_f32 v[18:19], v[18:19], v[28:29] op_sel_hi:[1,0]
    v_pk_mul_f32 v[20:21], v[20:21], v[28:29] op_sel_hi:[1,0]
    v_pk_mul_f32 v[22:23], v[22:23], v[28:29] op_sel_hi:[1,0]
    v_pk_mul_f32 v[24:25], v[24:25], v[28:29] op_sel_hi:[1,0]
    v_pk_mul_f32 v[26:27], v[26:27], v[28:29] op_sel_hi:[1,0]
    v_cvt_pk_bf16_f32 v16, v16, v17
    v_cvt_pk_bf16_f32 v17, v18, v19
    v_cvt_pk_bf16_f32 v18, v20, v21
    v_cvt_pk_bf16_f32 v19, v22, v23
    v_cvt_pk_bf16_f32 v20, v24, v25
    v_cvt_pk_bf16_f32 v21, v26, v27
    buffer_store_dwordx4 v[16:19], v10, s[32:35], s27 offen offset:0 sc1
    s_mov_b32 exec_hi, 0
    buffer_store_dwordx2 v[20:21], v11, s[32:35], s27 offen offset:0 sc1
    s_mov_b64 exec, -1
    v_add_f32 v44, s31, v44
    v_rcp_f32 v44, v44
    s_nop 0
    v_pk_mul_f32 v[32:33], v[32:33], v[44:45] op_sel_hi:[1,0]
    v_pk_mul_f32 v[34:35], v[34:35], v[44:45] op_sel_hi:[1,0]
    v_pk_mul_f32 v[36:37], v[36:37], v[44:45] op_sel_hi:[1,0]
    v_pk_mul_f32 v[38:39], v[38:39], v[44:45] op_sel_hi:[1,0]
    v_pk_mul_f32 v[40:41], v[40:41], v[44:45] op_sel_hi:[1,0]
    v_pk_mul_f32 v[42:43], v[42:43], v[44:45] op_sel_hi:[1,0]
    v_cvt_pk_bf16_f32 v32, v32, v33
    v_cvt_pk_bf16_f32 v33, v34, v35
    v_cvt_pk_bf16_f32 v34, v36, v37
    v_cvt_pk_bf16_f32 v35, v38, v39
    v_cvt_pk_bf16_f32 v36, v40, v41
    v_cvt_pk_bf16_f32 v37, v42, v43
    buffer_store_dwordx4 v[32:35], v10, s[32:35], s27 offen offset:1024 sc1
    s_mov_b32 exec_hi, 0
    buffer_store_dwordx2 v[36:37], v11, s[32:35], s27 offen offset:1024 sc1
    s_mov_b64 exec, -1
    v_add_f32 v60, s31, v60
    v_rcp_f32 v60, v60
    s_nop 0
    v_pk_mul_f32 v[48:49], v[48:49], v[60:61] op_sel_hi:[1,0]
    v_pk_mul_f32 v[50:51], v[50:51], v[60:61] op_sel_hi:[1,0]
    v_pk_mul_f32 v[52:53], v[52:53], v[60:61] op_sel_hi:[1,0]
    v_pk_mul_f32 v[54:55], v[54:55], v[60:61] op_sel_hi:[1,0]
    v_pk_mul_f32 v[56:57], v[56:57], v[60:61] op_sel_hi:[1,0]
    v_pk_mul_f32 v[58:59], v[58:59], v[60:61] op_sel_hi:[1,0]
    v_cvt_pk_bf16_f32 v48, v48, v49
    v_cvt_pk_bf16_f32 v49, v50, v51
    v_cvt_pk_bf16_f32 v50, v52, v53
    v_cvt_pk_bf16_f32 v51, v54, v55
    v_cvt_pk_bf16_f32 v52, v56, v57
    v_cvt_pk_bf16_f32 v53, v58, v59
    buffer_store_dwordx4 v[48:51], v10, s[32:35], s28 offen offset:0 sc1
    s_mov_b32 exec_hi, 0
    buffer_store_dwordx2 v[52:53], v11, s[32:35], s28 offen offset:0 sc1
    s_mov_b64 exec, -1
    v_add_f32 v76, s31, v76
    v_rcp_f32 v76, v76
    s_nop 0
    v_pk_mul_f32 v[64:65], v[64:65], v[76:77] op_sel_hi:[1,0]
    v_pk_mul_f32 v[66:67], v[66:67], v[76:77] op_sel_hi:[1,0]
    v_pk_mul_f32 v[68:69], v[68:69], v[76:77] op_sel_hi:[1,0]
    v_pk_mul_f32 v[70:71], v[70:71], v[76:77] op_sel_hi:[1,0]
    v_pk_mul_f32 v[72:73], v[72:73], v[76:77] op_sel_hi:[1,0]
    v_pk_mul_f32 v[74:75], v[74:75], v[76:77] op_sel_hi:[1,0]
    v_cvt_pk_bf16_f32 v64, v64, v65
    v_cvt_pk_bf16_f32 v65, v66, v67
    v_cvt_pk_bf16_f32 v66, v68, v69
    v_cvt_pk_bf16_f32 v67, v70, v71
    v_cvt_pk_bf16_f32 v68, v72, v73
    v_cvt_pk_bf16_f32 v69, v74, v75
    buffer_store_dwordx4 v[64:67], v10, s[32:35], s28 offen offset:1024 sc1
    s_mov_b32 exec_hi, 0
    buffer_store_dwordx2 v[68:69], v11, s[32:35], s28 offen offset:1024 sc1
    s_mov_b64 exec, -1
    v_add_f32 v92, s31, v92
    v_rcp_f32 v92, v92
    s_nop 0
    v_pk_mul_f32 v[80:81], v[80:81], v[92:93] op_sel_hi:[1,0]
    v_pk_mul_f32 v[82:83], v[82:83], v[92:93] op_sel_hi:[1,0]
    v_pk_mul_f32 v[84:85], v[84:85], v[92:93] op_sel_hi:[1,0]
    v_pk_mul_f32 v[86:87], v[86:87], v[92:93] op_sel_hi:[1,0]
    v_pk_mul_f32 v[88:89], v[88:89], v[92:93] op_sel_hi:[1,0]
    v_pk_mul_f32 v[90:91], v[90:91], v[92:93] op_sel_hi:[1,0]
    v_cvt_pk_bf16_f32 v80, v80, v81
    v_cvt_pk_bf16_f32 v81, v82, v83
    v_cvt_pk_bf16_f32 v82, v84, v85
    v_cvt_pk_bf16_f32 v83, v86, v87
    v_cvt_pk_bf16_f32 v84, v88, v89
    v_cvt_pk_bf16_f32 v85, v90, v91
    buffer_store_dwordx4 v[80:83], v10, s[32:35], s29 offen offset:0 sc1
    s_mov_b32 exec_hi, 0
    buffer_store_dwordx2 v[84:85], v11, s[32:35], s29 offen offset:0 sc1
    s_mov_b64 exec, -1
    v_add_f32 v108, s31, v108
    v_rcp_f32 v108, v108
    s_nop 0
    v_pk_mul_f32 v[96:97], v[96:97], v[108:109] op_sel_hi:[1,0]
    v_pk_mul_f32 v[98:99], v[98:99], v[108:109] op_sel_hi:[1,0]
    v_pk_mul_f32 v[100:101], v[100:101], v[108:109] op_sel_hi:[1,0]
    v_pk_mul_f32 v[102:103], v[102:103], v[108:109] op_sel_hi:[1,0]
    v_pk_mul_f32 v[104:105], v[104:105], v[108:109] op_sel_hi:[1,0]
    v_pk_mul_f32 v[106:107], v[106:107], v[108:109] op_sel_hi:[1,0]
    v_cvt_pk_bf16_f32 v96, v96, v97
    v_cvt_pk_bf16_f32 v97, v98, v99
    v_cvt_pk_bf16_f32 v98, v100, v101
    v_cvt_pk_bf16_f32 v99, v102, v103
    v_cvt_pk_bf16_f32 v100, v104, v105
    v_cvt_pk_bf16_f32 v101, v106, v107
    buffer_store_dwordx4 v[96:99], v10, s[32:35], s29 offen offset:1024 sc1
    s_mov_b32 exec_hi, 0
    buffer_store_dwordx2 v[100:101], v11, s[32:35], s29 offen offset:1024 sc1
    s_mov_b64 exec, -1
    v_add_f32 v124, s31, v124
    v_rcp_f32 v124, v124
    s_nop 0
    v_pk_mul_f32 v[112:113], v[112:113], v[124:125] op_sel_hi:[1,0]
    v_pk_mul_f32 v[114:115], v[114:115], v[124:125] op_sel_hi:[1,0]
    v_pk_mul_f32 v[116:117], v[116:117], v[124:125] op_sel_hi:[1,0]
    v_pk_mul_f32 v[118:119], v[118:119], v[124:125] op_sel_hi:[1,0]
    v_pk_mul_f32 v[120:121], v[120:121], v[124:125] op_sel_hi:[1,0]
    v_pk_mul_f32 v[122:123], v[122:123], v[124:125] op_sel_hi:[1,0]
    v_cvt_pk_bf16_f32 v112, v112, v113
    v_cvt_pk_bf16_f32 v113, v114, v115
    v_cvt_pk_bf16_f32 v114, v116, v117
    v_cvt_pk_bf16_f32 v115, v118, v119
    v_cvt_pk_bf16_f32 v116, v120, v121
    v_cvt_pk_bf16_f32 v117, v122, v123
    buffer_store_dwordx4 v[112:115], v10, s[32:35], s30 offen offset:0 sc1
    s_mov_b32 exec_hi, 0
    buffer_store_dwordx2 v[116:117], v11, s[32:35], s30 offen offset:0 sc1
    s_mov_b64 exec, -1
    s_nop 11
    v_add_f32 v220, s31, v220
    v_rcp_f32 v220, v220
    s_nop 0
    v_pk_mul_f32 v[208:209], v[208:209], v[220:221] op_sel_hi:[1,0]
    v_pk_mul_f32 v[210:211], v[210:211], v[220:221] op_sel_hi:[1,0]
    v_pk_mul_f32 v[212:213], v[212:213], v[220:221] op_sel_hi:[1,0]
    v_pk_mul_f32 v[214:215], v[214:215], v[220:221] op_sel_hi:[1,0]
    v_pk_mul_f32 v[216:217], v[216:217], v[220:221] op_sel_hi:[1,0]
    v_pk_mul_f32 v[218:219], v[218:219], v[220:221] op_sel_hi:[1,0]
    v_cvt_pk_bf16_f32 v208, v208, v209
    v_cvt_pk_bf16_f32 v209, v210, v211
    v_cvt_pk_bf16_f32 v210, v212, v213
    v_cvt_pk_bf16_f32 v211, v214, v215
    v_cvt_pk_bf16_f32 v212, v216, v217
    v_cvt_pk_bf16_f32 v213, v218, v219
    buffer_store_dwordx4 v[208:211], v10, s[32:35], s30 offen offset:1024 sc1
    s_mov_b32 exec_hi, 0
    buffer_store_dwordx2 v[212:213], v11, s[32:35], s30 offen offset:1024 sc1
    s_mov_b64 exec, -1
    s_lshl_b32 s3, s21, 5
    s_add_u32 s3, s3, s20
    s_lshl_b32 s3, s3, 2
    s_add_u32 s3, s3, 17367040
    s_mov_b32 s31, s3
    s_cmp_ge_u32 s20, 4
    s_cbranch_scc1 L_w19
    s_waitcnt vmcnt(0)
    v_mov_b32 v251, s62
    s_mov_b64 exec, 1
    buffer_store_dword v251, v252, s[32:35], s3 offen sc1
    s_mov_b64 exec, -1
    s_cmp_ge_u32 s20, 4
    s_cbranch_scc1 L_w19
    s_branch L_cfromh
L_end:
    s_endpgm
.section .rodata,"a"
.p2align 6
.amdhsa_kernel parallel_sum__linear_attn_block__mixer_token_mlp__prompt_kernel
  .amdhsa_next_free_vgpr 256
  .amdhsa_next_free_sgpr 102
  .amdhsa_accum_offset 256
  .amdhsa_group_segment_fixed_size 0
  .amdhsa_kernarg_size 88
  .amdhsa_user_sgpr_count 2
  .amdhsa_user_sgpr_kernarg_segment_ptr 1
  .amdhsa_system_sgpr_workgroup_id_x 1
.end_amdhsa_kernel
```
